```python
import torch

def _softmax(x, axis=-1):
    return torch.softmax(x, dim=axis)
def _gelu(x):
    return torch.nn.functional.gelu(x, approximate="tanh")
def _silu(x):
    return torch.nn.functional.silu(x)
def _sigmoid(x):
    return torch.sigmoid(x)
def _layernorm(x, axis=-1, eps=1e-5):
    m = x.mean(dim=axis, keepdim=True)
    v = x.var(dim=axis, keepdim=True, unbiased=False)
    return (x - m) / torch.sqrt(v + eps)
def _scatter_add(tgt, idx, src, axis=0):
    return tgt.clone().index_add_(axis, idx, src)
def _segment_sum(src, seg, n):
    out = torch.zeros((n,) + src.shape[1:], dtype=src.dtype)
    return out.index_add_(0, seg, src)
def _pad(x, pw):
    flat = tuple(v for pair in reversed(pw) for v in pair)
    return torch.nn.functional.pad(x, flat)

kernel_name = 'gated_mix__linear_kernel_hedgehog__mixer_token_mlp__prompt'

def setup_inputs():

    _w = (lambda a: (lambda t: t.to(torch.bfloat16) if t.is_floating_point() else t)(torch.as_tensor(a)))
    def _A_setup():
        B, S, D, H = 1, 2048, 1024, 32
        Dh = D // H
        return {
            "x": _w((lambda *s: torch.randn(*s, dtype=torch.bfloat16) * 0.05)(B, S, D)),
            "wqkv": _w((lambda *s: torch.randn(*s, dtype=torch.bfloat16) * 0.8)(D, 3 * D)),
            "w_phi": _w((lambda *s: torch.randn(*s, dtype=torch.bfloat16) * 0.8)(H, Dh, Dh) * (Dh ** -0.5)),
            "wo": _w((lambda *s: torch.randn(*s, dtype=torch.bfloat16) * 0.05)(D, D)),
        }
    _A_in = _A_setup()

    def _B_setup():
        B, S, D, F = 1, 2048, 1024, 3584
        return {
            "x": _w((lambda *s: torch.randn(*s, dtype=torch.bfloat16) * 0.05)(B, S, D)),
            "w1": _w((lambda *s: torch.randn(*s, dtype=torch.bfloat16) * 0.8)(S, F) * (S ** -0.5)),
            "b1": _w((lambda *s: torch.randn(*s, dtype=torch.bfloat16) * 12.8)(F) * 0.02),
            "w2": _w((lambda *s: torch.randn(*s, dtype=torch.bfloat16) * 0.05)(F, S) * (F ** -0.5)),
            "b2": _w((lambda *s: torch.randn(*s, dtype=torch.bfloat16) * 0.8)(S) * 0.02),
        }
    _B_in = _B_setup()

    return {
        "A_x": _A_in["x"],
        "A_wqkv": _A_in["wqkv"],
        "A_w_phi": _A_in["w_phi"],
        "A_wo": _A_in["wo"],
        "B_x": _B_in["x"],
        "B_w1": _B_in["w1"],
        "B_b1": _B_in["b1"],
        "B_w2": _B_in["w2"],
        "B_b2": _B_in["b2"],
        "gate_w": _w((lambda *s: torch.randn(*s, dtype=torch.bfloat16) * 0.05)(1024) * 16.0),
    }

def reference(A_x, A_wqkv, A_w_phi, A_wo, B_x, B_w1, B_b1, B_w2, B_b2, gate_w):
    def _A_ref(x, wqkv, w_phi, wo):
        B, S, D = x.shape
        H = 32; Dh = D // H
        qkv = (lambda x, *d: x.permute(*d))((x @ wqkv).reshape(B, S, 3, H, Dh), 2, 0, 3, 1, 4)
        q, k, v = qkv[0], qkv[1], qkv[2]
        pq = torch.einsum("bhsd,hdf->bhsf", q, w_phi)
        pk = torch.einsum("bhsd,hdf->bhsf", k, w_phi)
        phi_q = torch.concatenate([_softmax(pq, axis=-1), _softmax(-pq, axis=-1)], axis=-1)
        phi_k = torch.concatenate([_softmax(pk, axis=-1), _softmax(-pk, axis=-1)], axis=-1)
        kv = torch.einsum("bhsf,bhsd->bhfd", phi_k, v)
        z  = torch.einsum("bhsf->bhf", phi_k)
        num = torch.einsum("bhqf,bhfd->bhqd", phi_q, kv)
        den = torch.einsum("bhqf,bhf->bhq", phi_q, z)[..., None] + 1e-6
        o = num / den
        return (lambda x, *d: x.permute(*d))(o, 0, 2, 1, 3).reshape(B, S, D) @ wo

    def _B_ref(x, w1, b1, w2, b2):
        B, S, D = x.shape
        h = _layernorm(x, axis=-1)
        u = torch.einsum("bsd,sf->bdf", h, w1) + b1
        u = _gelu(u)
        y = torch.einsum("bdf,fs->bds", u, w2) + b2
        return (lambda x, *d: x.permute(*d))(y, 0, 2, 1)

    x = A_x
    g = _sigmoid((x * gate_w).sum(-1, keepdims=True))
    a = _A_ref(x, A_wqkv, A_w_phi, A_wo)
    b = _B_ref(x, B_w1, B_b1, B_w2, B_b2)
    return g * a + (1 - g) * b
```

```asm
; @launch grid=(256,1,1) block=(512,1,1) lds=159744
.amdgcn_target "amdgcn-amd-amdhsa--gfx950"
.text
.globl gated_mix__linear_kernel_hedgehog__mixer_token_mlp__prompt_kernel
.p2align 8
.type gated_mix__linear_kernel_hedgehog__mixer_token_mlp__prompt_kernel,@function
gated_mix__linear_kernel_hedgehog__mixer_token_mlp__prompt_kernel:
    s_cmp_ge_u32 s2, 256
    s_cbranch_scc1 L1_end
    s_load_dwordx2 s[44:45], s[0:1], 96
    s_load_dwordx4 s[4:7], s[0:1], 0
    s_load_dwordx2 s[20:21], s[0:1], 16
    s_load_dwordx4 s[40:43], s[0:1], 40
    s_load_dwordx4 s[92:95], s[0:1], 56
    s_load_dwordx2 s[96:97], s[0:1], 24
    s_load_dwordx2 s[98:99], s[0:1], 80
    s_load_dwordx2 s[22:23], s[0:1], 88
    s_load_dwordx2 s[100:101], s[0:1], 72
    v_lshrrev_b32 v2, 6, v0
    v_and_b32 v1, 63, v0
    v_readfirstlane_b32 s28, v2
    v_lshrrev_b32 v4, 4, v1
    v_bfe_u32 v5, v1, 2, 2
    v_and_b32 v6, 3, v1
    s_and_b32 s34, s2, 7
    s_lshr_b32 s35, s2, 3
    s_and_b32 s37, s34, 1
    s_lshl_b32 s37, s37, 2
    s_and_b32 s3, s35, 3
    s_add_u32 s37, s37, s3
    s_lshr_b32 s38, s34, 1
    s_lshl_b32 s38, s38, 2
    s_bfe_u32 s31, s35, 0x20002
    s_add_u32 s38, s38, s31
    s_add_u32 s31, s31, s3
    s_and_b32 s29, s28, 3
    s_lshl_b32 s29, s29, 10
    s_mov_b32 s30, 0
    s_cmp_ge_u32 s35, 16
    s_waitcnt lgkmcnt(0)
    s_mov_b32 s52, s22
    s_mov_b32 s53, s23
    s_mov_b32 s54, 256
    s_mov_b32 s55, 0x20000
    s_cbranch_scc1 L1_g1
    s_mov_b32 s8, s4
    s_mov_b32 s9, s5
    s_mov_b32 s10, 4194304
    s_mov_b32 s11, 0x20000
    s_mov_b32 s12, s6
    s_mov_b32 s13, s7
    s_mov_b32 s14, 6291456
    s_mov_b32 s15, 0x20000
    s_mov_b32 s24, s20
    s_mov_b32 s25, s21
    s_mov_b32 s26, 65536
    s_mov_b32 s27, 0x20000
    s_mov_b32 s16, s44
    s_mov_b32 s17, s45
    s_mov_b32 s18, 268435456
    s_mov_b32 s19, 0x20000
    v_lshrrev_b32 v2, 2, v1
    v_lshlrev_b32 v2, 11, v2
    v_lshl_add_u32 v2, v6, 4, v2
    v_and_b32 v3, 32, v1
    v_xor_b32 v2, v3, v2
    s_lshl_b32 s34, s37, 19
    s_lshl_b32 s35, s28, 15
    s_add_u32 s34, s34, s35
    s_add_u32 s35, s34, 0
    v_add_u32 v8, s35, v2
    s_add_u32 s35, s34, 131072
    v_add_u32 v9, s35, v2
    s_add_u32 s35, s34, 262144
    v_add_u32 v10, s35, v2
    s_add_u32 s35, s34, 393216
    v_add_u32 v11, s35, v2
    v_bfe_u32 v2, v1, 2, 3
    v_mul_u32_u24 v2, 6144, v2
    v_lshrrev_b32 v3, 5, v1
    v_lshl_add_u32 v2, v3, 6, v2
    v_lshl_add_u32 v2, v6, 4, v2
    s_and_b32 s34, s28, 1
    s_lshl_b32 s34, s34, 5
    v_xor_b32 v2, s34, v2
    s_mul_i32 s34, s28, 49152
    s_lshl_b32 s35, s38, 7
    s_add_u32 s34, s34, s35
    s_add_u32 s35, s34, 0
    v_add_u32 v12, s35, v2
    s_add_u32 s35, s34, 2048
    v_add_u32 v13, s35, v2
    s_add_u32 s35, s34, 4096
    v_add_u32 v14, s35, v2
    s_cmp_ge_u32 s28, 4
    s_cbranch_scc1 L1q_nold0
    v_lshlrev_b32 v2, 4, v1
    s_lshl_b32 s34, s38, 12
    s_add_u32 s34, s34, s29
    s_add_u32 m0, s29, 114688
    s_nop 0
    buffer_load_dwordx4 v2, s[24:27], s34 offen lds
    s_add_u32 s34, s30, s31
    s_and_b32 s34, s34, 3
    s_andn2_b32 s35, s30, 3
    s_or_b32 s34, s34, s35
    s_mul_i32 s32, s34, 64
    s_mul_i32 s33, s34, 196608
    s_add_u32 s30, s30, 1
    s_add_u32 m0, s29, 0
    s_nop 0
    buffer_load_dwordx4 v8, s[8:11], s32 offen  lds
    s_add_u32 m0, s29, 4096
    s_nop 0
    buffer_load_dwordx4 v9, s[8:11], s32 offen  lds
    s_add_u32 m0, s29, 8192
    s_nop 0
    buffer_load_dwordx4 v10, s[8:11], s32 offen  lds
    s_add_u32 m0, s29, 12288
    s_nop 0
    buffer_load_dwordx4 v11, s[8:11], s32 offen  lds
    s_add_u32 m0, s29, 16384
    s_nop 0
    buffer_load_dwordx4 v12, s[12:15], s33 offen lds
    s_add_u32 m0, s29, 20480
    s_nop 0
    buffer_load_dwordx4 v13, s[12:15], s33 offen lds
    s_add_u32 m0, s29, 24576
    s_nop 0
    buffer_load_dwordx4 v14, s[12:15], s33 offen lds
    s_add_u32 s34, s30, s31
    s_and_b32 s34, s34, 3
    s_andn2_b32 s35, s30, 3
    s_or_b32 s34, s34, s35
    s_mul_i32 s32, s34, 64
    s_mul_i32 s33, s34, 196608
    s_add_u32 s30, s30, 1
    s_add_u32 m0, s29, 28672
    s_nop 0
    buffer_load_dwordx4 v8, s[8:11], s32 offen  lds
    s_add_u32 m0, s29, 32768
    s_nop 0
    buffer_load_dwordx4 v9, s[8:11], s32 offen  lds
    s_add_u32 m0, s29, 36864
    s_nop 0
    buffer_load_dwordx4 v10, s[8:11], s32 offen  lds
    s_add_u32 m0, s29, 40960
    s_nop 0
    buffer_load_dwordx4 v11, s[8:11], s32 offen  lds
    s_add_u32 m0, s29, 45056
    s_nop 0
    buffer_load_dwordx4 v12, s[12:15], s33 offen lds
    s_add_u32 m0, s29, 49152
    s_nop 0
    buffer_load_dwordx4 v13, s[12:15], s33 offen lds
    s_add_u32 m0, s29, 53248
    s_nop 0
    buffer_load_dwordx4 v14, s[12:15], s33 offen lds
    s_add_u32 s34, s30, s31
    s_and_b32 s34, s34, 3
    s_andn2_b32 s35, s30, 3
    s_or_b32 s34, s34, s35
    s_mul_i32 s32, s34, 64
    s_mul_i32 s33, s34, 196608
    s_add_u32 s30, s30, 1
    s_add_u32 m0, s29, 57344
    s_nop 0
    buffer_load_dwordx4 v8, s[8:11], s32 offen  lds
    s_add_u32 m0, s29, 61440
    s_nop 0
    buffer_load_dwordx4 v9, s[8:11], s32 offen  lds
    s_add_u32 m0, s29, 65536
    s_nop 0
    buffer_load_dwordx4 v10, s[8:11], s32 offen  lds
    s_add_u32 m0, s29, 69632
    s_nop 0
    buffer_load_dwordx4 v11, s[8:11], s32 offen  lds
    s_add_u32 m0, s29, 73728
    s_nop 0
    buffer_load_dwordx4 v12, s[12:15], s33 offen lds
    s_add_u32 m0, s29, 77824
    s_nop 0
    buffer_load_dwordx4 v13, s[12:15], s33 offen lds
    s_add_u32 m0, s29, 81920
    s_nop 0
    buffer_load_dwordx4 v14, s[12:15], s33 offen lds
    s_add_u32 s34, s30, s31
    s_and_b32 s34, s34, 3
    s_andn2_b32 s35, s30, 3
    s_or_b32 s34, s34, s35
    s_mul_i32 s32, s34, 64
    s_mul_i32 s33, s34, 196608
    s_add_u32 s30, s30, 1
    s_add_u32 m0, s29, 86016
    s_nop 0
    buffer_load_dwordx4 v8, s[8:11], s32 offen  lds
    s_add_u32 m0, s29, 90112
    s_nop 0
    buffer_load_dwordx4 v9, s[8:11], s32 offen  lds
    s_add_u32 m0, s29, 94208
    s_nop 0
    buffer_load_dwordx4 v10, s[8:11], s32 offen  lds
    s_add_u32 m0, s29, 98304
    s_nop 0
    buffer_load_dwordx4 v11, s[8:11], s32 offen  lds
    s_add_u32 m0, s29, 102400
    s_nop 0
    buffer_load_dwordx4 v12, s[12:15], s33 offen lds
    s_add_u32 m0, s29, 106496
    s_nop 0
    buffer_load_dwordx4 v13, s[12:15], s33 offen lds
    s_add_u32 m0, s29, 110592
    s_nop 0
    buffer_load_dwordx4 v14, s[12:15], s33 offen lds
L1q_nold0:
    s_bfe_u32 s40, s2, 0x10001
    s_lshl_b32 s40, s40, 2
    s_and_b32 s34, s37, 3
    s_add_u32 s40, s40, s34
    s_bfe_u32 s41, s2, 0x10002
    s_lshl_b32 s41, s41, 2
    s_and_b32 s34, s38, 3
    s_add_u32 s41, s41, s34
    s_and_b32 s32, s2, 1
    s_mul_i32 s34, s32, 32
    s_mul_i32 s35, s32, 24
    s_add_u32 s35, s35, 64
    s_add_u32 s33, s32, 2
    s_bitcmp1_b32 s2, 7
    s_cselect_b32 s42, s32, s33
    s_cselect_b32 s43, s34, s35
    v_lshlrev_b32 v2, 4, v1
    s_bfe_u32 s34, s28, 0x10001
    s_lshl_b32 s34, s34, 14
    s_and_b32 s35, s28, 1
    s_lshl_b32 s35, s35, 10
    s_add_u32 s34, s34, s35
    s_lshl_b32 s35, s40, 11
    s_add_u32 s34, s34, s35
    v_add_u32 v244, s34, v2
    s_lshl_b32 s34, s41, 12
    s_add_u32 s34, s34, s29
    v_add_u32 v245, s34, v2
    v_lshrrev_b32 v3, 5, v1
    v_lshlrev_b32 v3, 6, v3
    v_lshl_add_u32 v3, v6, 4, v3
    v_and_b32 v2, 16, v1
    v_lshlrev_b32 v2, 1, v2
    v_xor_b32 v3, v2, v3
    v_bfe_u32 v2, v1, 2, 3
    v_lshl_add_u32 v246, v2, 12, v3
    s_mul_i32 s34, s29, 32
    s_lshl_b32 s35, s41, 9
    s_add_u32 s34, s34, s35
    v_add_u32 v246, s34, v246
    v_lshl_add_u32 v247, v2, 11, v3
    s_mul_i32 s34, s29, 16
    s_lshl_b32 s35, s40, 8
    s_add_u32 s34, s34, s35
    v_add_u32 v247, s34, v247
    s_lshr_b32 s32, s28, 2
    v_and_b32 v252, 15, v1
    v_lshlrev_b32 v2, 4, v252
    v_lshl_add_u32 v248, v4, 11, v2
    v_lshl_add_u32 v248, s32, 10, v248
    v_lshl_add_u32 v249, v4, 12, v2
    v_add_u32 v249, s29, v249
    v_lshrrev_b32 v2, 1, v4
    v_lshlrev_b32 v2, 10, v2
    v_and_b32 v3, 1, v4
    v_mul_u32_u24 v3, 288, v3
    v_add_u32 v2, v3, v2
    v_lshl_add_u32 v2, v5, 6, v2
    v_lshl_add_u32 v2, v6, 3, v2
    v_lshl_add_u32 v250, s29, 2, v2
    v_add_u32 v250, 8192, v250
    v_lshl_add_u32 v251, s32, 12, v2
    v_add_u32 v251, 16384, v251
    s_lshl_b32 s34, s41, 8
    s_lshr_b32 s35, s29, 4
    s_add_u32 s34, s34, s35
    v_add_u32 v252, s34, v252
    s_lshl_b32 s46, s40, 7
    s_add_u32 s46, s46, 41951232
    s_lshl_b32 s47, s41, 7
    s_add_u32 s47, s47, 41955328
    s_lshl_b32 s48, s37, 7
    s_lshl_b32 s34, s38, 2
    s_add_u32 s48, s48, s34
    s_bitcmp1_b32 s2, 7
    s_cselect_b32 s47, s46, s47
    s_cselect_b32 s34, 0, 4096
    s_add_u32 s48, s48, s34
    s_add_u32 s48, s48, 41951232
    v_and_b32 v2, 15, v1
    v_lshlrev_b32 v2, 6, v2
    v_lshl_add_u32 v2, v4, 4, v2
    v_and_b32 v3, 8, v1
    v_lshlrev_b32 v3, 2, v3
    v_xor_b32 v2, v3, v2
    s_lshr_b32 s34, s28, 1
    s_lshl_b32 s34, s34, 12
    v_add_u32 v16, s34, v2
    v_add_u32 v17, 57344, v16
    v_lshlrev_b32 v2, 10, v4
    v_lshl_add_u32 v2, v5, 6, v2
    v_and_b32 v3, 1, v4
    v_lshl_add_u32 v2, v3, 5, v2
    v_lshl_add_u32 v2, v6, 3, v2
    s_and_b32 s34, s28, 1
    s_lshl_b32 s34, s34, 9
    s_add_u32 s34, s34, 16384
    v_add_u32 v18, s34, v2
    v_add_u32 v19, 57344, v18
    v_xor_b32 v20, 32, v18
    v_xor_b32 v21, 32, v19
    v_mov_b32 v104, 0
    v_mov_b32 v105, 0
    v_mov_b32 v106, 0
    v_mov_b32 v107, 0
    v_mov_b32 v108, 0
    v_mov_b32 v109, 0
    v_mov_b32 v110, 0
    v_mov_b32 v111, 0
    v_mov_b32 v112, 0
    v_mov_b32 v113, 0
    v_mov_b32 v114, 0
    v_mov_b32 v115, 0
    v_mov_b32 v116, 0
    v_mov_b32 v117, 0
    v_mov_b32 v118, 0
    v_mov_b32 v119, 0
    v_mov_b32 v120, 0
    v_mov_b32 v121, 0
    v_mov_b32 v122, 0
    v_mov_b32 v123, 0
    v_mov_b32 v124, 0
    v_mov_b32 v125, 0
    v_mov_b32 v126, 0
    v_mov_b32 v127, 0
    v_mov_b32 v128, 0
    v_mov_b32 v129, 0
    v_mov_b32 v130, 0
    v_mov_b32 v131, 0
    v_mov_b32 v132, 0
    v_mov_b32 v133, 0
    v_mov_b32 v134, 0
    v_mov_b32 v135, 0
    v_mov_b32 v136, 0
    v_mov_b32 v137, 0
    v_mov_b32 v138, 0
    v_mov_b32 v139, 0
    v_mov_b32 v140, 0
    v_mov_b32 v141, 0
    v_mov_b32 v142, 0
    v_mov_b32 v143, 0
    v_mov_b32 v144, 0
    v_mov_b32 v145, 0
    v_mov_b32 v146, 0
    v_mov_b32 v147, 0
    v_mov_b32 v148, 0
    v_mov_b32 v149, 0
    v_mov_b32 v150, 0
    v_mov_b32 v151, 0
    v_mov_b32 v152, 0
    v_mov_b32 v153, 0
    v_mov_b32 v154, 0
    v_mov_b32 v155, 0
    v_mov_b32 v156, 0
    v_mov_b32 v157, 0
    v_mov_b32 v158, 0
    v_mov_b32 v159, 0
    v_mov_b32 v160, 0
    v_mov_b32 v161, 0
    v_mov_b32 v162, 0
    v_mov_b32 v163, 0
    v_mov_b32 v164, 0
    v_mov_b32 v165, 0
    v_mov_b32 v166, 0
    v_mov_b32 v167, 0
    v_mov_b32 v168, 0
    v_mov_b32 v169, 0
    v_mov_b32 v170, 0
    v_mov_b32 v171, 0
    v_mov_b32 v172, 0
    v_mov_b32 v173, 0
    v_mov_b32 v174, 0
    v_mov_b32 v175, 0
    v_mov_b32 v176, 0
    v_mov_b32 v177, 0
    v_mov_b32 v178, 0
    v_mov_b32 v179, 0
    v_mov_b32 v180, 0
    v_mov_b32 v181, 0
    v_mov_b32 v182, 0
    v_mov_b32 v183, 0
    v_mov_b32 v184, 0
    v_mov_b32 v185, 0
    v_mov_b32 v186, 0
    v_mov_b32 v187, 0
    v_mov_b32 v188, 0
    v_mov_b32 v189, 0
    v_mov_b32 v190, 0
    v_mov_b32 v191, 0
    v_mov_b32 v192, 0
    v_mov_b32 v193, 0
    v_mov_b32 v194, 0
    v_mov_b32 v195, 0
    v_mov_b32 v196, 0
    v_mov_b32 v197, 0
    v_mov_b32 v198, 0
    v_mov_b32 v199, 0
    s_cmp_ge_u32 s28, 4
    s_cbranch_scc1 L1q_nold
    s_waitcnt vmcnt(21)
    s_barrier
    ds_read_b128 v[24:27], v16 offset:0
    ds_read_b64_tr_b16 v[40:41], v18 offset:0
    ds_read_b64_tr_b16 v[42:43], v18 offset:256
    ds_read_b128 v[28:31], v16 offset:1024
    ds_read_b64_tr_b16 v[44:45], v20 offset:0
    ds_read_b64_tr_b16 v[46:47], v20 offset:256
    ds_read_b128 v[32:35], v16 offset:2048
    ds_read_b64_tr_b16 v[48:49], v18 offset:4096
    ds_read_b64_tr_b16 v[50:51], v18 offset:4352
    ds_read_b128 v[36:39], v16 offset:3072
    ds_read_b64_tr_b16 v[52:53], v20 offset:4096
    ds_read_b64_tr_b16 v[54:55], v20 offset:4352
    ds_read_b64_tr_b16 v[56:57], v18 offset:8192
    ds_read_b64_tr_b16 v[58:59], v18 offset:8448
    ds_read_b64_tr_b16 v[60:61], v20 offset:8192
    ds_read_b64_tr_b16 v[62:63], v20 offset:8448
    s_mov_b32 s36, 7
L_q_430:
    s_waitcnt vmcnt(14) lgkmcnt(0)
    s_barrier
    v_mfma_f32_16x16x32_bf16 v[104:107], v[40:43], v[24:27], v[104:107]
    ds_read_b128 v[64:67], v16 offset:28672
    s_add_u32 s34, s30, s31
    s_and_b32 s34, s34, 3
    s_andn2_b32 s35, s30, 3
    s_or_b32 s34, s34, s35
    s_mul_i32 s32, s34, 64
    s_mul_i32 s33, s34, 196608
    s_add_u32 s30, s30, 1
    s_add_u32 m0, s29, 0
    s_nop 0
    buffer_load_dwordx4 v8, s[8:11], s32 offen  lds
    v_mfma_f32_16x16x32_bf16 v[108:111], v[44:47], v[24:27], v[108:111]
    ds_read_b64_tr_b16 v[80:81], v18 offset:28672
    v_mfma_f32_16x16x32_bf16 v[112:115], v[48:51], v[24:27], v[112:115]
    ds_read_b64_tr_b16 v[82:83], v18 offset:28928
    v_mfma_f32_16x16x32_bf16 v[116:119], v[52:55], v[24:27], v[116:119]
    ds_read_b128 v[68:71], v16 offset:29696
    s_add_u32 m0, s29, 4096
    s_nop 0
    buffer_load_dwordx4 v9, s[8:11], s32 offen  lds
    v_mfma_f32_16x16x32_bf16 v[120:123], v[24:27], v[56:59], v[120:123]
    ds_read_b64_tr_b16 v[84:85], v20 offset:28672
    v_mfma_f32_16x16x32_bf16 v[124:127], v[24:27], v[60:63], v[124:127]
    ds_read_b64_tr_b16 v[86:87], v20 offset:28928
    v_mfma_f32_16x16x32_bf16 v[128:131], v[40:43], v[28:31], v[128:131]
    ds_read_b128 v[72:75], v16 offset:30720
    s_add_u32 m0, s29, 8192
    s_nop 0
    buffer_load_dwordx4 v10, s[8:11], s32 offen  lds
    v_mfma_f32_16x16x32_bf16 v[132:135], v[44:47], v[28:31], v[132:135]
    ds_read_b64_tr_b16 v[88:89], v18 offset:32768
    v_mfma_f32_16x16x32_bf16 v[136:139], v[48:51], v[28:31], v[136:139]
    ds_read_b64_tr_b16 v[90:91], v18 offset:33024
    v_mfma_f32_16x16x32_bf16 v[140:143], v[52:55], v[28:31], v[140:143]
    ds_read_b128 v[76:79], v16 offset:31744
    v_mfma_f32_16x16x32_bf16 v[144:147], v[28:31], v[56:59], v[144:147]
    ds_read_b64_tr_b16 v[92:93], v20 offset:32768
    s_add_u32 m0, s29, 12288
    s_nop 0
    buffer_load_dwordx4 v11, s[8:11], s32 offen  lds
    v_mfma_f32_16x16x32_bf16 v[148:151], v[28:31], v[60:63], v[148:151]
    ds_read_b64_tr_b16 v[94:95], v20 offset:33024
    v_mfma_f32_16x16x32_bf16 v[152:155], v[40:43], v[32:35], v[152:155]
    ds_read_b64_tr_b16 v[96:97], v18 offset:36864
    v_mfma_f32_16x16x32_bf16 v[156:159], v[44:47], v[32:35], v[156:159]
    ds_read_b64_tr_b16 v[98:99], v18 offset:37120
    s_add_u32 m0, s29, 16384
    s_nop 0
    buffer_load_dwordx4 v12, s[12:15], s33 offen lds
    v_mfma_f32_16x16x32_bf16 v[160:163], v[48:51], v[32:35], v[160:163]
    ds_read_b64_tr_b16 v[100:101], v20 offset:36864
    v_mfma_f32_16x16x32_bf16 v[164:167], v[52:55], v[32:35], v[164:167]
    ds_read_b64_tr_b16 v[102:103], v20 offset:37120
    v_mfma_f32_16x16x32_bf16 v[168:171], v[32:35], v[56:59], v[168:171]
    v_mfma_f32_16x16x32_bf16 v[172:175], v[32:35], v[60:63], v[172:175]
    s_add_u32 m0, s29, 20480
    s_nop 0
    buffer_load_dwordx4 v13, s[12:15], s33 offen lds
    v_mfma_f32_16x16x32_bf16 v[176:179], v[40:43], v[36:39], v[176:179]
    v_mfma_f32_16x16x32_bf16 v[180:183], v[44:47], v[36:39], v[180:183]
    v_mfma_f32_16x16x32_bf16 v[184:187], v[48:51], v[36:39], v[184:187]
    s_add_u32 m0, s29, 24576
    s_nop 0
    buffer_load_dwordx4 v14, s[12:15], s33 offen lds
    v_mfma_f32_16x16x32_bf16 v[188:191], v[52:55], v[36:39], v[188:191]
    v_mfma_f32_16x16x32_bf16 v[192:195], v[36:39], v[56:59], v[192:195]
    v_mfma_f32_16x16x32_bf16 v[196:199], v[36:39], v[60:63], v[196:199]
    s_waitcnt vmcnt(14) lgkmcnt(0)
    s_barrier
    v_mfma_f32_16x16x32_bf16 v[104:107], v[80:83], v[64:67], v[104:107]
    ds_read_b128 v[24:27], v17 offset:0
    s_add_u32 s34, s30, s31
    s_and_b32 s34, s34, 3
    s_andn2_b32 s35, s30, 3
    s_or_b32 s34, s34, s35
    s_mul_i32 s32, s34, 64
    s_mul_i32 s33, s34, 196608
    s_add_u32 s30, s30, 1
    s_add_u32 m0, s29, 28672
    s_nop 0
    buffer_load_dwordx4 v8, s[8:11], s32 offen  lds
    v_mfma_f32_16x16x32_bf16 v[108:111], v[84:87], v[64:67], v[108:111]
    ds_read_b64_tr_b16 v[40:41], v19 offset:0
    v_mfma_f32_16x16x32_bf16 v[112:115], v[88:91], v[64:67], v[112:115]
    ds_read_b64_tr_b16 v[42:43], v19 offset:256
    v_mfma_f32_16x16x32_bf16 v[116:119], v[92:95], v[64:67], v[116:119]
    ds_read_b128 v[28:31], v17 offset:1024
    s_add_u32 m0, s29, 32768
    s_nop 0
    buffer_load_dwordx4 v9, s[8:11], s32 offen  lds
    v_mfma_f32_16x16x32_bf16 v[120:123], v[64:67], v[96:99], v[120:123]
    ds_read_b64_tr_b16 v[44:45], v21 offset:0
    v_mfma_f32_16x16x32_bf16 v[124:127], v[64:67], v[100:103], v[124:127]
    ds_read_b64_tr_b16 v[46:47], v21 offset:256
    v_mfma_f32_16x16x32_bf16 v[128:131], v[80:83], v[68:71], v[128:131]
    ds_read_b128 v[32:35], v17 offset:2048
    s_add_u32 m0, s29, 36864
    s_nop 0
    buffer_load_dwordx4 v10, s[8:11], s32 offen  lds
    v_mfma_f32_16x16x32_bf16 v[132:135], v[84:87], v[68:71], v[132:135]
    ds_read_b64_tr_b16 v[48:49], v19 offset:4096
    v_mfma_f32_16x16x32_bf16 v[136:139], v[88:91], v[68:71], v[136:139]
    ds_read_b64_tr_b16 v[50:51], v19 offset:4352
    v_mfma_f32_16x16x32_bf16 v[140:143], v[92:95], v[68:71], v[140:143]
    ds_read_b128 v[36:39], v17 offset:3072
    v_mfma_f32_16x16x32_bf16 v[144:147], v[68:71], v[96:99], v[144:147]
    ds_read_b64_tr_b16 v[52:53], v21 offset:4096
    s_add_u32 m0, s29, 40960
    s_nop 0
    buffer_load_dwordx4 v11, s[8:11], s32 offen  lds
    v_mfma_f32_16x16x32_bf16 v[148:151], v[68:71], v[100:103], v[148:151]
    ds_read_b64_tr_b16 v[54:55], v21 offset:4352
    v_mfma_f32_16x16x32_bf16 v[152:155], v[80:83], v[72:75], v[152:155]
    ds_read_b64_tr_b16 v[56:57], v19 offset:8192
    v_mfma_f32_16x16x32_bf16 v[156:159], v[84:87], v[72:75], v[156:159]
    ds_read_b64_tr_b16 v[58:59], v19 offset:8448
    s_add_u32 m0, s29, 45056
    s_nop 0
    buffer_load_dwordx4 v12, s[12:15], s33 offen lds
    v_mfma_f32_16x16x32_bf16 v[160:163], v[88:91], v[72:75], v[160:163]
    ds_read_b64_tr_b16 v[60:61], v21 offset:8192
    v_mfma_f32_16x16x32_bf16 v[164:167], v[92:95], v[72:75], v[164:167]
    ds_read_b64_tr_b16 v[62:63], v21 offset:8448
    v_mfma_f32_16x16x32_bf16 v[168:171], v[72:75], v[96:99], v[168:171]
    v_mfma_f32_16x16x32_bf16 v[172:175], v[72:75], v[100:103], v[172:175]
    s_add_u32 m0, s29, 49152
    s_nop 0
    buffer_load_dwordx4 v13, s[12:15], s33 offen lds
    v_mfma_f32_16x16x32_bf16 v[176:179], v[80:83], v[76:79], v[176:179]
    v_mfma_f32_16x16x32_bf16 v[180:183], v[84:87], v[76:79], v[180:183]
    v_mfma_f32_16x16x32_bf16 v[184:187], v[88:91], v[76:79], v[184:187]
    s_add_u32 m0, s29, 53248
    s_nop 0
    buffer_load_dwordx4 v14, s[12:15], s33 offen lds
    v_mfma_f32_16x16x32_bf16 v[188:191], v[92:95], v[76:79], v[188:191]
    v_mfma_f32_16x16x32_bf16 v[192:195], v[76:79], v[96:99], v[192:195]
    v_mfma_f32_16x16x32_bf16 v[196:199], v[76:79], v[100:103], v[196:199]
    s_waitcnt vmcnt(14) lgkmcnt(0)
    s_barrier
    v_mfma_f32_16x16x32_bf16 v[104:107], v[40:43], v[24:27], v[104:107]
    ds_read_b128 v[64:67], v17 offset:28672
    s_add_u32 s34, s30, s31
    s_and_b32 s34, s34, 3
    s_andn2_b32 s35, s30, 3
    s_or_b32 s34, s34, s35
    s_mul_i32 s32, s34, 64
    s_mul_i32 s33, s34, 196608
    s_add_u32 s30, s30, 1
    s_add_u32 m0, s29, 57344
    s_nop 0
    buffer_load_dwordx4 v8, s[8:11], s32 offen  lds
    v_mfma_f32_16x16x32_bf16 v[108:111], v[44:47], v[24:27], v[108:111]
    ds_read_b64_tr_b16 v[80:81], v19 offset:28672
    v_mfma_f32_16x16x32_bf16 v[112:115], v[48:51], v[24:27], v[112:115]
    ds_read_b64_tr_b16 v[82:83], v19 offset:28928
    v_mfma_f32_16x16x32_bf16 v[116:119], v[52:55], v[24:27], v[116:119]
    ds_read_b128 v[68:71], v17 offset:29696
    s_add_u32 m0, s29, 61440
    s_nop 0
    buffer_load_dwordx4 v9, s[8:11], s32 offen  lds
    v_mfma_f32_16x16x32_bf16 v[120:123], v[24:27], v[56:59], v[120:123]
    ds_read_b64_tr_b16 v[84:85], v21 offset:28672
    v_mfma_f32_16x16x32_bf16 v[124:127], v[24:27], v[60:63], v[124:127]
    ds_read_b64_tr_b16 v[86:87], v21 offset:28928
    v_mfma_f32_16x16x32_bf16 v[128:131], v[40:43], v[28:31], v[128:131]
    ds_read_b128 v[72:75], v17 offset:30720
    s_add_u32 m0, s29, 65536
    s_nop 0
    buffer_load_dwordx4 v10, s[8:11], s32 offen  lds
    v_mfma_f32_16x16x32_bf16 v[132:135], v[44:47], v[28:31], v[132:135]
    ds_read_b64_tr_b16 v[88:89], v19 offset:32768
    v_mfma_f32_16x16x32_bf16 v[136:139], v[48:51], v[28:31], v[136:139]
    ds_read_b64_tr_b16 v[90:91], v19 offset:33024
    v_mfma_f32_16x16x32_bf16 v[140:143], v[52:55], v[28:31], v[140:143]
    ds_read_b128 v[76:79], v17 offset:31744
    v_mfma_f32_16x16x32_bf16 v[144:147], v[28:31], v[56:59], v[144:147]
    ds_read_b64_tr_b16 v[92:93], v21 offset:32768
    s_add_u32 m0, s29, 69632
    s_nop 0
    buffer_load_dwordx4 v11, s[8:11], s32 offen  lds
    v_mfma_f32_16x16x32_bf16 v[148:151], v[28:31], v[60:63], v[148:151]
    ds_read_b64_tr_b16 v[94:95], v21 offset:33024
    v_mfma_f32_16x16x32_bf16 v[152:155], v[40:43], v[32:35], v[152:155]
    ds_read_b64_tr_b16 v[96:97], v19 offset:36864
    v_mfma_f32_16x16x32_bf16 v[156:159], v[44:47], v[32:35], v[156:159]
    ds_read_b64_tr_b16 v[98:99], v19 offset:37120
    s_add_u32 m0, s29, 73728
    s_nop 0
    buffer_load_dwordx4 v12, s[12:15], s33 offen lds
    v_mfma_f32_16x16x32_bf16 v[160:163], v[48:51], v[32:35], v[160:163]
    ds_read_b64_tr_b16 v[100:101], v21 offset:36864
    v_mfma_f32_16x16x32_bf16 v[164:167], v[52:55], v[32:35], v[164:167]
    ds_read_b64_tr_b16 v[102:103], v21 offset:37120
    v_mfma_f32_16x16x32_bf16 v[168:171], v[32:35], v[56:59], v[168:171]
    v_mfma_f32_16x16x32_bf16 v[172:175], v[32:35], v[60:63], v[172:175]
    s_add_u32 m0, s29, 77824
    s_nop 0
    buffer_load_dwordx4 v13, s[12:15], s33 offen lds
    v_mfma_f32_16x16x32_bf16 v[176:179], v[40:43], v[36:39], v[176:179]
    v_mfma_f32_16x16x32_bf16 v[180:183], v[44:47], v[36:39], v[180:183]
    v_mfma_f32_16x16x32_bf16 v[184:187], v[48:51], v[36:39], v[184:187]
    s_add_u32 m0, s29, 81920
    s_nop 0
    buffer_load_dwordx4 v14, s[12:15], s33 offen lds
    v_mfma_f32_16x16x32_bf16 v[188:191], v[52:55], v[36:39], v[188:191]
    v_mfma_f32_16x16x32_bf16 v[192:195], v[36:39], v[56:59], v[192:195]
    v_mfma_f32_16x16x32_bf16 v[196:199], v[36:39], v[60:63], v[196:199]
    s_waitcnt vmcnt(14) lgkmcnt(0)
    s_barrier
    v_mfma_f32_16x16x32_bf16 v[104:107], v[80:83], v[64:67], v[104:107]
    ds_read_b128 v[24:27], v16 offset:0
    s_add_u32 s34, s30, s31
    s_and_b32 s34, s34, 3
    s_andn2_b32 s35, s30, 3
    s_or_b32 s34, s34, s35
    s_mul_i32 s32, s34, 64
    s_mul_i32 s33, s34, 196608
    s_add_u32 s30, s30, 1
    s_add_u32 m0, s29, 86016
    s_nop 0
    buffer_load_dwordx4 v8, s[8:11], s32 offen  lds
    v_mfma_f32_16x16x32_bf16 v[108:111], v[84:87], v[64:67], v[108:111]
    ds_read_b64_tr_b16 v[40:41], v18 offset:0
    v_mfma_f32_16x16x32_bf16 v[112:115], v[88:91], v[64:67], v[112:115]
    ds_read_b64_tr_b16 v[42:43], v18 offset:256
    v_mfma_f32_16x16x32_bf16 v[116:119], v[92:95], v[64:67], v[116:119]
    ds_read_b128 v[28:31], v16 offset:1024
    s_add_u32 m0, s29, 90112
    s_nop 0
    buffer_load_dwordx4 v9, s[8:11], s32 offen  lds
    v_mfma_f32_16x16x32_bf16 v[120:123], v[64:67], v[96:99], v[120:123]
    ds_read_b64_tr_b16 v[44:45], v20 offset:0
    v_mfma_f32_16x16x32_bf16 v[124:127], v[64:67], v[100:103], v[124:127]
    ds_read_b64_tr_b16 v[46:47], v20 offset:256
    v_mfma_f32_16x16x32_bf16 v[128:131], v[80:83], v[68:71], v[128:131]
    ds_read_b128 v[32:35], v16 offset:2048
    s_add_u32 m0, s29, 94208
    s_nop 0
    buffer_load_dwordx4 v10, s[8:11], s32 offen  lds
    v_mfma_f32_16x16x32_bf16 v[132:135], v[84:87], v[68:71], v[132:135]
    ds_read_b64_tr_b16 v[48:49], v18 offset:4096
    v_mfma_f32_16x16x32_bf16 v[136:139], v[88:91], v[68:71], v[136:139]
    ds_read_b64_tr_b16 v[50:51], v18 offset:4352
    v_mfma_f32_16x16x32_bf16 v[140:143], v[92:95], v[68:71], v[140:143]
    ds_read_b128 v[36:39], v16 offset:3072
    v_mfma_f32_16x16x32_bf16 v[144:147], v[68:71], v[96:99], v[144:147]
    ds_read_b64_tr_b16 v[52:53], v20 offset:4096
    s_add_u32 m0, s29, 98304
    s_nop 0
    buffer_load_dwordx4 v11, s[8:11], s32 offen  lds
    v_mfma_f32_16x16x32_bf16 v[148:151], v[68:71], v[100:103], v[148:151]
    ds_read_b64_tr_b16 v[54:55], v20 offset:4352
    v_mfma_f32_16x16x32_bf16 v[152:155], v[80:83], v[72:75], v[152:155]
    ds_read_b64_tr_b16 v[56:57], v18 offset:8192
    v_mfma_f32_16x16x32_bf16 v[156:159], v[84:87], v[72:75], v[156:159]
    ds_read_b64_tr_b16 v[58:59], v18 offset:8448
    s_add_u32 m0, s29, 102400
    s_nop 0
    buffer_load_dwordx4 v12, s[12:15], s33 offen lds
    v_mfma_f32_16x16x32_bf16 v[160:163], v[88:91], v[72:75], v[160:163]
    ds_read_b64_tr_b16 v[60:61], v20 offset:8192
    v_mfma_f32_16x16x32_bf16 v[164:167], v[92:95], v[72:75], v[164:167]
    ds_read_b64_tr_b16 v[62:63], v20 offset:8448
    v_mfma_f32_16x16x32_bf16 v[168:171], v[72:75], v[96:99], v[168:171]
    v_mfma_f32_16x16x32_bf16 v[172:175], v[72:75], v[100:103], v[172:175]
    s_add_u32 m0, s29, 106496
    s_nop 0
    buffer_load_dwordx4 v13, s[12:15], s33 offen lds
    v_mfma_f32_16x16x32_bf16 v[176:179], v[80:83], v[76:79], v[176:179]
    v_mfma_f32_16x16x32_bf16 v[180:183], v[84:87], v[76:79], v[180:183]
    v_mfma_f32_16x16x32_bf16 v[184:187], v[88:91], v[76:79], v[184:187]
    s_add_u32 m0, s29, 110592
    s_nop 0
    buffer_load_dwordx4 v14, s[12:15], s33 offen lds
    v_mfma_f32_16x16x32_bf16 v[188:191], v[92:95], v[76:79], v[188:191]
    v_mfma_f32_16x16x32_bf16 v[192:195], v[76:79], v[96:99], v[192:195]
    v_mfma_f32_16x16x32_bf16 v[196:199], v[76:79], v[100:103], v[196:199]
    s_sub_u32 s36, s36, 1
    s_cmp_lg_u32 s36, 0
    s_cbranch_scc1 L_q_430
    s_waitcnt vmcnt(14) lgkmcnt(0)
    s_barrier
    v_mfma_f32_16x16x32_bf16 v[104:107], v[40:43], v[24:27], v[104:107]
    ds_read_b128 v[64:67], v16 offset:28672
    v_mfma_f32_16x16x32_bf16 v[108:111], v[44:47], v[24:27], v[108:111]
    ds_read_b64_tr_b16 v[80:81], v18 offset:28672
    v_mfma_f32_16x16x32_bf16 v[112:115], v[48:51], v[24:27], v[112:115]
    ds_read_b64_tr_b16 v[82:83], v18 offset:28928
    v_mfma_f32_16x16x32_bf16 v[116:119], v[52:55], v[24:27], v[116:119]
    ds_read_b128 v[68:71], v16 offset:29696
    v_mfma_f32_16x16x32_bf16 v[120:123], v[24:27], v[56:59], v[120:123]
    ds_read_b64_tr_b16 v[84:85], v20 offset:28672
    v_mfma_f32_16x16x32_bf16 v[124:127], v[24:27], v[60:63], v[124:127]
    ds_read_b64_tr_b16 v[86:87], v20 offset:28928
    v_mfma_f32_16x16x32_bf16 v[128:131], v[40:43], v[28:31], v[128:131]
    ds_read_b128 v[72:75], v16 offset:30720
    v_mfma_f32_16x16x32_bf16 v[132:135], v[44:47], v[28:31], v[132:135]
    ds_read_b64_tr_b16 v[88:89], v18 offset:32768
    v_mfma_f32_16x16x32_bf16 v[136:139], v[48:51], v[28:31], v[136:139]
    ds_read_b64_tr_b16 v[90:91], v18 offset:33024
    v_mfma_f32_16x16x32_bf16 v[140:143], v[52:55], v[28:31], v[140:143]
    ds_read_b128 v[76:79], v16 offset:31744
    v_mfma_f32_16x16x32_bf16 v[144:147], v[28:31], v[56:59], v[144:147]
    ds_read_b64_tr_b16 v[92:93], v20 offset:32768
    v_mfma_f32_16x16x32_bf16 v[148:151], v[28:31], v[60:63], v[148:151]
    ds_read_b64_tr_b16 v[94:95], v20 offset:33024
    v_mfma_f32_16x16x32_bf16 v[152:155], v[40:43], v[32:35], v[152:155]
    ds_read_b64_tr_b16 v[96:97], v18 offset:36864
    v_mfma_f32_16x16x32_bf16 v[156:159], v[44:47], v[32:35], v[156:159]
    ds_read_b64_tr_b16 v[98:99], v18 offset:37120
    v_mfma_f32_16x16x32_bf16 v[160:163], v[48:51], v[32:35], v[160:163]
    ds_read_b64_tr_b16 v[100:101], v20 offset:36864
    v_mfma_f32_16x16x32_bf16 v[164:167], v[52:55], v[32:35], v[164:167]
    ds_read_b64_tr_b16 v[102:103], v20 offset:37120
    v_mfma_f32_16x16x32_bf16 v[168:171], v[32:35], v[56:59], v[168:171]
    v_mfma_f32_16x16x32_bf16 v[172:175], v[32:35], v[60:63], v[172:175]
    v_mfma_f32_16x16x32_bf16 v[176:179], v[40:43], v[36:39], v[176:179]
    v_mfma_f32_16x16x32_bf16 v[180:183], v[44:47], v[36:39], v[180:183]
    v_mfma_f32_16x16x32_bf16 v[184:187], v[48:51], v[36:39], v[184:187]
    v_mfma_f32_16x16x32_bf16 v[188:191], v[52:55], v[36:39], v[188:191]
    v_mfma_f32_16x16x32_bf16 v[192:195], v[36:39], v[56:59], v[192:195]
    v_mfma_f32_16x16x32_bf16 v[196:199], v[36:39], v[60:63], v[196:199]
    s_waitcnt vmcnt(7) lgkmcnt(0)
    s_barrier
    v_mfma_f32_16x16x32_bf16 v[104:107], v[80:83], v[64:67], v[104:107]
    ds_read_b128 v[24:27], v17 offset:0
    v_mfma_f32_16x16x32_bf16 v[108:111], v[84:87], v[64:67], v[108:111]
    ds_read_b64_tr_b16 v[40:41], v19 offset:0
    v_mfma_f32_16x16x32_bf16 v[112:115], v[88:91], v[64:67], v[112:115]
    ds_read_b64_tr_b16 v[42:43], v19 offset:256
    v_mfma_f32_16x16x32_bf16 v[116:119], v[92:95], v[64:67], v[116:119]
    ds_read_b128 v[28:31], v17 offset:1024
    v_mfma_f32_16x16x32_bf16 v[120:123], v[64:67], v[96:99], v[120:123]
    ds_read_b64_tr_b16 v[44:45], v21 offset:0
    v_mfma_f32_16x16x32_bf16 v[124:127], v[64:67], v[100:103], v[124:127]
    ds_read_b64_tr_b16 v[46:47], v21 offset:256
    v_mfma_f32_16x16x32_bf16 v[128:131], v[80:83], v[68:71], v[128:131]
    ds_read_b128 v[32:35], v17 offset:2048
    v_mfma_f32_16x16x32_bf16 v[132:135], v[84:87], v[68:71], v[132:135]
    ds_read_b64_tr_b16 v[48:49], v19 offset:4096
    v_mfma_f32_16x16x32_bf16 v[136:139], v[88:91], v[68:71], v[136:139]
    ds_read_b64_tr_b16 v[50:51], v19 offset:4352
    v_mfma_f32_16x16x32_bf16 v[140:143], v[92:95], v[68:71], v[140:143]
    ds_read_b128 v[36:39], v17 offset:3072
    v_mfma_f32_16x16x32_bf16 v[144:147], v[68:71], v[96:99], v[144:147]
    ds_read_b64_tr_b16 v[52:53], v21 offset:4096
    v_mfma_f32_16x16x32_bf16 v[148:151], v[68:71], v[100:103], v[148:151]
    ds_read_b64_tr_b16 v[54:55], v21 offset:4352
    v_mfma_f32_16x16x32_bf16 v[152:155], v[80:83], v[72:75], v[152:155]
    ds_read_b64_tr_b16 v[56:57], v19 offset:8192
    v_mfma_f32_16x16x32_bf16 v[156:159], v[84:87], v[72:75], v[156:159]
    ds_read_b64_tr_b16 v[58:59], v19 offset:8448
    v_mfma_f32_16x16x32_bf16 v[160:163], v[88:91], v[72:75], v[160:163]
    ds_read_b64_tr_b16 v[60:61], v21 offset:8192
    v_mfma_f32_16x16x32_bf16 v[164:167], v[92:95], v[72:75], v[164:167]
    ds_read_b64_tr_b16 v[62:63], v21 offset:8448
    v_mfma_f32_16x16x32_bf16 v[168:171], v[72:75], v[96:99], v[168:171]
    v_mfma_f32_16x16x32_bf16 v[172:175], v[72:75], v[100:103], v[172:175]
    v_mfma_f32_16x16x32_bf16 v[176:179], v[80:83], v[76:79], v[176:179]
    v_mfma_f32_16x16x32_bf16 v[180:183], v[84:87], v[76:79], v[180:183]
    v_mfma_f32_16x16x32_bf16 v[184:187], v[88:91], v[76:79], v[184:187]
    v_mfma_f32_16x16x32_bf16 v[188:191], v[92:95], v[76:79], v[188:191]
    v_mfma_f32_16x16x32_bf16 v[192:195], v[76:79], v[96:99], v[192:195]
    v_mfma_f32_16x16x32_bf16 v[196:199], v[76:79], v[100:103], v[196:199]
    s_waitcnt vmcnt(0) lgkmcnt(0)
    s_barrier
    v_mfma_f32_16x16x32_bf16 v[104:107], v[40:43], v[24:27], v[104:107]
    ds_read_b128 v[64:67], v17 offset:28672
    v_mfma_f32_16x16x32_bf16 v[108:111], v[44:47], v[24:27], v[108:111]
    ds_read_b64_tr_b16 v[80:81], v19 offset:28672
    v_mfma_f32_16x16x32_bf16 v[112:115], v[48:51], v[24:27], v[112:115]
    ds_read_b64_tr_b16 v[82:83], v19 offset:28928
    v_mfma_f32_16x16x32_bf16 v[116:119], v[52:55], v[24:27], v[116:119]
    ds_read_b128 v[68:71], v17 offset:29696
    v_mfma_f32_16x16x32_bf16 v[120:123], v[24:27], v[56:59], v[120:123]
    ds_read_b64_tr_b16 v[84:85], v21 offset:28672
    v_mfma_f32_16x16x32_bf16 v[124:127], v[24:27], v[60:63], v[124:127]
    ds_read_b64_tr_b16 v[86:87], v21 offset:28928
    v_mfma_f32_16x16x32_bf16 v[128:131], v[40:43], v[28:31], v[128:131]
    ds_read_b128 v[72:75], v17 offset:30720
    v_mfma_f32_16x16x32_bf16 v[132:135], v[44:47], v[28:31], v[132:135]
    ds_read_b64_tr_b16 v[88:89], v19 offset:32768
    v_mfma_f32_16x16x32_bf16 v[136:139], v[48:51], v[28:31], v[136:139]
    ds_read_b64_tr_b16 v[90:91], v19 offset:33024
    v_mfma_f32_16x16x32_bf16 v[140:143], v[52:55], v[28:31], v[140:143]
    ds_read_b128 v[76:79], v17 offset:31744
    v_mfma_f32_16x16x32_bf16 v[144:147], v[28:31], v[56:59], v[144:147]
    ds_read_b64_tr_b16 v[92:93], v21 offset:32768
    v_mfma_f32_16x16x32_bf16 v[148:151], v[28:31], v[60:63], v[148:151]
    ds_read_b64_tr_b16 v[94:95], v21 offset:33024
    v_mfma_f32_16x16x32_bf16 v[152:155], v[40:43], v[32:35], v[152:155]
    ds_read_b64_tr_b16 v[96:97], v19 offset:36864
    v_mfma_f32_16x16x32_bf16 v[156:159], v[44:47], v[32:35], v[156:159]
    ds_read_b64_tr_b16 v[98:99], v19 offset:37120
    v_mfma_f32_16x16x32_bf16 v[160:163], v[48:51], v[32:35], v[160:163]
    ds_read_b64_tr_b16 v[100:101], v21 offset:36864
    v_mfma_f32_16x16x32_bf16 v[164:167], v[52:55], v[32:35], v[164:167]
    ds_read_b64_tr_b16 v[102:103], v21 offset:37120
    v_mfma_f32_16x16x32_bf16 v[168:171], v[32:35], v[56:59], v[168:171]
    v_mfma_f32_16x16x32_bf16 v[172:175], v[32:35], v[60:63], v[172:175]
    v_mfma_f32_16x16x32_bf16 v[176:179], v[40:43], v[36:39], v[176:179]
    v_mfma_f32_16x16x32_bf16 v[180:183], v[44:47], v[36:39], v[180:183]
    v_mfma_f32_16x16x32_bf16 v[184:187], v[48:51], v[36:39], v[184:187]
    v_mfma_f32_16x16x32_bf16 v[188:191], v[52:55], v[36:39], v[188:191]
    v_mfma_f32_16x16x32_bf16 v[192:195], v[36:39], v[56:59], v[192:195]
    v_mfma_f32_16x16x32_bf16 v[196:199], v[36:39], v[60:63], v[196:199]
    s_waitcnt lgkmcnt(0)
    v_mfma_f32_16x16x32_bf16 v[104:107], v[80:83], v[64:67], v[104:107]
    v_mfma_f32_16x16x32_bf16 v[108:111], v[84:87], v[64:67], v[108:111]
    v_mfma_f32_16x16x32_bf16 v[112:115], v[88:91], v[64:67], v[112:115]
    v_mfma_f32_16x16x32_bf16 v[116:119], v[92:95], v[64:67], v[116:119]
    v_mfma_f32_16x16x32_bf16 v[120:123], v[64:67], v[96:99], v[120:123]
    v_mfma_f32_16x16x32_bf16 v[124:127], v[64:67], v[100:103], v[124:127]
    v_mfma_f32_16x16x32_bf16 v[128:131], v[80:83], v[68:71], v[128:131]
    v_mfma_f32_16x16x32_bf16 v[132:135], v[84:87], v[68:71], v[132:135]
    v_mfma_f32_16x16x32_bf16 v[136:139], v[88:91], v[68:71], v[136:139]
    v_mfma_f32_16x16x32_bf16 v[140:143], v[92:95], v[68:71], v[140:143]
    v_mfma_f32_16x16x32_bf16 v[144:147], v[68:71], v[96:99], v[144:147]
    v_mfma_f32_16x16x32_bf16 v[148:151], v[68:71], v[100:103], v[148:151]
    v_mfma_f32_16x16x32_bf16 v[152:155], v[80:83], v[72:75], v[152:155]
    v_mfma_f32_16x16x32_bf16 v[156:159], v[84:87], v[72:75], v[156:159]
    v_mfma_f32_16x16x32_bf16 v[160:163], v[88:91], v[72:75], v[160:163]
    v_mfma_f32_16x16x32_bf16 v[164:167], v[92:95], v[72:75], v[164:167]
    v_mfma_f32_16x16x32_bf16 v[168:171], v[72:75], v[96:99], v[168:171]
    v_mfma_f32_16x16x32_bf16 v[172:175], v[72:75], v[100:103], v[172:175]
    v_mfma_f32_16x16x32_bf16 v[176:179], v[80:83], v[76:79], v[176:179]
    v_mfma_f32_16x16x32_bf16 v[180:183], v[84:87], v[76:79], v[180:183]
    v_mfma_f32_16x16x32_bf16 v[184:187], v[88:91], v[76:79], v[184:187]
    v_mfma_f32_16x16x32_bf16 v[188:191], v[92:95], v[76:79], v[188:191]
    v_mfma_f32_16x16x32_bf16 v[192:195], v[76:79], v[96:99], v[192:195]
    v_mfma_f32_16x16x32_bf16 v[196:199], v[76:79], v[100:103], v[196:199]
    s_branch L1q_epi
L1q_nold:
    s_barrier
    ds_read_b128 v[24:27], v16 offset:0
    ds_read_b64_tr_b16 v[40:41], v18 offset:0
    ds_read_b64_tr_b16 v[42:43], v18 offset:256
    ds_read_b128 v[28:31], v16 offset:1024
    ds_read_b64_tr_b16 v[44:45], v20 offset:0
    ds_read_b64_tr_b16 v[46:47], v20 offset:256
    ds_read_b128 v[32:35], v16 offset:2048
    ds_read_b64_tr_b16 v[48:49], v18 offset:4096
    ds_read_b64_tr_b16 v[50:51], v18 offset:4352
    ds_read_b128 v[36:39], v16 offset:3072
    ds_read_b64_tr_b16 v[52:53], v20 offset:4096
    ds_read_b64_tr_b16 v[54:55], v20 offset:4352
    ds_read_b64_tr_b16 v[56:57], v18 offset:8192
    ds_read_b64_tr_b16 v[58:59], v18 offset:8448
    ds_read_b64_tr_b16 v[60:61], v20 offset:8192
    ds_read_b64_tr_b16 v[62:63], v20 offset:8448
    s_mov_b32 s36, 7
L_q_885:
    s_waitcnt lgkmcnt(0)
    s_barrier
    v_mfma_f32_16x16x32_bf16 v[104:107], v[40:43], v[24:27], v[104:107]
    ds_read_b128 v[64:67], v16 offset:28672
    v_mfma_f32_16x16x32_bf16 v[108:111], v[44:47], v[24:27], v[108:111]
    ds_read_b64_tr_b16 v[80:81], v18 offset:28672
    v_mfma_f32_16x16x32_bf16 v[112:115], v[48:51], v[24:27], v[112:115]
    ds_read_b64_tr_b16 v[82:83], v18 offset:28928
    v_mfma_f32_16x16x32_bf16 v[116:119], v[52:55], v[24:27], v[116:119]
    ds_read_b128 v[68:71], v16 offset:29696
    v_mfma_f32_16x16x32_bf16 v[120:123], v[24:27], v[56:59], v[120:123]
    ds_read_b64_tr_b16 v[84:85], v20 offset:28672
    v_mfma_f32_16x16x32_bf16 v[124:127], v[24:27], v[60:63], v[124:127]
    ds_read_b64_tr_b16 v[86:87], v20 offset:28928
    v_mfma_f32_16x16x32_bf16 v[128:131], v[40:43], v[28:31], v[128:131]
    ds_read_b128 v[72:75], v16 offset:30720
    v_mfma_f32_16x16x32_bf16 v[132:135], v[44:47], v[28:31], v[132:135]
    ds_read_b64_tr_b16 v[88:89], v18 offset:32768
    v_mfma_f32_16x16x32_bf16 v[136:139], v[48:51], v[28:31], v[136:139]
    ds_read_b64_tr_b16 v[90:91], v18 offset:33024
    v_mfma_f32_16x16x32_bf16 v[140:143], v[52:55], v[28:31], v[140:143]
    ds_read_b128 v[76:79], v16 offset:31744
    v_mfma_f32_16x16x32_bf16 v[144:147], v[28:31], v[56:59], v[144:147]
    ds_read_b64_tr_b16 v[92:93], v20 offset:32768
    v_mfma_f32_16x16x32_bf16 v[148:151], v[28:31], v[60:63], v[148:151]
    ds_read_b64_tr_b16 v[94:95], v20 offset:33024
    v_mfma_f32_16x16x32_bf16 v[152:155], v[40:43], v[32:35], v[152:155]
    ds_read_b64_tr_b16 v[96:97], v18 offset:36864
    v_mfma_f32_16x16x32_bf16 v[156:159], v[44:47], v[32:35], v[156:159]
    ds_read_b64_tr_b16 v[98:99], v18 offset:37120
    v_mfma_f32_16x16x32_bf16 v[160:163], v[48:51], v[32:35], v[160:163]
    ds_read_b64_tr_b16 v[100:101], v20 offset:36864
    v_mfma_f32_16x16x32_bf16 v[164:167], v[52:55], v[32:35], v[164:167]
    ds_read_b64_tr_b16 v[102:103], v20 offset:37120
    v_mfma_f32_16x16x32_bf16 v[168:171], v[32:35], v[56:59], v[168:171]
    v_mfma_f32_16x16x32_bf16 v[172:175], v[32:35], v[60:63], v[172:175]
    v_mfma_f32_16x16x32_bf16 v[176:179], v[40:43], v[36:39], v[176:179]
    v_mfma_f32_16x16x32_bf16 v[180:183], v[44:47], v[36:39], v[180:183]
    v_mfma_f32_16x16x32_bf16 v[184:187], v[48:51], v[36:39], v[184:187]
    v_mfma_f32_16x16x32_bf16 v[188:191], v[52:55], v[36:39], v[188:191]
    v_mfma_f32_16x16x32_bf16 v[192:195], v[36:39], v[56:59], v[192:195]
    v_mfma_f32_16x16x32_bf16 v[196:199], v[36:39], v[60:63], v[196:199]
    s_waitcnt lgkmcnt(0)
    s_barrier
    v_mfma_f32_16x16x32_bf16 v[104:107], v[80:83], v[64:67], v[104:107]
    ds_read_b128 v[24:27], v17 offset:0
    v_mfma_f32_16x16x32_bf16 v[108:111], v[84:87], v[64:67], v[108:111]
    ds_read_b64_tr_b16 v[40:41], v19 offset:0
    v_mfma_f32_16x16x32_bf16 v[112:115], v[88:91], v[64:67], v[112:115]
    ds_read_b64_tr_b16 v[42:43], v19 offset:256
    v_mfma_f32_16x16x32_bf16 v[116:119], v[92:95], v[64:67], v[116:119]
    ds_read_b128 v[28:31], v17 offset:1024
    v_mfma_f32_16x16x32_bf16 v[120:123], v[64:67], v[96:99], v[120:123]
    ds_read_b64_tr_b16 v[44:45], v21 offset:0
    v_mfma_f32_16x16x32_bf16 v[124:127], v[64:67], v[100:103], v[124:127]
    ds_read_b64_tr_b16 v[46:47], v21 offset:256
    v_mfma_f32_16x16x32_bf16 v[128:131], v[80:83], v[68:71], v[128:131]
    ds_read_b128 v[32:35], v17 offset:2048
    v_mfma_f32_16x16x32_bf16 v[132:135], v[84:87], v[68:71], v[132:135]
    ds_read_b64_tr_b16 v[48:49], v19 offset:4096
    v_mfma_f32_16x16x32_bf16 v[136:139], v[88:91], v[68:71], v[136:139]
    ds_read_b64_tr_b16 v[50:51], v19 offset:4352
    v_mfma_f32_16x16x32_bf16 v[140:143], v[92:95], v[68:71], v[140:143]
    ds_read_b128 v[36:39], v17 offset:3072
    v_mfma_f32_16x16x32_bf16 v[144:147], v[68:71], v[96:99], v[144:147]
    ds_read_b64_tr_b16 v[52:53], v21 offset:4096
    v_mfma_f32_16x16x32_bf16 v[148:151], v[68:71], v[100:103], v[148:151]
    ds_read_b64_tr_b16 v[54:55], v21 offset:4352
    v_mfma_f32_16x16x32_bf16 v[152:155], v[80:83], v[72:75], v[152:155]
    ds_read_b64_tr_b16 v[56:57], v19 offset:8192
    v_mfma_f32_16x16x32_bf16 v[156:159], v[84:87], v[72:75], v[156:159]
    ds_read_b64_tr_b16 v[58:59], v19 offset:8448
    v_mfma_f32_16x16x32_bf16 v[160:163], v[88:91], v[72:75], v[160:163]
    ds_read_b64_tr_b16 v[60:61], v21 offset:8192
    v_mfma_f32_16x16x32_bf16 v[164:167], v[92:95], v[72:75], v[164:167]
    ds_read_b64_tr_b16 v[62:63], v21 offset:8448
    v_mfma_f32_16x16x32_bf16 v[168:171], v[72:75], v[96:99], v[168:171]
    v_mfma_f32_16x16x32_bf16 v[172:175], v[72:75], v[100:103], v[172:175]
    v_mfma_f32_16x16x32_bf16 v[176:179], v[80:83], v[76:79], v[176:179]
    v_mfma_f32_16x16x32_bf16 v[180:183], v[84:87], v[76:79], v[180:183]
    v_mfma_f32_16x16x32_bf16 v[184:187], v[88:91], v[76:79], v[184:187]
    v_mfma_f32_16x16x32_bf16 v[188:191], v[92:95], v[76:79], v[188:191]
    v_mfma_f32_16x16x32_bf16 v[192:195], v[76:79], v[96:99], v[192:195]
    v_mfma_f32_16x16x32_bf16 v[196:199], v[76:79], v[100:103], v[196:199]
    s_waitcnt lgkmcnt(0)
    s_barrier
    v_mfma_f32_16x16x32_bf16 v[104:107], v[40:43], v[24:27], v[104:107]
    ds_read_b128 v[64:67], v17 offset:28672
    v_mfma_f32_16x16x32_bf16 v[108:111], v[44:47], v[24:27], v[108:111]
    ds_read_b64_tr_b16 v[80:81], v19 offset:28672
    v_mfma_f32_16x16x32_bf16 v[112:115], v[48:51], v[24:27], v[112:115]
    ds_read_b64_tr_b16 v[82:83], v19 offset:28928
    v_mfma_f32_16x16x32_bf16 v[116:119], v[52:55], v[24:27], v[116:119]
    ds_read_b128 v[68:71], v17 offset:29696
    v_mfma_f32_16x16x32_bf16 v[120:123], v[24:27], v[56:59], v[120:123]
    ds_read_b64_tr_b16 v[84:85], v21 offset:28672
    v_mfma_f32_16x16x32_bf16 v[124:127], v[24:27], v[60:63], v[124:127]
    ds_read_b64_tr_b16 v[86:87], v21 offset:28928
    v_mfma_f32_16x16x32_bf16 v[128:131], v[40:43], v[28:31], v[128:131]
    ds_read_b128 v[72:75], v17 offset:30720
    v_mfma_f32_16x16x32_bf16 v[132:135], v[44:47], v[28:31], v[132:135]
    ds_read_b64_tr_b16 v[88:89], v19 offset:32768
    v_mfma_f32_16x16x32_bf16 v[136:139], v[48:51], v[28:31], v[136:139]
    ds_read_b64_tr_b16 v[90:91], v19 offset:33024
    v_mfma_f32_16x16x32_bf16 v[140:143], v[52:55], v[28:31], v[140:143]
    ds_read_b128 v[76:79], v17 offset:31744
    v_mfma_f32_16x16x32_bf16 v[144:147], v[28:31], v[56:59], v[144:147]
    ds_read_b64_tr_b16 v[92:93], v21 offset:32768
    v_mfma_f32_16x16x32_bf16 v[148:151], v[28:31], v[60:63], v[148:151]
    ds_read_b64_tr_b16 v[94:95], v21 offset:33024
    v_mfma_f32_16x16x32_bf16 v[152:155], v[40:43], v[32:35], v[152:155]
    ds_read_b64_tr_b16 v[96:97], v19 offset:36864
    v_mfma_f32_16x16x32_bf16 v[156:159], v[44:47], v[32:35], v[156:159]
    ds_read_b64_tr_b16 v[98:99], v19 offset:37120
    v_mfma_f32_16x16x32_bf16 v[160:163], v[48:51], v[32:35], v[160:163]
    ds_read_b64_tr_b16 v[100:101], v21 offset:36864
    v_mfma_f32_16x16x32_bf16 v[164:167], v[52:55], v[32:35], v[164:167]
    ds_read_b64_tr_b16 v[102:103], v21 offset:37120
    v_mfma_f32_16x16x32_bf16 v[168:171], v[32:35], v[56:59], v[168:171]
    v_mfma_f32_16x16x32_bf16 v[172:175], v[32:35], v[60:63], v[172:175]
    v_mfma_f32_16x16x32_bf16 v[176:179], v[40:43], v[36:39], v[176:179]
    v_mfma_f32_16x16x32_bf16 v[180:183], v[44:47], v[36:39], v[180:183]
    v_mfma_f32_16x16x32_bf16 v[184:187], v[48:51], v[36:39], v[184:187]
    v_mfma_f32_16x16x32_bf16 v[188:191], v[52:55], v[36:39], v[188:191]
    v_mfma_f32_16x16x32_bf16 v[192:195], v[36:39], v[56:59], v[192:195]
    v_mfma_f32_16x16x32_bf16 v[196:199], v[36:39], v[60:63], v[196:199]
    s_waitcnt lgkmcnt(0)
    s_barrier
    v_mfma_f32_16x16x32_bf16 v[104:107], v[80:83], v[64:67], v[104:107]
    ds_read_b128 v[24:27], v16 offset:0
    v_mfma_f32_16x16x32_bf16 v[108:111], v[84:87], v[64:67], v[108:111]
    ds_read_b64_tr_b16 v[40:41], v18 offset:0
    v_mfma_f32_16x16x32_bf16 v[112:115], v[88:91], v[64:67], v[112:115]
    ds_read_b64_tr_b16 v[42:43], v18 offset:256
    v_mfma_f32_16x16x32_bf16 v[116:119], v[92:95], v[64:67], v[116:119]
    ds_read_b128 v[28:31], v16 offset:1024
    v_mfma_f32_16x16x32_bf16 v[120:123], v[64:67], v[96:99], v[120:123]
    ds_read_b64_tr_b16 v[44:45], v20 offset:0
    v_mfma_f32_16x16x32_bf16 v[124:127], v[64:67], v[100:103], v[124:127]
    ds_read_b64_tr_b16 v[46:47], v20 offset:256
    v_mfma_f32_16x16x32_bf16 v[128:131], v[80:83], v[68:71], v[128:131]
    ds_read_b128 v[32:35], v16 offset:2048
    v_mfma_f32_16x16x32_bf16 v[132:135], v[84:87], v[68:71], v[132:135]
    ds_read_b64_tr_b16 v[48:49], v18 offset:4096
    v_mfma_f32_16x16x32_bf16 v[136:139], v[88:91], v[68:71], v[136:139]
    ds_read_b64_tr_b16 v[50:51], v18 offset:4352
    v_mfma_f32_16x16x32_bf16 v[140:143], v[92:95], v[68:71], v[140:143]
    ds_read_b128 v[36:39], v16 offset:3072
    v_mfma_f32_16x16x32_bf16 v[144:147], v[68:71], v[96:99], v[144:147]
    ds_read_b64_tr_b16 v[52:53], v20 offset:4096
    v_mfma_f32_16x16x32_bf16 v[148:151], v[68:71], v[100:103], v[148:151]
    ds_read_b64_tr_b16 v[54:55], v20 offset:4352
    v_mfma_f32_16x16x32_bf16 v[152:155], v[80:83], v[72:75], v[152:155]
    ds_read_b64_tr_b16 v[56:57], v18 offset:8192
    v_mfma_f32_16x16x32_bf16 v[156:159], v[84:87], v[72:75], v[156:159]
    ds_read_b64_tr_b16 v[58:59], v18 offset:8448
    v_mfma_f32_16x16x32_bf16 v[160:163], v[88:91], v[72:75], v[160:163]
    ds_read_b64_tr_b16 v[60:61], v20 offset:8192
    v_mfma_f32_16x16x32_bf16 v[164:167], v[92:95], v[72:75], v[164:167]
    ds_read_b64_tr_b16 v[62:63], v20 offset:8448
    v_mfma_f32_16x16x32_bf16 v[168:171], v[72:75], v[96:99], v[168:171]
    v_mfma_f32_16x16x32_bf16 v[172:175], v[72:75], v[100:103], v[172:175]
    v_mfma_f32_16x16x32_bf16 v[176:179], v[80:83], v[76:79], v[176:179]
    v_mfma_f32_16x16x32_bf16 v[180:183], v[84:87], v[76:79], v[180:183]
    v_mfma_f32_16x16x32_bf16 v[184:187], v[88:91], v[76:79], v[184:187]
    v_mfma_f32_16x16x32_bf16 v[188:191], v[92:95], v[76:79], v[188:191]
    v_mfma_f32_16x16x32_bf16 v[192:195], v[76:79], v[96:99], v[192:195]
    v_mfma_f32_16x16x32_bf16 v[196:199], v[76:79], v[100:103], v[196:199]
    s_sub_u32 s36, s36, 1
    s_cmp_lg_u32 s36, 0
    s_cbranch_scc1 L_q_885
    s_cmp_lg_u32 s28, 4
    s_cbranch_scc1 L1q_h
    v_lshlrev_b32 v8, 3, v1
    v_mov_b32 v9, 0
    s_and_b32 s39, s2, 7
    s_lshl_b32 s39, s39, 9
    s_add_u32 s39, s39, 41943040
    buffer_load_dword v7, v9, s[52:55], 0 offen sc1
    buffer_load_dwordx2 v[10:11], v8, s[16:19], s39 offen sc1
L1q_h:
    s_waitcnt lgkmcnt(0)
    s_barrier
    v_mfma_f32_16x16x32_bf16 v[104:107], v[40:43], v[24:27], v[104:107]
    ds_read_b128 v[64:67], v16 offset:28672
    v_mfma_f32_16x16x32_bf16 v[108:111], v[44:47], v[24:27], v[108:111]
    ds_read_b64_tr_b16 v[80:81], v18 offset:28672
    v_mfma_f32_16x16x32_bf16 v[112:115], v[48:51], v[24:27], v[112:115]
    ds_read_b64_tr_b16 v[82:83], v18 offset:28928
    v_mfma_f32_16x16x32_bf16 v[116:119], v[52:55], v[24:27], v[116:119]
    ds_read_b128 v[68:71], v16 offset:29696
    v_mfma_f32_16x16x32_bf16 v[120:123], v[24:27], v[56:59], v[120:123]
    ds_read_b64_tr_b16 v[84:85], v20 offset:28672
    v_mfma_f32_16x16x32_bf16 v[124:127], v[24:27], v[60:63], v[124:127]
    ds_read_b64_tr_b16 v[86:87], v20 offset:28928
    v_mfma_f32_16x16x32_bf16 v[128:131], v[40:43], v[28:31], v[128:131]
    ds_read_b128 v[72:75], v16 offset:30720
    v_mfma_f32_16x16x32_bf16 v[132:135], v[44:47], v[28:31], v[132:135]
    ds_read_b64_tr_b16 v[88:89], v18 offset:32768
    v_mfma_f32_16x16x32_bf16 v[136:139], v[48:51], v[28:31], v[136:139]
    ds_read_b64_tr_b16 v[90:91], v18 offset:33024
    v_mfma_f32_16x16x32_bf16 v[140:143], v[52:55], v[28:31], v[140:143]
    ds_read_b128 v[76:79], v16 offset:31744
    v_mfma_f32_16x16x32_bf16 v[144:147], v[28:31], v[56:59], v[144:147]
    ds_read_b64_tr_b16 v[92:93], v20 offset:32768
    v_mfma_f32_16x16x32_bf16 v[148:151], v[28:31], v[60:63], v[148:151]
    ds_read_b64_tr_b16 v[94:95], v20 offset:33024
    v_mfma_f32_16x16x32_bf16 v[152:155], v[40:43], v[32:35], v[152:155]
    ds_read_b64_tr_b16 v[96:97], v18 offset:36864
    v_mfma_f32_16x16x32_bf16 v[156:159], v[44:47], v[32:35], v[156:159]
    ds_read_b64_tr_b16 v[98:99], v18 offset:37120
    v_mfma_f32_16x16x32_bf16 v[160:163], v[48:51], v[32:35], v[160:163]
    ds_read_b64_tr_b16 v[100:101], v20 offset:36864
    v_mfma_f32_16x16x32_bf16 v[164:167], v[52:55], v[32:35], v[164:167]
    ds_read_b64_tr_b16 v[102:103], v20 offset:37120
    v_mfma_f32_16x16x32_bf16 v[168:171], v[32:35], v[56:59], v[168:171]
    v_mfma_f32_16x16x32_bf16 v[172:175], v[32:35], v[60:63], v[172:175]
    v_mfma_f32_16x16x32_bf16 v[176:179], v[40:43], v[36:39], v[176:179]
    v_mfma_f32_16x16x32_bf16 v[180:183], v[44:47], v[36:39], v[180:183]
    v_mfma_f32_16x16x32_bf16 v[184:187], v[48:51], v[36:39], v[184:187]
    v_mfma_f32_16x16x32_bf16 v[188:191], v[52:55], v[36:39], v[188:191]
    v_mfma_f32_16x16x32_bf16 v[192:195], v[36:39], v[56:59], v[192:195]
    v_mfma_f32_16x16x32_bf16 v[196:199], v[36:39], v[60:63], v[196:199]
    s_waitcnt lgkmcnt(0)
    s_barrier
    v_mfma_f32_16x16x32_bf16 v[104:107], v[80:83], v[64:67], v[104:107]
    ds_read_b128 v[24:27], v17 offset:0
    v_mfma_f32_16x16x32_bf16 v[108:111], v[84:87], v[64:67], v[108:111]
    ds_read_b64_tr_b16 v[40:41], v19 offset:0
    v_mfma_f32_16x16x32_bf16 v[112:115], v[88:91], v[64:67], v[112:115]
    ds_read_b64_tr_b16 v[42:43], v19 offset:256
    v_mfma_f32_16x16x32_bf16 v[116:119], v[92:95], v[64:67], v[116:119]
    ds_read_b128 v[28:31], v17 offset:1024
    v_mfma_f32_16x16x32_bf16 v[120:123], v[64:67], v[96:99], v[120:123]
    ds_read_b64_tr_b16 v[44:45], v21 offset:0
    v_mfma_f32_16x16x32_bf16 v[124:127], v[64:67], v[100:103], v[124:127]
    ds_read_b64_tr_b16 v[46:47], v21 offset:256
    v_mfma_f32_16x16x32_bf16 v[128:131], v[80:83], v[68:71], v[128:131]
    ds_read_b128 v[32:35], v17 offset:2048
    v_mfma_f32_16x16x32_bf16 v[132:135], v[84:87], v[68:71], v[132:135]
    ds_read_b64_tr_b16 v[48:49], v19 offset:4096
    v_mfma_f32_16x16x32_bf16 v[136:139], v[88:91], v[68:71], v[136:139]
    ds_read_b64_tr_b16 v[50:51], v19 offset:4352
    v_mfma_f32_16x16x32_bf16 v[140:143], v[92:95], v[68:71], v[140:143]
    ds_read_b128 v[36:39], v17 offset:3072
    v_mfma_f32_16x16x32_bf16 v[144:147], v[68:71], v[96:99], v[144:147]
    ds_read_b64_tr_b16 v[52:53], v21 offset:4096
    v_mfma_f32_16x16x32_bf16 v[148:151], v[68:71], v[100:103], v[148:151]
    ds_read_b64_tr_b16 v[54:55], v21 offset:4352
    v_mfma_f32_16x16x32_bf16 v[152:155], v[80:83], v[72:75], v[152:155]
    ds_read_b64_tr_b16 v[56:57], v19 offset:8192
    v_mfma_f32_16x16x32_bf16 v[156:159], v[84:87], v[72:75], v[156:159]
    ds_read_b64_tr_b16 v[58:59], v19 offset:8448
    v_mfma_f32_16x16x32_bf16 v[160:163], v[88:91], v[72:75], v[160:163]
    ds_read_b64_tr_b16 v[60:61], v21 offset:8192
    v_mfma_f32_16x16x32_bf16 v[164:167], v[92:95], v[72:75], v[164:167]
    ds_read_b64_tr_b16 v[62:63], v21 offset:8448
    v_mfma_f32_16x16x32_bf16 v[168:171], v[72:75], v[96:99], v[168:171]
    v_mfma_f32_16x16x32_bf16 v[172:175], v[72:75], v[100:103], v[172:175]
    v_mfma_f32_16x16x32_bf16 v[176:179], v[80:83], v[76:79], v[176:179]
    v_mfma_f32_16x16x32_bf16 v[180:183], v[84:87], v[76:79], v[180:183]
    v_mfma_f32_16x16x32_bf16 v[184:187], v[88:91], v[76:79], v[184:187]
    v_mfma_f32_16x16x32_bf16 v[188:191], v[92:95], v[76:79], v[188:191]
    v_mfma_f32_16x16x32_bf16 v[192:195], v[76:79], v[96:99], v[192:195]
    v_mfma_f32_16x16x32_bf16 v[196:199], v[76:79], v[100:103], v[196:199]
    s_waitcnt lgkmcnt(0)
    s_barrier
    v_mfma_f32_16x16x32_bf16 v[104:107], v[40:43], v[24:27], v[104:107]
    ds_read_b128 v[64:67], v17 offset:28672
    v_mfma_f32_16x16x32_bf16 v[108:111], v[44:47], v[24:27], v[108:111]
    ds_read_b64_tr_b16 v[80:81], v19 offset:28672
    v_mfma_f32_16x16x32_bf16 v[112:115], v[48:51], v[24:27], v[112:115]
    ds_read_b64_tr_b16 v[82:83], v19 offset:28928
    v_mfma_f32_16x16x32_bf16 v[116:119], v[52:55], v[24:27], v[116:119]
    ds_read_b128 v[68:71], v17 offset:29696
    v_mfma_f32_16x16x32_bf16 v[120:123], v[24:27], v[56:59], v[120:123]
    ds_read_b64_tr_b16 v[84:85], v21 offset:28672
    v_mfma_f32_16x16x32_bf16 v[124:127], v[24:27], v[60:63], v[124:127]
    ds_read_b64_tr_b16 v[86:87], v21 offset:28928
    v_mfma_f32_16x16x32_bf16 v[128:131], v[40:43], v[28:31], v[128:131]
    ds_read_b128 v[72:75], v17 offset:30720
    v_mfma_f32_16x16x32_bf16 v[132:135], v[44:47], v[28:31], v[132:135]
    ds_read_b64_tr_b16 v[88:89], v19 offset:32768
    v_mfma_f32_16x16x32_bf16 v[136:139], v[48:51], v[28:31], v[136:139]
    ds_read_b64_tr_b16 v[90:91], v19 offset:33024
    v_mfma_f32_16x16x32_bf16 v[140:143], v[52:55], v[28:31], v[140:143]
    ds_read_b128 v[76:79], v17 offset:31744
    v_mfma_f32_16x16x32_bf16 v[144:147], v[28:31], v[56:59], v[144:147]
    ds_read_b64_tr_b16 v[92:93], v21 offset:32768
    v_mfma_f32_16x16x32_bf16 v[148:151], v[28:31], v[60:63], v[148:151]
    ds_read_b64_tr_b16 v[94:95], v21 offset:33024
    v_mfma_f32_16x16x32_bf16 v[152:155], v[40:43], v[32:35], v[152:155]
    ds_read_b64_tr_b16 v[96:97], v19 offset:36864
    v_mfma_f32_16x16x32_bf16 v[156:159], v[44:47], v[32:35], v[156:159]
    ds_read_b64_tr_b16 v[98:99], v19 offset:37120
    v_mfma_f32_16x16x32_bf16 v[160:163], v[48:51], v[32:35], v[160:163]
    ds_read_b64_tr_b16 v[100:101], v21 offset:36864
    v_mfma_f32_16x16x32_bf16 v[164:167], v[52:55], v[32:35], v[164:167]
    ds_read_b64_tr_b16 v[102:103], v21 offset:37120
    v_mfma_f32_16x16x32_bf16 v[168:171], v[32:35], v[56:59], v[168:171]
    v_mfma_f32_16x16x32_bf16 v[172:175], v[32:35], v[60:63], v[172:175]
    v_mfma_f32_16x16x32_bf16 v[176:179], v[40:43], v[36:39], v[176:179]
    v_mfma_f32_16x16x32_bf16 v[180:183], v[44:47], v[36:39], v[180:183]
    v_mfma_f32_16x16x32_bf16 v[184:187], v[48:51], v[36:39], v[184:187]
    v_mfma_f32_16x16x32_bf16 v[188:191], v[52:55], v[36:39], v[188:191]
    v_mfma_f32_16x16x32_bf16 v[192:195], v[36:39], v[56:59], v[192:195]
    v_mfma_f32_16x16x32_bf16 v[196:199], v[36:39], v[60:63], v[196:199]
    s_waitcnt lgkmcnt(0)
    v_mfma_f32_16x16x32_bf16 v[104:107], v[80:83], v[64:67], v[104:107]
    v_mfma_f32_16x16x32_bf16 v[108:111], v[84:87], v[64:67], v[108:111]
    v_mfma_f32_16x16x32_bf16 v[112:115], v[88:91], v[64:67], v[112:115]
    v_mfma_f32_16x16x32_bf16 v[116:119], v[92:95], v[64:67], v[116:119]
    v_mfma_f32_16x16x32_bf16 v[120:123], v[64:67], v[96:99], v[120:123]
    v_mfma_f32_16x16x32_bf16 v[124:127], v[64:67], v[100:103], v[124:127]
    v_mfma_f32_16x16x32_bf16 v[128:131], v[80:83], v[68:71], v[128:131]
    v_mfma_f32_16x16x32_bf16 v[132:135], v[84:87], v[68:71], v[132:135]
    v_mfma_f32_16x16x32_bf16 v[136:139], v[88:91], v[68:71], v[136:139]
    v_mfma_f32_16x16x32_bf16 v[140:143], v[92:95], v[68:71], v[140:143]
    v_mfma_f32_16x16x32_bf16 v[144:147], v[68:71], v[96:99], v[144:147]
    v_mfma_f32_16x16x32_bf16 v[148:151], v[68:71], v[100:103], v[148:151]
    v_mfma_f32_16x16x32_bf16 v[152:155], v[80:83], v[72:75], v[152:155]
    v_mfma_f32_16x16x32_bf16 v[156:159], v[84:87], v[72:75], v[156:159]
    v_mfma_f32_16x16x32_bf16 v[160:163], v[88:91], v[72:75], v[160:163]
    v_mfma_f32_16x16x32_bf16 v[164:167], v[92:95], v[72:75], v[164:167]
    v_mfma_f32_16x16x32_bf16 v[168:171], v[72:75], v[96:99], v[168:171]
    v_mfma_f32_16x16x32_bf16 v[172:175], v[72:75], v[100:103], v[172:175]
    v_mfma_f32_16x16x32_bf16 v[176:179], v[80:83], v[76:79], v[176:179]
    v_mfma_f32_16x16x32_bf16 v[180:183], v[84:87], v[76:79], v[180:183]
    v_mfma_f32_16x16x32_bf16 v[184:187], v[88:91], v[76:79], v[184:187]
    v_mfma_f32_16x16x32_bf16 v[188:191], v[92:95], v[76:79], v[188:191]
    v_mfma_f32_16x16x32_bf16 v[192:195], v[76:79], v[96:99], v[192:195]
    v_mfma_f32_16x16x32_bf16 v[196:199], v[76:79], v[100:103], v[196:199]
    s_cmp_lg_u32 s28, 4
    s_cbranch_scc1 L1q_epi
    s_waitcnt vmcnt(0)
    v_cmp_eq_u32 vcc, 0, v7
    s_cbranch_vccz Lq_elnq
    s_mov_b32 s34, 0
Lp_elnq:
    buffer_load_dword v7, v9, s[52:55], 0 offen sc1
    s_add_u32 s34, s34, 1
    s_waitcnt vmcnt(0)
    v_cmp_eq_u32 vcc, 0, v7
    s_cbranch_vccz Lq_elnq
    s_cmp_ge_u32 s34, 0x40000
    s_cbranch_scc1 Lq_elnq
    s_sleep 1
    s_branch Lp_elnq
Lq_elnq:
    v_readfirstlane_b32 s51, v7
    s_nop 1
    v_xor_b32 v10, s51, v10
    v_xor_b32 v11, s51, v11
    v_or_b32 v10, v10, v11
    v_cmp_ne_u32 vcc, 0, v10
    s_cbranch_vccz Lq_lnq
    s_mov_b32 s34, 0
Lp_lnq:
    buffer_load_dwordx2 v[10:11], v8, s[16:19], s39 offen sc1
    s_add_u32 s34, s34, 1
    s_waitcnt vmcnt(0)
    v_xor_b32 v10, s51, v10
    v_xor_b32 v11, s51, v11
    v_or_b32 v10, v10, v11
    v_cmp_ne_u32 vcc, 0, v10
    s_cbranch_vccz Lq_lnq
    s_cmp_ge_u32 s34, 0x40000
    s_cbranch_scc1 Lq_lnq
    s_sleep 1
    s_branch Lp_lnq
Lq_lnq:
    v_mov_b32 v9, 128
    ds_write_b32 v9, v7
    s_waitcnt lgkmcnt(0)
L1q_epi:
    v_lshl_add_u32 v2, v4, 2, v5
    v_lshlrev_b32 v3, 6, v2
    v_lshl_add_u32 v3, v6, 3, v3
    s_and_b32 s34, s28, 1
    s_lshl_b32 s35, s34, 11
    s_add_u32 s35, s35, 114688
    v_add_u32 v3, s35, v3
    ds_read_b64_tr_b16 v[8:9], v3 offset:0
    ds_read_b64_tr_b16 v[10:11], v3 offset:1024
    ds_read_b64_tr_b16 v[12:13], v3 offset:32
    ds_read_b64_tr_b16 v[14:15], v3 offset:1056
    s_mul_i32 s35, s34, 8704
    s_lshr_b32 s33, s28, 1
    s_lshl_b32 s33, s33, 5
    s_add_u32 s35, s35, s33
    v_mul_u32_u24 v17, 136, v2
    v_lshl_add_u32 v17, v6, 3, v17
    v_add_u32 v17, s35, v17
    s_mul_i32 s35, s28, 8704
    v_and_b32 v2, 15, v1
    v_mul_u32_u24 v16, 136, v2
    v_lshl_add_u32 v16, v4, 3, v16
    v_add_u32 v16, s35, v16
    s_lshl_b32 s31, s38, 1
    s_add_u32 s31, s31, s34
    s_lshl_b32 s33, s37, 2
    s_lshr_b32 s35, s28, 1
    s_add_u32 s33, s33, s35
    v_lshlrev_b32 v18, 3, v2
    s_lshl_b32 s35, s33, 9
    s_add_u32 s35, s35, 4194304
    v_add_u32 v232, s35, v18
    v_lshlrev_b32 v18, 15, v4
    v_lshl_add_u32 v18, v2, 4, v18
    s_lshl_b32 s33, s33, 10
    s_lshl_b32 s35, s31, 17
    s_add_u32 s33, s33, s35
    s_add_u32 s33, s33, 29360128
    s_mov_b32 s30, 1069066811
    v_mov_b32 v19, 0
    v_cvt_pk_bf16_f32 v24, v112, v113
    v_cvt_pk_bf16_f32 v25, v114, v115
    v_cvt_pk_bf16_f32 v26, v116, v117
    v_cvt_pk_bf16_f32 v27, v118, v119
    v_cvt_pk_bf16_f32 v28, v136, v137
    v_cvt_pk_bf16_f32 v29, v138, v139
    v_cvt_pk_bf16_f32 v30, v140, v141
    v_cvt_pk_bf16_f32 v31, v142, v143
    v_cvt_pk_bf16_f32 v32, v160, v161
    v_cvt_pk_bf16_f32 v33, v162, v163
    v_cvt_pk_bf16_f32 v34, v164, v165
    v_cvt_pk_bf16_f32 v35, v166, v167
    v_cvt_pk_bf16_f32 v36, v184, v185
    v_cvt_pk_bf16_f32 v37, v186, v187
    v_cvt_pk_bf16_f32 v38, v188, v189
    v_cvt_pk_bf16_f32 v39, v190, v191
    s_waitcnt lgkmcnt(0)
    s_nop 1
    v_mfma_f32_16x16x32_bf16 v[40:43], v[8:11], v[24:27], 0
    v_mfma_f32_16x16x32_bf16 v[44:47], v[12:15], v[24:27], 0
    v_mfma_f32_16x16x32_bf16 v[48:51], v[8:11], v[28:31], 0
    v_mfma_f32_16x16x32_bf16 v[52:55], v[12:15], v[28:31], 0
    v_mfma_f32_16x16x32_bf16 v[56:59], v[8:11], v[32:35], 0
    v_mfma_f32_16x16x32_bf16 v[60:63], v[12:15], v[32:35], 0
    v_mfma_f32_16x16x32_bf16 v[64:67], v[8:11], v[36:39], 0
    v_mfma_f32_16x16x32_bf16 v[68:71], v[12:15], v[36:39], 0
    s_nop 3
    v_max3_f32 v72, v40, v41, v42
    v_max3_f32 v72, v72, v43, v44
    v_max3_f32 v72, v72, v45, v46
    v_max_f32 v72, v72, v47
    v_min3_f32 v80, v40, v41, v42
    v_min3_f32 v80, v80, v43, v44
    v_min3_f32 v80, v80, v45, v46
    v_min_f32 v80, v80, v47
    v_max3_f32 v74, v48, v49, v50
    v_max3_f32 v74, v74, v51, v52
    v_max3_f32 v74, v74, v53, v54
    v_max_f32 v74, v74, v55
    v_min3_f32 v82, v48, v49, v50
    v_min3_f32 v82, v82, v51, v52
    v_min3_f32 v82, v82, v53, v54
    v_min_f32 v82, v82, v55
    v_max3_f32 v76, v56, v57, v58
    v_max3_f32 v76, v76, v59, v60
    v_max3_f32 v76, v76, v61, v62
    v_max_f32 v76, v76, v63
    v_min3_f32 v84, v56, v57, v58
    v_min3_f32 v84, v84, v59, v60
    v_min3_f32 v84, v84, v61, v62
    v_min_f32 v84, v84, v63
    s_nop 0
    v_max3_f32 v78, v64, v65, v66
    v_max3_f32 v78, v78, v67, v68
    v_max3_f32 v78, v78, v69, v70
    v_max_f32 v78, v78, v71
    v_min3_f32 v86, v64, v65, v66
    v_min3_f32 v86, v86, v67, v68
    v_min3_f32 v86, v86, v69, v70
    v_min_f32 v86, v86, v71
    s_nop 1
    v_permlane32_swap_b32 v72, v74
    v_permlane32_swap_b32 v76, v78
    v_permlane32_swap_b32 v80, v82
    v_permlane32_swap_b32 v84, v86
    v_max_f32 v72, v72, v74
    v_max_f32 v76, v76, v78
    v_min_f32 v80, v80, v82
    v_min_f32 v84, v84, v86
    s_nop 0
    v_permlane16_swap_b32 v72, v76
    v_permlane16_swap_b32 v80, v84
    v_max_f32 v72, v72, v76
    v_min_f32 v80, v80, v84
    v_mul_f32 v72, s30, v72
    v_mul_f32 v80, s30, v80
    s_nop 0
    v_mov_b32 v76, v72
    v_mov_b32 v84, v80
    s_nop 0
    v_permlane16_swap_b32 v72, v76
    v_permlane16_swap_b32 v80, v84
    v_mov_b32 v74, v72
    v_mov_b32 v78, v76
    v_mov_b32 v82, v80
    v_mov_b32 v86, v84
    v_permlane32_swap_b32 v72, v74
    v_permlane32_swap_b32 v76, v78
    v_permlane32_swap_b32 v80, v82
    v_permlane32_swap_b32 v84, v86
    v_pk_fma_f32 v[112:113], v[40:41], s[30:31], v[72:73] op_sel:[0,0,0] op_sel_hi:[1,0,0] neg_lo:[0,0,1] neg_hi:[0,0,1]
    v_pk_fma_f32 v[40:41], v[40:41], s[30:31], v[80:81] op_sel:[0,0,0] op_sel_hi:[1,0,0] neg_lo:[1,0,0] neg_hi:[1,0,0]
    v_exp_f32 v112, v112
    v_exp_f32 v113, v113
    v_exp_f32 v40, v40
    v_exp_f32 v41, v41
    v_pk_fma_f32 v[114:115], v[42:43], s[30:31], v[72:73] op_sel:[0,0,0] op_sel_hi:[1,0,0] neg_lo:[0,0,1] neg_hi:[0,0,1]
    v_pk_fma_f32 v[42:43], v[42:43], s[30:31], v[80:81] op_sel:[0,0,0] op_sel_hi:[1,0,0] neg_lo:[1,0,0] neg_hi:[1,0,0]
    v_exp_f32 v114, v114
    v_exp_f32 v115, v115
    v_exp_f32 v42, v42
    v_exp_f32 v43, v43
    v_pk_fma_f32 v[116:117], v[44:45], s[30:31], v[72:73] op_sel:[0,0,0] op_sel_hi:[1,0,0] neg_lo:[0,0,1] neg_hi:[0,0,1]
    v_pk_fma_f32 v[44:45], v[44:45], s[30:31], v[80:81] op_sel:[0,0,0] op_sel_hi:[1,0,0] neg_lo:[1,0,0] neg_hi:[1,0,0]
    v_exp_f32 v116, v116
    v_exp_f32 v117, v117
    v_exp_f32 v44, v44
    v_exp_f32 v45, v45
    v_pk_add_f32 v[24:25], v[112:113], v[114:115]
    v_pk_add_f32 v[26:27], v[40:41], v[42:43]
    v_pk_fma_f32 v[118:119], v[46:47], s[30:31], v[72:73] op_sel:[0,0,0] op_sel_hi:[1,0,0] neg_lo:[0,0,1] neg_hi:[0,0,1]
    v_pk_fma_f32 v[46:47], v[46:47], s[30:31], v[80:81] op_sel:[0,0,0] op_sel_hi:[1,0,0] neg_lo:[1,0,0] neg_hi:[1,0,0]
    v_exp_f32 v118, v118
    v_exp_f32 v119, v119
    v_exp_f32 v46, v46
    v_exp_f32 v47, v47
    v_pk_add_f32 v[24:25], v[24:25], v[116:117]
    v_pk_add_f32 v[26:27], v[26:27], v[44:45]
    v_pk_add_f32 v[24:25], v[24:25], v[118:119]
    v_pk_add_f32 v[26:27], v[26:27], v[46:47]
    v_add_f32 v72, v24, v25
    v_add_f32 v80, v26, v27
    v_pk_fma_f32 v[136:137], v[48:49], s[30:31], v[74:75] op_sel:[0,0,0] op_sel_hi:[1,0,0] neg_lo:[0,0,1] neg_hi:[0,0,1]
    v_pk_fma_f32 v[48:49], v[48:49], s[30:31], v[82:83] op_sel:[0,0,0] op_sel_hi:[1,0,0] neg_lo:[1,0,0] neg_hi:[1,0,0]
    v_exp_f32 v136, v136
    v_exp_f32 v137, v137
    v_exp_f32 v48, v48
    v_exp_f32 v49, v49
    v_pk_fma_f32 v[138:139], v[50:51], s[30:31], v[74:75] op_sel:[0,0,0] op_sel_hi:[1,0,0] neg_lo:[0,0,1] neg_hi:[0,0,1]
    v_pk_fma_f32 v[50:51], v[50:51], s[30:31], v[82:83] op_sel:[0,0,0] op_sel_hi:[1,0,0] neg_lo:[1,0,0] neg_hi:[1,0,0]
    v_exp_f32 v138, v138
    v_exp_f32 v139, v139
    v_exp_f32 v50, v50
    v_exp_f32 v51, v51
    v_pk_fma_f32 v[140:141], v[52:53], s[30:31], v[74:75] op_sel:[0,0,0] op_sel_hi:[1,0,0] neg_lo:[0,0,1] neg_hi:[0,0,1]
    v_pk_fma_f32 v[52:53], v[52:53], s[30:31], v[82:83] op_sel:[0,0,0] op_sel_hi:[1,0,0] neg_lo:[1,0,0] neg_hi:[1,0,0]
    v_exp_f32 v140, v140
    v_exp_f32 v141, v141
    v_exp_f32 v52, v52
    v_exp_f32 v53, v53
    v_pk_add_f32 v[24:25], v[136:137], v[138:139]
    v_pk_add_f32 v[26:27], v[48:49], v[50:51]
    v_pk_fma_f32 v[142:143], v[54:55], s[30:31], v[74:75] op_sel:[0,0,0] op_sel_hi:[1,0,0] neg_lo:[0,0,1] neg_hi:[0,0,1]
    v_pk_fma_f32 v[54:55], v[54:55], s[30:31], v[82:83] op_sel:[0,0,0] op_sel_hi:[1,0,0] neg_lo:[1,0,0] neg_hi:[1,0,0]
    v_exp_f32 v142, v142
    v_exp_f32 v143, v143
    v_exp_f32 v54, v54
    v_exp_f32 v55, v55
    v_pk_add_f32 v[24:25], v[24:25], v[140:141]
    v_pk_add_f32 v[26:27], v[26:27], v[52:53]
    v_pk_add_f32 v[24:25], v[24:25], v[142:143]
    v_pk_add_f32 v[26:27], v[26:27], v[54:55]
    v_add_f32 v74, v24, v25
    v_add_f32 v82, v26, v27
    v_pk_fma_f32 v[160:161], v[56:57], s[30:31], v[76:77] op_sel:[0,0,0] op_sel_hi:[1,0,0] neg_lo:[0,0,1] neg_hi:[0,0,1]
    v_pk_fma_f32 v[56:57], v[56:57], s[30:31], v[84:85] op_sel:[0,0,0] op_sel_hi:[1,0,0] neg_lo:[1,0,0] neg_hi:[1,0,0]
    v_exp_f32 v160, v160
    v_exp_f32 v161, v161
    v_exp_f32 v56, v56
    v_exp_f32 v57, v57
    v_pk_fma_f32 v[162:163], v[58:59], s[30:31], v[76:77] op_sel:[0,0,0] op_sel_hi:[1,0,0] neg_lo:[0,0,1] neg_hi:[0,0,1]
    v_pk_fma_f32 v[58:59], v[58:59], s[30:31], v[84:85] op_sel:[0,0,0] op_sel_hi:[1,0,0] neg_lo:[1,0,0] neg_hi:[1,0,0]
    v_exp_f32 v162, v162
    v_exp_f32 v163, v163
    v_exp_f32 v58, v58
    v_exp_f32 v59, v59
    v_pk_fma_f32 v[164:165], v[60:61], s[30:31], v[76:77] op_sel:[0,0,0] op_sel_hi:[1,0,0] neg_lo:[0,0,1] neg_hi:[0,0,1]
    v_pk_fma_f32 v[60:61], v[60:61], s[30:31], v[84:85] op_sel:[0,0,0] op_sel_hi:[1,0,0] neg_lo:[1,0,0] neg_hi:[1,0,0]
    v_exp_f32 v164, v164
    v_exp_f32 v165, v165
    v_exp_f32 v60, v60
    v_exp_f32 v61, v61
    v_pk_add_f32 v[24:25], v[160:161], v[162:163]
    v_pk_add_f32 v[26:27], v[56:57], v[58:59]
    v_pk_fma_f32 v[166:167], v[62:63], s[30:31], v[76:77] op_sel:[0,0,0] op_sel_hi:[1,0,0] neg_lo:[0,0,1] neg_hi:[0,0,1]
    v_pk_fma_f32 v[62:63], v[62:63], s[30:31], v[84:85] op_sel:[0,0,0] op_sel_hi:[1,0,0] neg_lo:[1,0,0] neg_hi:[1,0,0]
    v_exp_f32 v166, v166
    v_exp_f32 v167, v167
    v_exp_f32 v62, v62
    v_exp_f32 v63, v63
    v_pk_add_f32 v[24:25], v[24:25], v[164:165]
    v_pk_add_f32 v[26:27], v[26:27], v[60:61]
    v_pk_add_f32 v[24:25], v[24:25], v[166:167]
    v_pk_add_f32 v[26:27], v[26:27], v[62:63]
    v_add_f32 v76, v24, v25
    v_add_f32 v84, v26, v27
    v_pk_fma_f32 v[184:185], v[64:65], s[30:31], v[78:79] op_sel:[0,0,0] op_sel_hi:[1,0,0] neg_lo:[0,0,1] neg_hi:[0,0,1]
    v_pk_fma_f32 v[64:65], v[64:65], s[30:31], v[86:87] op_sel:[0,0,0] op_sel_hi:[1,0,0] neg_lo:[1,0,0] neg_hi:[1,0,0]
    v_exp_f32 v184, v184
    v_exp_f32 v185, v185
    v_exp_f32 v64, v64
    v_exp_f32 v65, v65
    v_pk_fma_f32 v[186:187], v[66:67], s[30:31], v[78:79] op_sel:[0,0,0] op_sel_hi:[1,0,0] neg_lo:[0,0,1] neg_hi:[0,0,1]
    v_pk_fma_f32 v[66:67], v[66:67], s[30:31], v[86:87] op_sel:[0,0,0] op_sel_hi:[1,0,0] neg_lo:[1,0,0] neg_hi:[1,0,0]
    v_exp_f32 v186, v186
    v_exp_f32 v187, v187
    v_exp_f32 v66, v66
    v_exp_f32 v67, v67
    v_pk_fma_f32 v[188:189], v[68:69], s[30:31], v[78:79] op_sel:[0,0,0] op_sel_hi:[1,0,0] neg_lo:[0,0,1] neg_hi:[0,0,1]
    v_pk_fma_f32 v[68:69], v[68:69], s[30:31], v[86:87] op_sel:[0,0,0] op_sel_hi:[1,0,0] neg_lo:[1,0,0] neg_hi:[1,0,0]
    v_exp_f32 v188, v188
    v_exp_f32 v189, v189
    v_exp_f32 v68, v68
    v_exp_f32 v69, v69
    v_pk_add_f32 v[24:25], v[184:185], v[186:187]
    v_pk_add_f32 v[26:27], v[64:65], v[66:67]
    v_pk_fma_f32 v[190:191], v[70:71], s[30:31], v[78:79] op_sel:[0,0,0] op_sel_hi:[1,0,0] neg_lo:[0,0,1] neg_hi:[0,0,1]
    v_pk_fma_f32 v[70:71], v[70:71], s[30:31], v[86:87] op_sel:[0,0,0] op_sel_hi:[1,0,0] neg_lo:[1,0,0] neg_hi:[1,0,0]
    v_exp_f32 v190, v190
    v_exp_f32 v191, v191
    v_exp_f32 v70, v70
    v_exp_f32 v71, v71
    v_pk_add_f32 v[24:25], v[24:25], v[188:189]
    v_pk_add_f32 v[26:27], v[26:27], v[68:69]
    v_pk_add_f32 v[24:25], v[24:25], v[190:191]
    v_pk_add_f32 v[26:27], v[26:27], v[70:71]
    v_add_f32 v78, v24, v25
    v_add_f32 v86, v26, v27
    s_nop 1
    v_permlane32_swap_b32 v72, v74
    v_permlane32_swap_b32 v76, v78
    v_permlane32_swap_b32 v80, v82
    v_permlane32_swap_b32 v84, v86
    v_add_f32 v72, v72, v74
    v_add_f32 v76, v76, v78
    v_add_f32 v80, v80, v82
    v_add_f32 v84, v84, v86
    s_nop 0
    v_permlane16_swap_b32 v72, v76
    v_permlane16_swap_b32 v80, v84
    v_add_f32 v72, v72, v76
    v_add_f32 v80, v80, v84
    v_rcp_f32 v72, v72
    v_rcp_f32 v80, v80
    s_nop 0
    v_mov_b32 v76, v72
    v_mov_b32 v84, v80
    s_nop 0
    v_permlane16_swap_b32 v72, v76
    v_permlane16_swap_b32 v80, v84
    v_mov_b32 v74, v72
    v_mov_b32 v78, v76
    v_mov_b32 v82, v80
    v_mov_b32 v86, v84
    v_permlane32_swap_b32 v72, v74
    v_permlane32_swap_b32 v76, v78
    v_permlane32_swap_b32 v80, v82
    v_permlane32_swap_b32 v84, v86
    v_pk_mul_f32 v[112:113], v[112:113], v[72:73] op_sel:[0,0] op_sel_hi:[1,0]
    v_pk_mul_f32 v[114:115], v[114:115], v[72:73] op_sel:[0,0] op_sel_hi:[1,0]
    v_pk_mul_f32 v[116:117], v[116:117], v[72:73] op_sel:[0,0] op_sel_hi:[1,0]
    v_pk_mul_f32 v[118:119], v[118:119], v[72:73] op_sel:[0,0] op_sel_hi:[1,0]
    v_cvt_pk_bf16_f32 v88, v112, v113
    v_cvt_pk_bf16_f32 v89, v114, v115
    v_cvt_pk_bf16_f32 v90, v116, v117
    v_cvt_pk_bf16_f32 v91, v118, v119
    ds_write_b64 v16, v[88:89] offset:0
    ds_write_b64 v16, v[90:91] offset:32
    v_pk_mul_f32 v[40:41], v[40:41], v[80:81] op_sel:[0,0] op_sel_hi:[1,0]
    v_pk_mul_f32 v[42:43], v[42:43], v[80:81] op_sel:[0,0] op_sel_hi:[1,0]
    v_pk_mul_f32 v[44:45], v[44:45], v[80:81] op_sel:[0,0] op_sel_hi:[1,0]
    v_pk_mul_f32 v[46:47], v[46:47], v[80:81] op_sel:[0,0] op_sel_hi:[1,0]
    v_cvt_pk_bf16_f32 v92, v40, v41
    v_cvt_pk_bf16_f32 v93, v42, v43
    v_cvt_pk_bf16_f32 v94, v44, v45
    v_cvt_pk_bf16_f32 v95, v46, v47
    ds_write_b64 v16, v[92:93] offset:64
    ds_write_b64 v16, v[94:95] offset:96
    v_pk_mul_f32 v[136:137], v[136:137], v[74:75] op_sel:[0,0] op_sel_hi:[1,0]
    v_pk_mul_f32 v[138:139], v[138:139], v[74:75] op_sel:[0,0] op_sel_hi:[1,0]
    v_pk_mul_f32 v[140:141], v[140:141], v[74:75] op_sel:[0,0] op_sel_hi:[1,0]
    v_pk_mul_f32 v[142:143], v[142:143], v[74:75] op_sel:[0,0] op_sel_hi:[1,0]
    v_cvt_pk_bf16_f32 v96, v136, v137
    v_cvt_pk_bf16_f32 v97, v138, v139
    v_cvt_pk_bf16_f32 v98, v140, v141
    v_cvt_pk_bf16_f32 v99, v142, v143
    ds_write_b64 v16, v[96:97] offset:2176
    ds_write_b64 v16, v[98:99] offset:2208
    v_pk_mul_f32 v[48:49], v[48:49], v[82:83] op_sel:[0,0] op_sel_hi:[1,0]
    v_pk_mul_f32 v[50:51], v[50:51], v[82:83] op_sel:[0,0] op_sel_hi:[1,0]
    v_pk_mul_f32 v[52:53], v[52:53], v[82:83] op_sel:[0,0] op_sel_hi:[1,0]
    v_pk_mul_f32 v[54:55], v[54:55], v[82:83] op_sel:[0,0] op_sel_hi:[1,0]
    v_cvt_pk_bf16_f32 v100, v48, v49
    v_cvt_pk_bf16_f32 v101, v50, v51
    v_cvt_pk_bf16_f32 v102, v52, v53
    v_cvt_pk_bf16_f32 v103, v54, v55
    ds_write_b64 v16, v[100:101] offset:2240
    ds_write_b64 v16, v[102:103] offset:2272
    v_pk_mul_f32 v[160:161], v[160:161], v[76:77] op_sel:[0,0] op_sel_hi:[1,0]
    v_pk_mul_f32 v[162:163], v[162:163], v[76:77] op_sel:[0,0] op_sel_hi:[1,0]
    v_pk_mul_f32 v[164:165], v[164:165], v[76:77] op_sel:[0,0] op_sel_hi:[1,0]
    v_pk_mul_f32 v[166:167], v[166:167], v[76:77] op_sel:[0,0] op_sel_hi:[1,0]
    v_cvt_pk_bf16_f32 v88, v160, v161
    v_cvt_pk_bf16_f32 v89, v162, v163
    v_cvt_pk_bf16_f32 v90, v164, v165
    v_cvt_pk_bf16_f32 v91, v166, v167
    ds_write_b64 v16, v[88:89] offset:4352
    ds_write_b64 v16, v[90:91] offset:4384
    v_pk_mul_f32 v[56:57], v[56:57], v[84:85] op_sel:[0,0] op_sel_hi:[1,0]
    v_pk_mul_f32 v[58:59], v[58:59], v[84:85] op_sel:[0,0] op_sel_hi:[1,0]
    v_pk_mul_f32 v[60:61], v[60:61], v[84:85] op_sel:[0,0] op_sel_hi:[1,0]
    v_pk_mul_f32 v[62:63], v[62:63], v[84:85] op_sel:[0,0] op_sel_hi:[1,0]
    v_cvt_pk_bf16_f32 v92, v56, v57
    v_cvt_pk_bf16_f32 v93, v58, v59
    v_cvt_pk_bf16_f32 v94, v60, v61
    v_cvt_pk_bf16_f32 v95, v62, v63
    ds_write_b64 v16, v[92:93] offset:4416
    ds_write_b64 v16, v[94:95] offset:4448
    v_pk_mul_f32 v[184:185], v[184:185], v[78:79] op_sel:[0,0] op_sel_hi:[1,0]
    v_pk_mul_f32 v[186:187], v[186:187], v[78:79] op_sel:[0,0] op_sel_hi:[1,0]
    v_pk_mul_f32 v[188:189], v[188:189], v[78:79] op_sel:[0,0] op_sel_hi:[1,0]
    v_pk_mul_f32 v[190:191], v[190:191], v[78:79] op_sel:[0,0] op_sel_hi:[1,0]
    v_cvt_pk_bf16_f32 v96, v184, v185
    v_cvt_pk_bf16_f32 v97, v186, v187
    v_cvt_pk_bf16_f32 v98, v188, v189
    v_cvt_pk_bf16_f32 v99, v190, v191
    ds_write_b64 v16, v[96:97] offset:6528
    ds_write_b64 v16, v[98:99] offset:6560
    v_pk_mul_f32 v[64:65], v[64:65], v[86:87] op_sel:[0,0] op_sel_hi:[1,0]
    v_pk_mul_f32 v[66:67], v[66:67], v[86:87] op_sel:[0,0] op_sel_hi:[1,0]
    v_pk_mul_f32 v[68:69], v[68:69], v[86:87] op_sel:[0,0] op_sel_hi:[1,0]
    v_pk_mul_f32 v[70:71], v[70:71], v[86:87] op_sel:[0,0] op_sel_hi:[1,0]
    v_cvt_pk_bf16_f32 v100, v64, v65
    v_cvt_pk_bf16_f32 v101, v66, v67
    v_cvt_pk_bf16_f32 v102, v68, v69
    v_cvt_pk_bf16_f32 v103, v70, v71
    ds_write_b64 v16, v[100:101] offset:6592
    ds_write_b64 v16, v[102:103] offset:6624
    s_lshl_b32 s35, s28, 12
    s_add_u32 s35, s35, 69632
    s_cmp_ge_u32 s28, 4
    s_cselect_b32 s34, 32768, 0
    s_add_u32 s35, s35, s34
    v_lshlrev_b32 v2, 4, v1
    v_add_u32 v16, s35, v2
    v_cvt_pk_bf16_f32 v56, v120, v121
    v_cvt_pk_bf16_f32 v57, v122, v123
    v_cvt_pk_bf16_f32 v58, v144, v145
    v_cvt_pk_bf16_f32 v59, v146, v147
    ds_write_b128 v16, v[56:59] offset:0
    v_cvt_pk_bf16_f32 v60, v124, v125
    v_cvt_pk_bf16_f32 v61, v126, v127
    v_cvt_pk_bf16_f32 v62, v148, v149
    v_cvt_pk_bf16_f32 v63, v150, v151
    ds_write_b128 v16, v[60:63] offset:1024
    v_cvt_pk_bf16_f32 v64, v168, v169
    v_cvt_pk_bf16_f32 v65, v170, v171
    v_cvt_pk_bf16_f32 v66, v192, v193
    v_cvt_pk_bf16_f32 v67, v194, v195
    ds_write_b128 v16, v[64:67] offset:2048
    v_cvt_pk_bf16_f32 v68, v172, v173
    v_cvt_pk_bf16_f32 v69, v174, v175
    v_cvt_pk_bf16_f32 v70, v196, v197
    v_cvt_pk_bf16_f32 v71, v198, v199
    ds_write_b128 v16, v[68:71] offset:3072
    v_mov_b32 v200, 0x3f803f80
    v_mov_b32 v201, 0x3f803f80
    v_mov_b32 v202, 0x3f803f80
    v_mov_b32 v203, 0x3f803f80
    s_and_b32 s34, s28, 1
    s_lshl_b32 s35, s34, 12
    s_add_u32 s35, s35, 69632
    v_add_u32 v16, s35, v2
    v_lshlrev_b32 v3, 2, v1
    s_mul_i32 s32, s31, 12288
    s_add_u32 s32, s32, 25165824
    s_lshr_b32 s35, s28, 1
    s_lshl_b32 s34, s35, 11
    s_add_u32 s34, s34, s32
    s_lshl_b32 s35, s35, 6
    s_add_u32 s35, s35, s32
    s_add_u32 s35, s35, 8192
    s_waitcnt lgkmcnt(0)
    s_barrier
    v_mov_b32 v7, 128
    ds_read_b32 v7, v7
    buffer_load_dword v20, v232, s[16:19], 0 offen offset:0 sc1
    buffer_load_dword v21, v232, s[16:19], 0 offen offset:128 sc1
    buffer_load_dword v22, v232, s[16:19], 0 offen offset:256 sc1
    buffer_load_dword v23, v232, s[16:19], 0 offen offset:384 sc1
    ds_read_b64_tr_b16 v[24:25], v17 offset:0
    ds_read_b64_tr_b16 v[26:27], v17 offset:2176
    ds_read_b128 v[112:115], v16 offset:0
    ds_read_b128 v[116:119], v16 offset:1024
    ds_read_b64_tr_b16 v[28:29], v17 offset:4352
    ds_read_b64_tr_b16 v[30:31], v17 offset:6528
    ds_read_b128 v[120:123], v16 offset:2048
    ds_read_b128 v[124:127], v16 offset:3072
    ds_read_b64_tr_b16 v[32:33], v17 offset:17408
    ds_read_b64_tr_b16 v[34:35], v17 offset:19584
    ds_read_b128 v[136:139], v16 offset:8192
    ds_read_b128 v[140:143], v16 offset:9216
    ds_read_b64_tr_b16 v[36:37], v17 offset:21760
    ds_read_b64_tr_b16 v[38:39], v17 offset:23936
    ds_read_b128 v[144:147], v16 offset:10240
    ds_read_b128 v[148:151], v16 offset:11264
    s_waitcnt lgkmcnt(12)
    v_mfma_f32_16x16x32_bf16 v[88:91], v[112:115], v[24:27], 0
    v_mfma_f32_16x16x32_bf16 v[92:95], v[116:119], v[24:27], 0
    v_mfma_f32_16x16x32_bf16 v[96:99], v[200:203], v[24:27], 0
    s_waitcnt lgkmcnt(8)
    v_mfma_f32_16x16x32_bf16 v[88:91], v[120:123], v[28:31], v[88:91]
    v_mfma_f32_16x16x32_bf16 v[92:95], v[124:127], v[28:31], v[92:95]
    v_mfma_f32_16x16x32_bf16 v[96:99], v[200:203], v[28:31], v[96:99]
    s_waitcnt lgkmcnt(4)
    v_mfma_f32_16x16x32_bf16 v[88:91], v[136:139], v[32:35], v[88:91]
    v_mfma_f32_16x16x32_bf16 v[92:95], v[140:143], v[32:35], v[92:95]
    v_mfma_f32_16x16x32_bf16 v[96:99], v[200:203], v[32:35], v[96:99]
    s_waitcnt lgkmcnt(0)
    v_mfma_f32_16x16x32_bf16 v[88:91], v[144:147], v[36:39], v[88:91]
    v_mfma_f32_16x16x32_bf16 v[92:95], v[148:151], v[36:39], v[92:95]
    v_mfma_f32_16x16x32_bf16 v[96:99], v[200:203], v[36:39], v[96:99]
    ds_read_b64_tr_b16 v[40:41], v17 offset:34816
    ds_read_b64_tr_b16 v[42:43], v17 offset:36992
    ds_read_b128 v[160:163], v16 offset:49152
    ds_read_b128 v[164:167], v16 offset:50176
    ds_read_b64_tr_b16 v[44:45], v17 offset:39168
    ds_read_b64_tr_b16 v[46:47], v17 offset:41344
    ds_read_b128 v[168:171], v16 offset:51200
    ds_read_b128 v[172:175], v16 offset:52224
    ds_read_b64_tr_b16 v[48:49], v17 offset:52224
    ds_read_b64_tr_b16 v[50:51], v17 offset:54400
    ds_read_b128 v[184:187], v16 offset:57344
    ds_read_b128 v[188:191], v16 offset:58368
    ds_read_b64_tr_b16 v[52:53], v17 offset:56576
    ds_read_b64_tr_b16 v[54:55], v17 offset:58752
    ds_read_b128 v[192:195], v16 offset:59392
    ds_read_b128 v[196:199], v16 offset:60416
    s_waitcnt lgkmcnt(12)
    v_mfma_f32_16x16x32_bf16 v[88:91], v[160:163], v[40:43], v[88:91]
    v_mfma_f32_16x16x32_bf16 v[92:95], v[164:167], v[40:43], v[92:95]
    v_mfma_f32_16x16x32_bf16 v[96:99], v[200:203], v[40:43], v[96:99]
    s_waitcnt lgkmcnt(8)
    v_mfma_f32_16x16x32_bf16 v[88:91], v[168:171], v[44:47], v[88:91]
    v_mfma_f32_16x16x32_bf16 v[92:95], v[172:175], v[44:47], v[92:95]
    v_mfma_f32_16x16x32_bf16 v[96:99], v[200:203], v[44:47], v[96:99]
    s_waitcnt lgkmcnt(4)
    v_mfma_f32_16x16x32_bf16 v[88:91], v[184:187], v[48:51], v[88:91]
    v_mfma_f32_16x16x32_bf16 v[92:95], v[188:191], v[48:51], v[92:95]
    v_mfma_f32_16x16x32_bf16 v[96:99], v[200:203], v[48:51], v[96:99]
    s_waitcnt lgkmcnt(0)
    v_mfma_f32_16x16x32_bf16 v[88:91], v[192:195], v[52:55], v[88:91]
    v_mfma_f32_16x16x32_bf16 v[92:95], v[196:199], v[52:55], v[92:95]
    v_mfma_f32_16x16x32_bf16 v[96:99], v[200:203], v[52:55], v[96:99]
    v_readfirstlane_b32 s51, v7
    s_nop 6
    buffer_atomic_add_f32 v88, v3, s[16:19], s34 offen offset:0
    buffer_atomic_add_f32 v89, v3, s[16:19], s34 offen offset:256
    buffer_atomic_add_f32 v90, v3, s[16:19], s34 offen offset:512
    buffer_atomic_add_f32 v91, v3, s[16:19], s34 offen offset:768
    buffer_atomic_add_f32 v92, v3, s[16:19], s34 offen offset:1024
    buffer_atomic_add_f32 v93, v3, s[16:19], s34 offen offset:1280
    buffer_atomic_add_f32 v94, v3, s[16:19], s34 offen offset:1536
    buffer_atomic_add_f32 v95, v3, s[16:19], s34 offen offset:1792
    s_mov_b64 exec, 0xffff
    buffer_atomic_add_f32 v96, v3, s[16:19], s35 offen
    s_mov_b64 exec, -1
    s_lshl_b32 s34, s38, 7
    s_add_u32 s34, s34, 41947136
    v_lshlrev_b32 v17, 4, v4
    v_lshl_add_u32 v16, v6, 8, v17
    v_lshl_add_u32 v16, v5, 6, v16
    v_cvt_pk_bf16_f32 v24, v104, v105
    v_cvt_pk_bf16_f32 v25, v106, v107
    v_cvt_pk_bf16_f32 v26, v108, v109
    v_cvt_pk_bf16_f32 v27, v110, v111
    v_cvt_pk_bf16_f32 v28, v128, v129
    v_cvt_pk_bf16_f32 v29, v130, v131
    v_cvt_pk_bf16_f32 v30, v132, v133
    v_cvt_pk_bf16_f32 v31, v134, v135
    v_cvt_pk_bf16_f32 v32, v152, v153
    v_cvt_pk_bf16_f32 v33, v154, v155
    v_cvt_pk_bf16_f32 v34, v156, v157
    v_cvt_pk_bf16_f32 v35, v158, v159
    v_cvt_pk_bf16_f32 v36, v176, v177
    v_cvt_pk_bf16_f32 v37, v178, v179
    v_cvt_pk_bf16_f32 v38, v180, v181
    v_cvt_pk_bf16_f32 v39, v182, v183
    s_nop 1
    v_mfma_f32_16x16x32_bf16 v[40:43], v[8:11], v[24:27], 0
    v_mfma_f32_16x16x32_bf16 v[44:47], v[12:15], v[24:27], 0
    v_mfma_f32_16x16x32_bf16 v[48:51], v[8:11], v[28:31], 0
    v_mfma_f32_16x16x32_bf16 v[52:55], v[12:15], v[28:31], 0
    v_mfma_f32_16x16x32_bf16 v[56:59], v[8:11], v[32:35], 0
    v_mfma_f32_16x16x32_bf16 v[60:63], v[12:15], v[32:35], 0
    v_mfma_f32_16x16x32_bf16 v[64:67], v[8:11], v[36:39], 0
    v_mfma_f32_16x16x32_bf16 v[68:71], v[12:15], v[36:39], 0
    s_nop 3
    v_max3_f32 v72, v40, v41, v42
    v_max3_f32 v72, v72, v43, v44
    v_max3_f32 v72, v72, v45, v46
    v_max_f32 v72, v72, v47
    v_min3_f32 v80, v40, v41, v42
    v_min3_f32 v80, v80, v43, v44
    v_min3_f32 v80, v80, v45, v46
    v_min_f32 v80, v80, v47
    v_max3_f32 v74, v48, v49, v50
    v_max3_f32 v74, v74, v51, v52
    v_max3_f32 v74, v74, v53, v54
    v_max_f32 v74, v74, v55
    v_min3_f32 v82, v48, v49, v50
    v_min3_f32 v82, v82, v51, v52
    v_min3_f32 v82, v82, v53, v54
    v_min_f32 v82, v82, v55
    v_max3_f32 v76, v56, v57, v58
    v_max3_f32 v76, v76, v59, v60
    v_max3_f32 v76, v76, v61, v62
    v_max_f32 v76, v76, v63
    v_min3_f32 v84, v56, v57, v58
    v_min3_f32 v84, v84, v59, v60
    v_min3_f32 v84, v84, v61, v62
    v_min_f32 v84, v84, v63
    s_nop 0
    v_max3_f32 v78, v64, v65, v66
    v_max3_f32 v78, v78, v67, v68
    v_max3_f32 v78, v78, v69, v70
    v_max_f32 v78, v78, v71
    v_min3_f32 v86, v64, v65, v66
    v_min3_f32 v86, v86, v67, v68
    v_min3_f32 v86, v86, v69, v70
    v_min_f32 v86, v86, v71
    s_nop 1
    v_permlane32_swap_b32 v72, v74
    v_permlane32_swap_b32 v76, v78
    v_permlane32_swap_b32 v80, v82
    v_permlane32_swap_b32 v84, v86
    v_max_f32 v72, v72, v74
    v_max_f32 v76, v76, v78
    v_min_f32 v80, v80, v82
    v_min_f32 v84, v84, v86
    s_nop 0
    v_permlane16_swap_b32 v72, v76
    v_permlane16_swap_b32 v80, v84
    v_max_f32 v72, v72, v76
    v_min_f32 v80, v80, v84
    v_mul_f32 v72, s30, v72
    v_mul_f32 v80, s30, v80
    s_nop 0
    v_mov_b32 v76, v72
    v_mov_b32 v84, v80
    s_nop 0
    v_permlane16_swap_b32 v72, v76
    v_permlane16_swap_b32 v80, v84
    v_mov_b32 v74, v72
    v_mov_b32 v78, v76
    v_mov_b32 v82, v80
    v_mov_b32 v86, v84
    v_permlane32_swap_b32 v72, v74
    v_permlane32_swap_b32 v76, v78
    v_permlane32_swap_b32 v80, v82
    v_permlane32_swap_b32 v84, v86
    v_pk_fma_f32 v[104:105], v[40:41], s[30:31], v[72:73] op_sel:[0,0,0] op_sel_hi:[1,0,0] neg_lo:[0,0,1] neg_hi:[0,0,1]
    v_pk_fma_f32 v[40:41], v[40:41], s[30:31], v[80:81] op_sel:[0,0,0] op_sel_hi:[1,0,0] neg_lo:[1,0,0] neg_hi:[1,0,0]
    v_exp_f32 v104, v104
    v_exp_f32 v105, v105
    v_exp_f32 v40, v40
    v_exp_f32 v41, v41
    v_pk_fma_f32 v[106:107], v[42:43], s[30:31], v[72:73] op_sel:[0,0,0] op_sel_hi:[1,0,0] neg_lo:[0,0,1] neg_hi:[0,0,1]
    v_pk_fma_f32 v[42:43], v[42:43], s[30:31], v[80:81] op_sel:[0,0,0] op_sel_hi:[1,0,0] neg_lo:[1,0,0] neg_hi:[1,0,0]
    v_exp_f32 v106, v106
    v_exp_f32 v107, v107
    v_exp_f32 v42, v42
    v_exp_f32 v43, v43
    v_pk_fma_f32 v[108:109], v[44:45], s[30:31], v[72:73] op_sel:[0,0,0] op_sel_hi:[1,0,0] neg_lo:[0,0,1] neg_hi:[0,0,1]
    v_pk_fma_f32 v[44:45], v[44:45], s[30:31], v[80:81] op_sel:[0,0,0] op_sel_hi:[1,0,0] neg_lo:[1,0,0] neg_hi:[1,0,0]
    v_exp_f32 v108, v108
    v_exp_f32 v109, v109
    v_exp_f32 v44, v44
    v_exp_f32 v45, v45
    v_pk_add_f32 v[24:25], v[104:105], v[106:107]
    v_pk_add_f32 v[26:27], v[40:41], v[42:43]
    v_pk_fma_f32 v[110:111], v[46:47], s[30:31], v[72:73] op_sel:[0,0,0] op_sel_hi:[1,0,0] neg_lo:[0,0,1] neg_hi:[0,0,1]
    v_pk_fma_f32 v[46:47], v[46:47], s[30:31], v[80:81] op_sel:[0,0,0] op_sel_hi:[1,0,0] neg_lo:[1,0,0] neg_hi:[1,0,0]
    v_exp_f32 v110, v110
    v_exp_f32 v111, v111
    v_exp_f32 v46, v46
    v_exp_f32 v47, v47
    v_pk_add_f32 v[24:25], v[24:25], v[108:109]
    v_pk_add_f32 v[26:27], v[26:27], v[44:45]
    v_pk_add_f32 v[24:25], v[24:25], v[110:111]
    v_pk_add_f32 v[26:27], v[26:27], v[46:47]
    v_add_f32 v72, v24, v25
    v_add_f32 v80, v26, v27
    v_pk_fma_f32 v[128:129], v[48:49], s[30:31], v[74:75] op_sel:[0,0,0] op_sel_hi:[1,0,0] neg_lo:[0,0,1] neg_hi:[0,0,1]
    v_pk_fma_f32 v[48:49], v[48:49], s[30:31], v[82:83] op_sel:[0,0,0] op_sel_hi:[1,0,0] neg_lo:[1,0,0] neg_hi:[1,0,0]
    v_exp_f32 v128, v128
    v_exp_f32 v129, v129
    v_exp_f32 v48, v48
    v_exp_f32 v49, v49
    v_pk_fma_f32 v[130:131], v[50:51], s[30:31], v[74:75] op_sel:[0,0,0] op_sel_hi:[1,0,0] neg_lo:[0,0,1] neg_hi:[0,0,1]
    v_pk_fma_f32 v[50:51], v[50:51], s[30:31], v[82:83] op_sel:[0,0,0] op_sel_hi:[1,0,0] neg_lo:[1,0,0] neg_hi:[1,0,0]
    v_exp_f32 v130, v130
    v_exp_f32 v131, v131
    v_exp_f32 v50, v50
    v_exp_f32 v51, v51
    v_pk_fma_f32 v[132:133], v[52:53], s[30:31], v[74:75] op_sel:[0,0,0] op_sel_hi:[1,0,0] neg_lo:[0,0,1] neg_hi:[0,0,1]
    v_pk_fma_f32 v[52:53], v[52:53], s[30:31], v[82:83] op_sel:[0,0,0] op_sel_hi:[1,0,0] neg_lo:[1,0,0] neg_hi:[1,0,0]
    v_exp_f32 v132, v132
    v_exp_f32 v133, v133
    v_exp_f32 v52, v52
    v_exp_f32 v53, v53
    v_pk_add_f32 v[24:25], v[128:129], v[130:131]
    v_pk_add_f32 v[26:27], v[48:49], v[50:51]
    v_pk_fma_f32 v[134:135], v[54:55], s[30:31], v[74:75] op_sel:[0,0,0] op_sel_hi:[1,0,0] neg_lo:[0,0,1] neg_hi:[0,0,1]
    v_pk_fma_f32 v[54:55], v[54:55], s[30:31], v[82:83] op_sel:[0,0,0] op_sel_hi:[1,0,0] neg_lo:[1,0,0] neg_hi:[1,0,0]
    v_exp_f32 v134, v134
    v_exp_f32 v135, v135
    v_exp_f32 v54, v54
    v_exp_f32 v55, v55
    v_pk_add_f32 v[24:25], v[24:25], v[132:133]
    v_pk_add_f32 v[26:27], v[26:27], v[52:53]
    v_pk_add_f32 v[24:25], v[24:25], v[134:135]
    v_pk_add_f32 v[26:27], v[26:27], v[54:55]
    v_add_f32 v74, v24, v25
    v_add_f32 v82, v26, v27
    s_waitcnt vmcnt(0)
    s_barrier
    s_cmp_lg_u32 s28, 0
    s_cbranch_scc1 L1q_nosig
    v_mov_b32 v3, s51
    s_lshl_b32 s35, s37, 2
    s_add_u32 s35, s35, s34
    s_mov_b64 exec, 1
    buffer_store_dword v3, v19, s[16:19], s35 offen sc1
    s_mov_b64 exec, -1
L1q_nosig:
    v_and_b32 v19, 7, v1
    v_lshlrev_b32 v19, 2, v19
    v_pk_fma_f32 v[152:153], v[56:57], s[30:31], v[76:77] op_sel:[0,0,0] op_sel_hi:[1,0,0] neg_lo:[0,0,1] neg_hi:[0,0,1]
    v_pk_fma_f32 v[56:57], v[56:57], s[30:31], v[84:85] op_sel:[0,0,0] op_sel_hi:[1,0,0] neg_lo:[1,0,0] neg_hi:[1,0,0]
    v_exp_f32 v152, v152
    v_exp_f32 v153, v153
    v_exp_f32 v56, v56
    v_exp_f32 v57, v57
    v_pk_fma_f32 v[154:155], v[58:59], s[30:31], v[76:77] op_sel:[0,0,0] op_sel_hi:[1,0,0] neg_lo:[0,0,1] neg_hi:[0,0,1]
    v_pk_fma_f32 v[58:59], v[58:59], s[30:31], v[84:85] op_sel:[0,0,0] op_sel_hi:[1,0,0] neg_lo:[1,0,0] neg_hi:[1,0,0]
    v_exp_f32 v154, v154
    v_exp_f32 v155, v155
    v_exp_f32 v58, v58
    v_exp_f32 v59, v59
    v_pk_fma_f32 v[156:157], v[60:61], s[30:31], v[76:77] op_sel:[0,0,0] op_sel_hi:[1,0,0] neg_lo:[0,0,1] neg_hi:[0,0,1]
    v_pk_fma_f32 v[60:61], v[60:61], s[30:31], v[84:85] op_sel:[0,0,0] op_sel_hi:[1,0,0] neg_lo:[1,0,0] neg_hi:[1,0,0]
    v_exp_f32 v156, v156
    v_exp_f32 v157, v157
    v_exp_f32 v60, v60
    v_exp_f32 v61, v61
    v_pk_add_f32 v[24:25], v[152:153], v[154:155]
    v_pk_add_f32 v[26:27], v[56:57], v[58:59]
    v_pk_fma_f32 v[158:159], v[62:63], s[30:31], v[76:77] op_sel:[0,0,0] op_sel_hi:[1,0,0] neg_lo:[0,0,1] neg_hi:[0,0,1]
    v_pk_fma_f32 v[62:63], v[62:63], s[30:31], v[84:85] op_sel:[0,0,0] op_sel_hi:[1,0,0] neg_lo:[1,0,0] neg_hi:[1,0,0]
    v_exp_f32 v158, v158
    v_exp_f32 v159, v159
    v_exp_f32 v62, v62
    v_exp_f32 v63, v63
    v_pk_add_f32 v[24:25], v[24:25], v[156:157]
    v_pk_add_f32 v[26:27], v[26:27], v[60:61]
    v_pk_add_f32 v[24:25], v[24:25], v[158:159]
    v_pk_add_f32 v[26:27], v[26:27], v[62:63]
    v_add_f32 v76, v24, v25
    v_add_f32 v84, v26, v27
    v_pk_fma_f32 v[176:177], v[64:65], s[30:31], v[78:79] op_sel:[0,0,0] op_sel_hi:[1,0,0] neg_lo:[0,0,1] neg_hi:[0,0,1]
    v_pk_fma_f32 v[64:65], v[64:65], s[30:31], v[86:87] op_sel:[0,0,0] op_sel_hi:[1,0,0] neg_lo:[1,0,0] neg_hi:[1,0,0]
    v_exp_f32 v176, v176
    v_exp_f32 v177, v177
    v_exp_f32 v64, v64
    v_exp_f32 v65, v65
    v_pk_fma_f32 v[178:179], v[66:67], s[30:31], v[78:79] op_sel:[0,0,0] op_sel_hi:[1,0,0] neg_lo:[0,0,1] neg_hi:[0,0,1]
    v_pk_fma_f32 v[66:67], v[66:67], s[30:31], v[86:87] op_sel:[0,0,0] op_sel_hi:[1,0,0] neg_lo:[1,0,0] neg_hi:[1,0,0]
    v_exp_f32 v178, v178
    v_exp_f32 v179, v179
    v_exp_f32 v66, v66
    v_exp_f32 v67, v67
    v_pk_fma_f32 v[180:181], v[68:69], s[30:31], v[78:79] op_sel:[0,0,0] op_sel_hi:[1,0,0] neg_lo:[0,0,1] neg_hi:[0,0,1]
    v_pk_fma_f32 v[68:69], v[68:69], s[30:31], v[86:87] op_sel:[0,0,0] op_sel_hi:[1,0,0] neg_lo:[1,0,0] neg_hi:[1,0,0]
    v_exp_f32 v180, v180
    v_exp_f32 v181, v181
    v_exp_f32 v68, v68
    v_exp_f32 v69, v69
    v_pk_add_f32 v[24:25], v[176:177], v[178:179]
    v_pk_add_f32 v[26:27], v[64:65], v[66:67]
    v_pk_fma_f32 v[182:183], v[70:71], s[30:31], v[78:79] op_sel:[0,0,0] op_sel_hi:[1,0,0] neg_lo:[0,0,1] neg_hi:[0,0,1]
    v_pk_fma_f32 v[70:71], v[70:71], s[30:31], v[86:87] op_sel:[0,0,0] op_sel_hi:[1,0,0] neg_lo:[1,0,0] neg_hi:[1,0,0]
    v_exp_f32 v182, v182
    v_exp_f32 v183, v183
    v_exp_f32 v70, v70
    v_exp_f32 v71, v71
    v_pk_add_f32 v[24:25], v[24:25], v[180:181]
    v_pk_add_f32 v[26:27], v[26:27], v[68:69]
    v_pk_add_f32 v[24:25], v[24:25], v[182:183]
    v_pk_add_f32 v[26:27], v[26:27], v[70:71]
    v_add_f32 v78, v24, v25
    v_add_f32 v86, v26, v27
    s_nop 1
    v_permlane32_swap_b32 v72, v74
    v_permlane32_swap_b32 v76, v78
    v_permlane32_swap_b32 v80, v82
    v_permlane32_swap_b32 v84, v86
    v_add_f32 v72, v72, v74
    v_add_f32 v76, v76, v78
    v_add_f32 v80, v80, v82
    v_add_f32 v84, v84, v86
    s_nop 0
    v_permlane16_swap_b32 v72, v76
    v_permlane16_swap_b32 v80, v84
    v_add_f32 v72, v72, v76
    v_add_f32 v80, v80, v84
    v_rcp_f32 v72, v72
    v_rcp_f32 v80, v80
    s_nop 0
    v_mov_b32 v76, v72
    v_mov_b32 v84, v80
    s_nop 0
    v_permlane16_swap_b32 v72, v76
    v_permlane16_swap_b32 v80, v84
    v_mov_b32 v74, v72
    v_mov_b32 v78, v76
    v_mov_b32 v82, v80
    v_mov_b32 v86, v84
    v_permlane32_swap_b32 v72, v74
    v_permlane32_swap_b32 v76, v78
    v_permlane32_swap_b32 v80, v82
    v_permlane32_swap_b32 v84, v86
    v_pk_mul_f32 v[104:105], v[104:105], v[72:73] op_sel:[0,0] op_sel_hi:[1,0]
    v_pk_mul_f32 v[106:107], v[106:107], v[72:73] op_sel:[0,0] op_sel_hi:[1,0]
    v_pk_mul_f32 v[108:109], v[108:109], v[72:73] op_sel:[0,0] op_sel_hi:[1,0]
    v_pk_mul_f32 v[110:111], v[110:111], v[72:73] op_sel:[0,0] op_sel_hi:[1,0]
    v_cvt_pk_bf16_f32 v200, v104, v105
    v_cvt_pk_bf16_f32 v201, v106, v107
    v_cvt_pk_bf16_f32 v202, v108, v109
    v_cvt_pk_bf16_f32 v203, v110, v111
    v_pk_mul_f32 v[40:41], v[40:41], v[80:81] op_sel:[0,0] op_sel_hi:[1,0]
    v_pk_mul_f32 v[42:43], v[42:43], v[80:81] op_sel:[0,0] op_sel_hi:[1,0]
    v_pk_mul_f32 v[44:45], v[44:45], v[80:81] op_sel:[0,0] op_sel_hi:[1,0]
    v_pk_mul_f32 v[46:47], v[46:47], v[80:81] op_sel:[0,0] op_sel_hi:[1,0]
    v_cvt_pk_bf16_f32 v204, v40, v41
    v_cvt_pk_bf16_f32 v205, v42, v43
    v_cvt_pk_bf16_f32 v206, v44, v45
    v_cvt_pk_bf16_f32 v207, v46, v47
    v_pk_mul_f32 v[128:129], v[128:129], v[74:75] op_sel:[0,0] op_sel_hi:[1,0]
    v_pk_mul_f32 v[130:131], v[130:131], v[74:75] op_sel:[0,0] op_sel_hi:[1,0]
    v_pk_mul_f32 v[132:133], v[132:133], v[74:75] op_sel:[0,0] op_sel_hi:[1,0]
    v_pk_mul_f32 v[134:135], v[134:135], v[74:75] op_sel:[0,0] op_sel_hi:[1,0]
    v_cvt_pk_bf16_f32 v208, v128, v129
    v_cvt_pk_bf16_f32 v209, v130, v131
    v_cvt_pk_bf16_f32 v210, v132, v133
    v_cvt_pk_bf16_f32 v211, v134, v135
    v_pk_mul_f32 v[48:49], v[48:49], v[82:83] op_sel:[0,0] op_sel_hi:[1,0]
    v_pk_mul_f32 v[50:51], v[50:51], v[82:83] op_sel:[0,0] op_sel_hi:[1,0]
    v_pk_mul_f32 v[52:53], v[52:53], v[82:83] op_sel:[0,0] op_sel_hi:[1,0]
    v_pk_mul_f32 v[54:55], v[54:55], v[82:83] op_sel:[0,0] op_sel_hi:[1,0]
    v_cvt_pk_bf16_f32 v212, v48, v49
    v_cvt_pk_bf16_f32 v213, v50, v51
    v_cvt_pk_bf16_f32 v214, v52, v53
    v_cvt_pk_bf16_f32 v215, v54, v55
    v_pk_mul_f32 v[152:153], v[152:153], v[76:77] op_sel:[0,0] op_sel_hi:[1,0]
    v_pk_mul_f32 v[154:155], v[154:155], v[76:77] op_sel:[0,0] op_sel_hi:[1,0]
    v_pk_mul_f32 v[156:157], v[156:157], v[76:77] op_sel:[0,0] op_sel_hi:[1,0]
    v_pk_mul_f32 v[158:159], v[158:159], v[76:77] op_sel:[0,0] op_sel_hi:[1,0]
    v_cvt_pk_bf16_f32 v216, v152, v153
    v_cvt_pk_bf16_f32 v217, v154, v155
    v_cvt_pk_bf16_f32 v218, v156, v157
    v_cvt_pk_bf16_f32 v219, v158, v159
    v_pk_mul_f32 v[56:57], v[56:57], v[84:85] op_sel:[0,0] op_sel_hi:[1,0]
    v_pk_mul_f32 v[58:59], v[58:59], v[84:85] op_sel:[0,0] op_sel_hi:[1,0]
    v_pk_mul_f32 v[60:61], v[60:61], v[84:85] op_sel:[0,0] op_sel_hi:[1,0]
    v_pk_mul_f32 v[62:63], v[62:63], v[84:85] op_sel:[0,0] op_sel_hi:[1,0]
    v_cvt_pk_bf16_f32 v220, v56, v57
    v_cvt_pk_bf16_f32 v221, v58, v59
    v_cvt_pk_bf16_f32 v222, v60, v61
    v_cvt_pk_bf16_f32 v223, v62, v63
    v_pk_mul_f32 v[176:177], v[176:177], v[78:79] op_sel:[0,0] op_sel_hi:[1,0]
    v_pk_mul_f32 v[178:179], v[178:179], v[78:79] op_sel:[0,0] op_sel_hi:[1,0]
    v_pk_mul_f32 v[180:181], v[180:181], v[78:79] op_sel:[0,0] op_sel_hi:[1,0]
    v_pk_mul_f32 v[182:183], v[182:183], v[78:79] op_sel:[0,0] op_sel_hi:[1,0]
    v_cvt_pk_bf16_f32 v224, v176, v177
    v_cvt_pk_bf16_f32 v225, v178, v179
    v_cvt_pk_bf16_f32 v226, v180, v181
    v_cvt_pk_bf16_f32 v227, v182, v183
    v_pk_mul_f32 v[64:65], v[64:65], v[86:87] op_sel:[0,0] op_sel_hi:[1,0]
    v_pk_mul_f32 v[66:67], v[66:67], v[86:87] op_sel:[0,0] op_sel_hi:[1,0]
    v_pk_mul_f32 v[68:69], v[68:69], v[86:87] op_sel:[0,0] op_sel_hi:[1,0]
    v_pk_mul_f32 v[70:71], v[70:71], v[86:87] op_sel:[0,0] op_sel_hi:[1,0]
    v_cvt_pk_bf16_f32 v228, v64, v65
    v_cvt_pk_bf16_f32 v229, v66, v67
    v_cvt_pk_bf16_f32 v230, v68, v69
    v_cvt_pk_bf16_f32 v231, v70, v71
    s_cmp_lg_u32 s28, 0
    s_cbranch_scc1 Lq_kv
    s_mov_b32 s35, 0
Lp_kv:
    buffer_load_dword v3, v19, s[16:19], s34 offen sc1
    s_add_u32 s35, s35, 1
    s_waitcnt vmcnt(0)
    v_cmp_ne_u32 vcc, s51, v3
    s_cbranch_vccz Lq_kv
    s_cmp_ge_u32 s35, 0x40000
    s_cbranch_scc1 Lq_kv
    s_sleep 1
    s_branch Lp_kv
Lq_kv:
    s_barrier
    s_add_u32 s34, s32, 4096
    s_add_u32 s35, s32, 8192
    buffer_load_dwordx4 v[112:115], v16, s[16:19], s32 offen offset:0 sc1
    buffer_load_dwordx4 v[120:123], v16, s[16:19], s32 offen offset:2048 sc1
    buffer_load_dwordx4 v[116:119], v16, s[16:19], s32 offen offset:1024 sc1
    buffer_load_dwordx4 v[124:127], v16, s[16:19], s32 offen offset:3072 sc1
    buffer_load_dwordx4 v[160:163], v17, s[16:19], s35 offen offset:0 sc1
    buffer_load_dwordx4 v[164:167], v17, s[16:19], s35 offen offset:64 sc1
    buffer_load_dwordx4 v[136:139], v16, s[16:19], s34 offen offset:0 sc1
    buffer_load_dwordx4 v[144:147], v16, s[16:19], s34 offen offset:2048 sc1
    buffer_load_dwordx4 v[140:143], v16, s[16:19], s34 offen offset:1024 sc1
    buffer_load_dwordx4 v[148:151], v16, s[16:19], s34 offen offset:3072 sc1
    buffer_load_dwordx4 v[168:171], v17, s[16:19], s35 offen offset:128 sc1
    buffer_load_dwordx4 v[172:175], v17, s[16:19], s35 offen offset:192 sc1
    s_waitcnt vmcnt(6)
    v_cvt_pk_bf16_f32 v72, v112, v113
    v_cvt_pk_bf16_f32 v73, v114, v115
    v_cvt_pk_bf16_f32 v74, v120, v121
    v_cvt_pk_bf16_f32 v75, v122, v123
    v_cvt_pk_bf16_f32 v80, v116, v117
    v_cvt_pk_bf16_f32 v81, v118, v119
    v_cvt_pk_bf16_f32 v82, v124, v125
    v_cvt_pk_bf16_f32 v83, v126, v127
    v_cvt_pk_bf16_f32 v88, v160, v161
    v_cvt_pk_bf16_f32 v89, v162, v163
    v_cvt_pk_bf16_f32 v90, v164, v165
    v_cvt_pk_bf16_f32 v91, v166, v167
    s_nop 0
    v_mfma_f32_16x16x32_bf16 v[24:27], v[72:75], v[200:203], 0
    v_mfma_f32_16x16x32_bf16 v[36:39], v[72:75], v[208:211], 0
    v_mfma_f32_16x16x32_bf16 v[48:51], v[72:75], v[216:219], 0
    v_mfma_f32_16x16x32_bf16 v[60:63], v[72:75], v[224:227], 0
    v_mfma_f32_16x16x32_bf16 v[28:31], v[80:83], v[200:203], 0
    v_mfma_f32_16x16x32_bf16 v[40:43], v[80:83], v[208:211], 0
    v_mfma_f32_16x16x32_bf16 v[52:55], v[80:83], v[216:219], 0
    v_mfma_f32_16x16x32_bf16 v[64:67], v[80:83], v[224:227], 0
    v_mfma_f32_16x16x32_bf16 v[32:35], v[88:91], v[200:203], 0
    v_mfma_f32_16x16x32_bf16 v[44:47], v[88:91], v[208:211], 0
    v_mfma_f32_16x16x32_bf16 v[56:59], v[88:91], v[216:219], 0
    v_mfma_f32_16x16x32_bf16 v[68:71], v[88:91], v[224:227], 0
    s_waitcnt vmcnt(0)
    v_cvt_pk_bf16_f32 v76, v136, v137
    v_cvt_pk_bf16_f32 v77, v138, v139
    v_cvt_pk_bf16_f32 v78, v144, v145
    v_cvt_pk_bf16_f32 v79, v146, v147
    v_cvt_pk_bf16_f32 v84, v140, v141
    v_cvt_pk_bf16_f32 v85, v142, v143
    v_cvt_pk_bf16_f32 v86, v148, v149
    v_cvt_pk_bf16_f32 v87, v150, v151
    v_cvt_pk_bf16_f32 v92, v168, v169
    v_cvt_pk_bf16_f32 v93, v170, v171
    v_cvt_pk_bf16_f32 v94, v172, v173
    v_cvt_pk_bf16_f32 v95, v174, v175
    s_nop 0
    v_mfma_f32_16x16x32_bf16 v[24:27], v[76:79], v[204:207], v[24:27]
    v_mfma_f32_16x16x32_bf16 v[36:39], v[76:79], v[212:215], v[36:39]
    v_mfma_f32_16x16x32_bf16 v[48:51], v[76:79], v[220:223], v[48:51]
    v_mfma_f32_16x16x32_bf16 v[60:63], v[76:79], v[228:231], v[60:63]
    v_mfma_f32_16x16x32_bf16 v[28:31], v[84:87], v[204:207], v[28:31]
    v_mfma_f32_16x16x32_bf16 v[40:43], v[84:87], v[212:215], v[40:43]
    v_mfma_f32_16x16x32_bf16 v[52:55], v[84:87], v[220:223], v[52:55]
    v_mfma_f32_16x16x32_bf16 v[64:67], v[84:87], v[228:231], v[64:67]
    v_mfma_f32_16x16x32_bf16 v[32:35], v[92:95], v[204:207], v[32:35]
    v_mfma_f32_16x16x32_bf16 v[44:47], v[92:95], v[212:215], v[44:47]
    v_mfma_f32_16x16x32_bf16 v[56:59], v[92:95], v[220:223], v[56:59]
    v_mfma_f32_16x16x32_bf16 v[68:71], v[92:95], v[228:231], v[68:71]
    s_nop 7
    v_add_f32 v96, 0x358637bd, v32
    v_add_f32 v98, 0x358637bd, v44
    v_add_f32 v100, 0x358637bd, v56
    v_add_f32 v102, 0x358637bd, v68
    v_rcp_f32 v96, v96
    v_rcp_f32 v98, v98
    v_rcp_f32 v100, v100
    v_rcp_f32 v102, v102
    s_nop 0
    v_mul_f32 v96, v96, v20
    v_mul_f32 v98, v98, v21
    v_mul_f32 v100, v100, v22
    v_mul_f32 v102, v102, v23
    v_pk_mul_f32 v[24:25], v[24:25], v[96:97] op_sel:[0,0] op_sel_hi:[1,0]
    v_pk_mul_f32 v[26:27], v[26:27], v[96:97] op_sel:[0,0] op_sel_hi:[1,0]
    v_pk_mul_f32 v[28:29], v[28:29], v[96:97] op_sel:[0,0] op_sel_hi:[1,0]
    v_pk_mul_f32 v[30:31], v[30:31], v[96:97] op_sel:[0,0] op_sel_hi:[1,0]
    v_cvt_pk_bf16_f32 v200, v24, v25
    v_cvt_pk_bf16_f32 v201, v26, v27
    v_cvt_pk_bf16_f32 v202, v28, v29
    v_cvt_pk_bf16_f32 v203, v30, v31
    buffer_store_dwordx4 v[200:203], v18, s[16:19], s33 offen offset:0 sc1
    v_pk_mul_f32 v[36:37], v[36:37], v[98:99] op_sel:[0,0] op_sel_hi:[1,0]
    v_pk_mul_f32 v[38:39], v[38:39], v[98:99] op_sel:[0,0] op_sel_hi:[1,0]
    v_pk_mul_f32 v[40:41], v[40:41], v[98:99] op_sel:[0,0] op_sel_hi:[1,0]
    v_pk_mul_f32 v[42:43], v[42:43], v[98:99] op_sel:[0,0] op_sel_hi:[1,0]
    v_cvt_pk_bf16_f32 v204, v36, v37
    v_cvt_pk_bf16_f32 v205, v38, v39
    v_cvt_pk_bf16_f32 v206, v40, v41
    v_cvt_pk_bf16_f32 v207, v42, v43
    buffer_store_dwordx4 v[204:207], v18, s[16:19], s33 offen offset:256 sc1
    v_pk_mul_f32 v[48:49], v[48:49], v[100:101] op_sel:[0,0] op_sel_hi:[1,0]
    v_pk_mul_f32 v[50:51], v[50:51], v[100:101] op_sel:[0,0] op_sel_hi:[1,0]
    v_pk_mul_f32 v[52:53], v[52:53], v[100:101] op_sel:[0,0] op_sel_hi:[1,0]
    v_pk_mul_f32 v[54:55], v[54:55], v[100:101] op_sel:[0,0] op_sel_hi:[1,0]
    v_cvt_pk_bf16_f32 v208, v48, v49
    v_cvt_pk_bf16_f32 v209, v50, v51
    v_cvt_pk_bf16_f32 v210, v52, v53
    v_cvt_pk_bf16_f32 v211, v54, v55
    buffer_store_dwordx4 v[208:211], v18, s[16:19], s33 offen offset:512 sc1
    v_pk_mul_f32 v[60:61], v[60:61], v[102:103] op_sel:[0,0] op_sel_hi:[1,0]
    v_pk_mul_f32 v[62:63], v[62:63], v[102:103] op_sel:[0,0] op_sel_hi:[1,0]
    v_pk_mul_f32 v[64:65], v[64:65], v[102:103] op_sel:[0,0] op_sel_hi:[1,0]
    v_pk_mul_f32 v[66:67], v[66:67], v[102:103] op_sel:[0,0] op_sel_hi:[1,0]
    v_cvt_pk_bf16_f32 v212, v60, v61
    v_cvt_pk_bf16_f32 v213, v62, v63
    v_cvt_pk_bf16_f32 v214, v64, v65
    v_cvt_pk_bf16_f32 v215, v66, v67
    buffer_store_dwordx4 v[212:215], v18, s[16:19], s33 offen offset:768 sc1
    s_branch L1_fin
L1_g1:
    s_mov_b32 s8, s4
    s_mov_b32 s9, s5
    s_mov_b32 s10, 4194304
    s_mov_b32 s11, 0x20000
    s_mov_b32 s56, s100
    s_mov_b32 s57, s101
    s_mov_b32 s58, 2048
    s_mov_b32 s59, 0x20000
    s_mov_b32 s16, s44
    s_mov_b32 s17, s45
    s_mov_b32 s18, 268435456
    s_mov_b32 s19, 0x20000
    s_mov_b32 s12, s40
    s_mov_b32 s13, s41
    s_mov_b32 s14, 14680064
    s_mov_b32 s15, 0x20000
    s_mov_b32 s24, s42
    s_mov_b32 s25, s43
    s_mov_b32 s26, 7168
    s_mov_b32 s27, 0x20000
    s_and_b32 s39, s2, 127
    v_lshlrev_b32 v124, 4, v1
    s_lshl_b32 s32, s39, 15
    s_lshl_b32 s33, s28, 12
    s_add_u32 s33, s33, s32
    buffer_load_dwordx4 v[136:139], v124, s[8:11], s33 offen offset:0
    buffer_load_dwordx4 v[140:143], v124, s[8:11], s33 offen offset:1024
    buffer_load_dwordx4 v[144:147], v124, s[8:11], s33 offen offset:2048
    buffer_load_dwordx4 v[148:151], v124, s[8:11], s33 offen offset:3072
    buffer_load_dwordx4 v[152:155], v124, s[56:59], 0 offen
    buffer_load_dwordx4 v[156:159], v124, s[56:59], 0 offen offset:1024
    s_lshr_b32 s34, s28, 2
    s_mul_i32 s33, s34, 45056
    s_and_b32 s35, s28, 1
    s_lshl_b32 s35, s35, 7
    v_xor_b32 v120, s35, v124
    v_xor_b32 v121, 64, v120
    s_lshl_b32 s35, s29, 2
    s_add_u32 s35, s35, s33
    v_add_u32 v120, s35, v120
    v_add_u32 v121, s35, v121
    v_lshlrev_b32 v122, 5, v4
    v_lshl_add_u32 v122, v6, 3, v122
    s_lshr_b32 s35, s29, 3
    v_add_u32 v122, s35, v122
    v_lshlrev_b32 v123, 6, v5
    v_xor_b32 v122, v123, v122
    v_lshl_add_u32 v122, v5, 11, v122
    v_add_u32 v122, s33, v122
    v_add_u32 v123, s29, v124
    s_lshl_b32 s36, s39, 1
    s_add_u32 s36, s36, s34
    s_lshl_b32 s36, s36, 14
    v_lshlrev_b32 v127, 3, v1
    v_lshl_add_u32 v127, s28, 4, v127
    v_mov_b32 v126, 0x3a800000
    v_mov_b32 v132, 0
    v_mov_b32 v133, 0
    v_mov_b32 v134, 0
    v_mov_b32 v135, 0
    v_lshrrev_b32 v2, 2, v1
    v_mul_u32_u24 v2, 7168, v2
    v_lshl_add_u32 v2, v6, 4, v2
    v_and_b32 v3, 32, v1
    v_xor_b32 v2, v3, v2
    s_mul_i32 s34, s28, 114688
    s_mul_i32 s35, s38, 448
    s_add_u32 s34, s34, s35
    s_add_u32 s35, s34, 0
    v_add_u32 v12, s35, v2
    s_add_u32 s35, s34, 64
    v_add_u32 v13, s35, v2
    s_add_u32 s35, s34, 128
    v_add_u32 v14, s35, v2
    s_add_u32 s35, s34, 192
    v_add_u32 v15, s35, v2
    s_add_u32 s35, s34, 256
    v_add_u32 v16, s35, v2
    s_add_u32 s35, s34, 320
    v_add_u32 v17, s35, v2
    s_add_u32 s35, s34, 384
    v_add_u32 v18, s35, v2
    s_cmp_ge_u32 s28, 4
    s_cbranch_scc1 L1g_h1
    s_add_u32 s34, s30, s31
    s_and_b32 s34, s34, 3
    s_andn2_b32 s35, s30, 3
    s_or_b32 s34, s34, s35
    s_mul_i32 s32, s34, 131072
    s_mul_i32 s33, s34, 458752
    s_add_u32 s30, s30, 1
    s_add_u32 m0, s29, 16384
    s_nop 0
    buffer_load_dwordx4 v12, s[12:15], s33 offen lds
    s_add_u32 m0, s29, 20480
    s_nop 0
    buffer_load_dwordx4 v13, s[12:15], s33 offen lds
    s_add_u32 m0, s29, 24576
    s_nop 0
    buffer_load_dwordx4 v14, s[12:15], s33 offen lds
    s_add_u32 m0, s29, 28672
    s_nop 0
    buffer_load_dwordx4 v15, s[12:15], s33 offen lds
    s_add_u32 m0, s29, 32768
    s_nop 0
    buffer_load_dwordx4 v16, s[12:15], s33 offen lds
    s_add_u32 m0, s29, 36864
    s_nop 0
    buffer_load_dwordx4 v17, s[12:15], s33 offen lds
    s_add_u32 m0, s29, 40960
    s_nop 0
    buffer_load_dwordx4 v18, s[12:15], s33 offen lds
    s_add_u32 s34, s30, s31
    s_and_b32 s34, s34, 3
    s_andn2_b32 s35, s30, 3
    s_or_b32 s34, s34, s35
    s_mul_i32 s32, s34, 131072
    s_mul_i32 s33, s34, 458752
    s_add_u32 s30, s30, 1
    s_add_u32 m0, s29, 61440
    s_nop 0
    buffer_load_dwordx4 v12, s[12:15], s33 offen lds
    s_add_u32 m0, s29, 65536
    s_nop 0
    buffer_load_dwordx4 v13, s[12:15], s33 offen lds
    s_add_u32 m0, s29, 69632
    s_nop 0
    buffer_load_dwordx4 v14, s[12:15], s33 offen lds
    s_add_u32 m0, s29, 73728
    s_nop 0
    buffer_load_dwordx4 v15, s[12:15], s33 offen lds
    s_add_u32 m0, s29, 77824
    s_nop 0
    buffer_load_dwordx4 v16, s[12:15], s33 offen lds
    s_add_u32 m0, s29, 81920
    s_nop 0
    buffer_load_dwordx4 v17, s[12:15], s33 offen lds
    s_add_u32 m0, s29, 86016
    s_nop 0
    buffer_load_dwordx4 v18, s[12:15], s33 offen lds
    s_add_u32 s34, s30, s31
    s_and_b32 s34, s34, 3
    s_andn2_b32 s35, s30, 3
    s_or_b32 s34, s34, s35
    s_mul_i32 s32, s34, 131072
    s_mul_i32 s33, s34, 458752
    s_add_u32 s30, s30, 1
    s_add_u32 m0, s29, 106496
    s_nop 0
    buffer_load_dwordx4 v12, s[12:15], s33 offen lds
    s_add_u32 m0, s29, 110592
    s_nop 0
    buffer_load_dwordx4 v13, s[12:15], s33 offen lds
    s_add_u32 m0, s29, 114688
    s_nop 0
    buffer_load_dwordx4 v14, s[12:15], s33 offen lds
    s_add_u32 m0, s29, 118784
    s_nop 0
    buffer_load_dwordx4 v15, s[12:15], s33 offen lds
    s_add_u32 m0, s29, 122880
    s_nop 0
    buffer_load_dwordx4 v16, s[12:15], s33 offen lds
    s_add_u32 m0, s29, 126976
    s_nop 0
    buffer_load_dwordx4 v17, s[12:15], s33 offen lds
    s_add_u32 m0, s29, 131072
    s_nop 0
    buffer_load_dwordx4 v18, s[12:15], s33 offen lds
    s_waitcnt vmcnt(21)
    s_branch L1g_h2
L1g_h1:
    v_mov_b32 v32, 0
    v_mov_b32 v33, 0
    v_mov_b32 v34, 0
    v_mov_b32 v35, 0
    v_lshlrev_b32 v2, 4, v1
    v_lshl_add_u32 v2, s39, 12, v2
    s_add_u32 s34, s29, 25165824
    buffer_store_dwordx4 v[32:35], v2, s[16:19], s34 offen sc1
    s_cmp_lg_u32 s28, 4
    s_cbranch_scc1 L1g_h3
    s_memrealtime s[88:89]
    v_mov_b32 v37, 0
    s_waitcnt lgkmcnt(0)
    s_or_b32 s88, s88, 1
    v_mov_b32 v36, s88
    v_mov_b32 v38, s88
    s_mov_b64 exec, 1
    buffer_atomic_cmpswap v[36:37], v37, s[52:55], 0 offen sc0 sc1
    s_mov_b64 exec, -1
    s_waitcnt vmcnt(2)
    s_branch L1g_h2
L1g_h3:
    s_waitcnt vmcnt(1)
L1g_h2:
    s_mov_b32 s35, 0x3f803f80
    v_dot2_f32_bf16 v132, v136, s35, v132
    v_dot2_f32_bf16 v134, v144, s35, v134
    v_dot2_f32_bf16 v133, v136, v152, v133
    v_dot2_f32_bf16 v135, v144, v152, v135
    v_dot2_f32_bf16 v132, v137, s35, v132
    v_dot2_f32_bf16 v134, v145, s35, v134
    v_dot2_f32_bf16 v133, v137, v153, v133
    v_dot2_f32_bf16 v135, v145, v153, v135
    v_dot2_f32_bf16 v132, v138, s35, v132
    v_dot2_f32_bf16 v134, v146, s35, v134
    v_dot2_f32_bf16 v133, v138, v154, v133
    v_dot2_f32_bf16 v135, v146, v154, v135
    v_dot2_f32_bf16 v132, v139, s35, v132
    v_dot2_f32_bf16 v134, v147, s35, v134
    v_dot2_f32_bf16 v133, v139, v155, v133
    v_dot2_f32_bf16 v135, v147, v155, v135
    v_dot2_f32_bf16 v132, v140, s35, v132
    v_dot2_f32_bf16 v134, v148, s35, v134
    v_dot2_f32_bf16 v133, v140, v156, v133
    v_dot2_f32_bf16 v135, v148, v156, v135
    v_dot2_f32_bf16 v132, v141, s35, v132
    v_dot2_f32_bf16 v134, v149, s35, v134
    v_dot2_f32_bf16 v133, v141, v157, v133
    v_dot2_f32_bf16 v135, v149, v157, v135
    v_dot2_f32_bf16 v132, v142, s35, v132
    v_dot2_f32_bf16 v134, v150, s35, v134
    v_dot2_f32_bf16 v133, v142, v158, v133
    v_dot2_f32_bf16 v135, v150, v158, v135
    v_dot2_f32_bf16 v132, v143, s35, v132
    v_dot2_f32_bf16 v134, v151, s35, v134
    v_dot2_f32_bf16 v133, v143, v159, v133
    v_dot2_f32_bf16 v135, v151, v159, v135
    v_lshlrev_b32 v160, 16, v136
    v_and_b32 v161, 0xffff0000, v136
    v_lshlrev_b32 v162, 16, v137
    v_add_f32_dpp v132, v132, v132 row_shr:1 row_mask:0xf bank_mask:0xf bound_ctrl:0
    v_add_f32_dpp v134, v134, v134 row_shr:1 row_mask:0xf bank_mask:0xf bound_ctrl:0
    v_add_f32_dpp v133, v133, v133 row_shr:1 row_mask:0xf bank_mask:0xf bound_ctrl:0
    v_add_f32_dpp v135, v135, v135 row_shr:1 row_mask:0xf bank_mask:0xf bound_ctrl:0
    v_and_b32 v163, 0xffff0000, v137
    v_lshlrev_b32 v164, 16, v138
    v_add_f32_dpp v132, v132, v132 row_shr:2 row_mask:0xf bank_mask:0xf bound_ctrl:0
    v_add_f32_dpp v134, v134, v134 row_shr:2 row_mask:0xf bank_mask:0xf bound_ctrl:0
    v_add_f32_dpp v133, v133, v133 row_shr:2 row_mask:0xf bank_mask:0xf bound_ctrl:0
    v_add_f32_dpp v135, v135, v135 row_shr:2 row_mask:0xf bank_mask:0xf bound_ctrl:0
    v_and_b32 v165, 0xffff0000, v138
    v_lshlrev_b32 v166, 16, v139
    v_add_f32_dpp v132, v132, v132 row_shr:4 row_mask:0xf bank_mask:0xf bound_ctrl:0
    v_add_f32_dpp v134, v134, v134 row_shr:4 row_mask:0xf bank_mask:0xf bound_ctrl:0
    v_add_f32_dpp v133, v133, v133 row_shr:4 row_mask:0xf bank_mask:0xf bound_ctrl:0
    v_add_f32_dpp v135, v135, v135 row_shr:4 row_mask:0xf bank_mask:0xf bound_ctrl:0
    v_and_b32 v167, 0xffff0000, v139
    v_lshlrev_b32 v168, 16, v140
    v_add_f32_dpp v132, v132, v132 row_shr:8 row_mask:0xf bank_mask:0xf bound_ctrl:0
    v_add_f32_dpp v134, v134, v134 row_shr:8 row_mask:0xf bank_mask:0xf bound_ctrl:0
    v_add_f32_dpp v133, v133, v133 row_shr:8 row_mask:0xf bank_mask:0xf bound_ctrl:0
    v_add_f32_dpp v135, v135, v135 row_shr:8 row_mask:0xf bank_mask:0xf bound_ctrl:0
    v_and_b32 v169, 0xffff0000, v140
    v_lshlrev_b32 v170, 16, v141
    v_add_f32_dpp v132, v132, v132 row_bcast:15 row_mask:0xa bank_mask:0xf
    v_add_f32_dpp v134, v134, v134 row_bcast:15 row_mask:0xa bank_mask:0xf
    v_add_f32_dpp v133, v133, v133 row_bcast:15 row_mask:0xa bank_mask:0xf
    v_add_f32_dpp v135, v135, v135 row_bcast:15 row_mask:0xa bank_mask:0xf
    v_and_b32 v171, 0xffff0000, v141
    v_lshlrev_b32 v172, 16, v142
    v_add_f32_dpp v132, v132, v132 row_bcast:31 row_mask:0xc bank_mask:0xf
    v_add_f32_dpp v134, v134, v134 row_bcast:31 row_mask:0xc bank_mask:0xf
    v_add_f32_dpp v133, v133, v133 row_bcast:31 row_mask:0xc bank_mask:0xf
    v_add_f32_dpp v135, v135, v135 row_bcast:31 row_mask:0xc bank_mask:0xf
    v_and_b32 v173, 0xffff0000, v142
    v_lshlrev_b32 v174, 16, v143
    v_and_b32 v175, 0xffff0000, v143
    v_readlane_b32 s88, v132, 63
    v_readlane_b32 s90, v134, 63
    v_readlane_b32 s89, v133, 63
    v_readlane_b32 s91, v135, 63
    v_lshlrev_b32 v176, 16, v144
    v_and_b32 v177, 0xffff0000, v144
    v_lshlrev_b32 v178, 16, v145
    v_and_b32 v179, 0xffff0000, v145
    v_lshlrev_b32 v180, 16, v146
    v_and_b32 v181, 0xffff0000, v146
    v_lshlrev_b32 v182, 16, v147
    v_and_b32 v183, 0xffff0000, v147
    v_lshlrev_b32 v184, 16, v148
    v_and_b32 v185, 0xffff0000, v148
    v_lshlrev_b32 v186, 16, v149
    v_and_b32 v187, 0xffff0000, v149
    v_lshlrev_b32 v188, 16, v150
    v_and_b32 v189, 0xffff0000, v150
    v_lshlrev_b32 v190, 16, v151
    v_and_b32 v191, 0xffff0000, v151
    v_mul_f32 v128, s88, v126
    v_mul_f32 v130, s90, v126
    v_pk_add_f32 v[192:193], v[160:161], v[128:129] op_sel_hi:[1,0] neg_lo:[0,1] neg_hi:[0,1]
    v_pk_mul_f32 v[132:133], v[192:193], v[192:193]
    v_pk_add_f32 v[194:195], v[176:177], v[130:131] op_sel_hi:[1,0] neg_lo:[0,1] neg_hi:[0,1]
    v_pk_mul_f32 v[134:135], v[194:195], v[194:195]
    v_pk_add_f32 v[192:193], v[162:163], v[128:129] op_sel_hi:[1,0] neg_lo:[0,1] neg_hi:[0,1]
    v_pk_fma_f32 v[132:133], v[192:193], v[192:193], v[132:133]
    v_pk_add_f32 v[194:195], v[178:179], v[130:131] op_sel_hi:[1,0] neg_lo:[0,1] neg_hi:[0,1]
    v_pk_fma_f32 v[134:135], v[194:195], v[194:195], v[134:135]
    v_pk_add_f32 v[192:193], v[164:165], v[128:129] op_sel_hi:[1,0] neg_lo:[0,1] neg_hi:[0,1]
    v_pk_fma_f32 v[132:133], v[192:193], v[192:193], v[132:133]
    v_pk_add_f32 v[194:195], v[180:181], v[130:131] op_sel_hi:[1,0] neg_lo:[0,1] neg_hi:[0,1]
    v_pk_fma_f32 v[134:135], v[194:195], v[194:195], v[134:135]
    v_pk_add_f32 v[192:193], v[166:167], v[128:129] op_sel_hi:[1,0] neg_lo:[0,1] neg_hi:[0,1]
    v_pk_fma_f32 v[132:133], v[192:193], v[192:193], v[132:133]
    v_pk_add_f32 v[194:195], v[182:183], v[130:131] op_sel_hi:[1,0] neg_lo:[0,1] neg_hi:[0,1]
    v_pk_fma_f32 v[134:135], v[194:195], v[194:195], v[134:135]
    v_pk_add_f32 v[192:193], v[168:169], v[128:129] op_sel_hi:[1,0] neg_lo:[0,1] neg_hi:[0,1]
    v_pk_fma_f32 v[132:133], v[192:193], v[192:193], v[132:133]
    v_pk_add_f32 v[194:195], v[184:185], v[130:131] op_sel_hi:[1,0] neg_lo:[0,1] neg_hi:[0,1]
    v_pk_fma_f32 v[134:135], v[194:195], v[194:195], v[134:135]
    v_pk_add_f32 v[192:193], v[170:171], v[128:129] op_sel_hi:[1,0] neg_lo:[0,1] neg_hi:[0,1]
    v_pk_fma_f32 v[132:133], v[192:193], v[192:193], v[132:133]
    v_pk_add_f32 v[194:195], v[186:187], v[130:131] op_sel_hi:[1,0] neg_lo:[0,1] neg_hi:[0,1]
    v_pk_fma_f32 v[134:135], v[194:195], v[194:195], v[134:135]
    v_pk_add_f32 v[192:193], v[172:173], v[128:129] op_sel_hi:[1,0] neg_lo:[0,1] neg_hi:[0,1]
    v_pk_fma_f32 v[132:133], v[192:193], v[192:193], v[132:133]
    v_pk_add_f32 v[194:195], v[188:189], v[130:131] op_sel_hi:[1,0] neg_lo:[0,1] neg_hi:[0,1]
    v_pk_fma_f32 v[134:135], v[194:195], v[194:195], v[134:135]
    v_pk_add_f32 v[192:193], v[174:175], v[128:129] op_sel_hi:[1,0] neg_lo:[0,1] neg_hi:[0,1]
    v_pk_fma_f32 v[132:133], v[192:193], v[192:193], v[132:133]
    v_pk_add_f32 v[194:195], v[190:191], v[130:131] op_sel_hi:[1,0] neg_lo:[0,1] neg_hi:[0,1]
    v_pk_fma_f32 v[134:135], v[194:195], v[194:195], v[134:135]
    v_add_f32 v132, v132, v133
    v_add_f32 v134, v134, v135
    v_cmp_eq_u32 vcc, 1, v1
    v_mov_b32 v196, s89
    v_mov_b32 v197, s91
    v_add_f32_dpp v132, v132, v132 row_shr:1 row_mask:0xf bank_mask:0xf bound_ctrl:0
    v_add_f32_dpp v134, v134, v134 row_shr:1 row_mask:0xf bank_mask:0xf bound_ctrl:0
    v_cndmask_b32 v128, v128, v130, vcc
    v_cndmask_b32 v196, v196, v197, vcc
    v_add_f32_dpp v132, v132, v132 row_shr:2 row_mask:0xf bank_mask:0xf bound_ctrl:0
    v_add_f32_dpp v134, v134, v134 row_shr:2 row_mask:0xf bank_mask:0xf bound_ctrl:0
    v_cvt_pk_bf16_f32 v196, v196, v196
    v_cvt_pk_bf16_f32 v128, v128, v128
    v_add_f32_dpp v132, v132, v132 row_shr:4 row_mask:0xf bank_mask:0xf bound_ctrl:0
    v_add_f32_dpp v134, v134, v134 row_shr:4 row_mask:0xf bank_mask:0xf bound_ctrl:0
    v_and_b32 v196, 0xffff0000, v196
    v_and_b32 v128, 0xffff0000, v128
    v_add_f32_dpp v132, v132, v132 row_shr:8 row_mask:0xf bank_mask:0xf bound_ctrl:0
    v_add_f32_dpp v134, v134, v134 row_shr:8 row_mask:0xf bank_mask:0xf bound_ctrl:0
    v_mul_f32 v196, 0xbfb8aa3b, v196
    v_exp_f32 v196, v196
    v_add_f32_dpp v132, v132, v132 row_bcast:15 row_mask:0xa bank_mask:0xf
    v_add_f32_dpp v134, v134, v134 row_bcast:15 row_mask:0xa bank_mask:0xf
    s_nop 0
    v_add_f32 v196, 1.0, v196
    v_add_f32_dpp v132, v132, v132 row_bcast:31 row_mask:0xc bank_mask:0xf
    v_add_f32_dpp v134, v134, v134 row_bcast:31 row_mask:0xc bank_mask:0xf
    v_rcp_f32 v196, v196
    s_nop 0
    v_cvt_pk_bf16_f32 v196, v196, v196
    v_readlane_b32 s88, v132, 63
    v_readlane_b32 s90, v134, 63
    v_and_b32 v196, 0xffff0000, v196
    v_sub_f32 v197, 1.0, v196
    v_mov_b32 v130, s88
    v_mov_b32 v131, s90
    v_cndmask_b32 v130, v130, v131, vcc
    v_mul_f32 v130, v130, v126
    v_cvt_pk_bf16_f32 v130, v130, v130
    v_and_b32 v130, 0xffff0000, v130
    v_add_f32 v130, 0x3727c5ac, v130
    v_cvt_pk_bf16_f32 v130, v130, v130
    v_and_b32 v130, 0xffff0000, v130
    v_sqrt_f32 v130, v130
    v_cvt_pk_bf16_f32 v197, v197, v197
    v_and_b32 v197, 0xffff0000, v197
    v_cvt_pk_bf16_f32 v130, v130, v130
    v_and_b32 v130, 0xffff0000, v130
    v_rcp_f32 v130, v130
    s_lshl_b32 s33, s39, 7
    s_add_u32 s33, s33, 4194304
    v_mul_f32 v128, v128, v130
    v_readlane_b32 s88, v130, 0
    v_readlane_b32 s90, v130, 1
    v_readlane_b32 s89, v128, 0
    v_readlane_b32 s91, v128, 1
    s_mov_b64 exec, 3
    buffer_store_dwordx2 v[196:197], v127, s[16:19], s33 offen sc1
    s_mov_b64 exec, -1
    v_mov_b32 v132, s89
    v_mov_b32 v134, s91
    v_pk_fma_f32 v[160:161], v[160:161], s[88:89], v[132:133] op_sel_hi:[1,0,0] neg_lo:[0,0,1] neg_hi:[0,0,1]
    v_pk_fma_f32 v[162:163], v[162:163], s[88:89], v[132:133] op_sel_hi:[1,0,0] neg_lo:[0,0,1] neg_hi:[0,0,1]
    v_pk_fma_f32 v[164:165], v[164:165], s[88:89], v[132:133] op_sel_hi:[1,0,0] neg_lo:[0,0,1] neg_hi:[0,0,1]
    v_pk_fma_f32 v[166:167], v[166:167], s[88:89], v[132:133] op_sel_hi:[1,0,0] neg_lo:[0,0,1] neg_hi:[0,0,1]
    v_cvt_pk_bf16_f32 v200, v160, v161
    v_cvt_pk_bf16_f32 v201, v162, v163
    v_cvt_pk_bf16_f32 v202, v164, v165
    v_cvt_pk_bf16_f32 v203, v166, v167
    ds_write_b128 v120, v[200:203] offset:0
    v_pk_fma_f32 v[168:169], v[168:169], s[88:89], v[132:133] op_sel_hi:[1,0,0] neg_lo:[0,0,1] neg_hi:[0,0,1]
    v_pk_fma_f32 v[170:171], v[170:171], s[88:89], v[132:133] op_sel_hi:[1,0,0] neg_lo:[0,0,1] neg_hi:[0,0,1]
    v_pk_fma_f32 v[172:173], v[172:173], s[88:89], v[132:133] op_sel_hi:[1,0,0] neg_lo:[0,0,1] neg_hi:[0,0,1]
    v_pk_fma_f32 v[174:175], v[174:175], s[88:89], v[132:133] op_sel_hi:[1,0,0] neg_lo:[0,0,1] neg_hi:[0,0,1]
    v_cvt_pk_bf16_f32 v204, v168, v169
    v_cvt_pk_bf16_f32 v205, v170, v171
    v_cvt_pk_bf16_f32 v206, v172, v173
    v_cvt_pk_bf16_f32 v207, v174, v175
    ds_write_b128 v120, v[204:207] offset:1024
    v_pk_fma_f32 v[176:177], v[176:177], s[90:91], v[134:135] op_sel_hi:[1,0,0] neg_lo:[0,0,1] neg_hi:[0,0,1]
    v_pk_fma_f32 v[178:179], v[178:179], s[90:91], v[134:135] op_sel_hi:[1,0,0] neg_lo:[0,0,1] neg_hi:[0,0,1]
    v_pk_fma_f32 v[180:181], v[180:181], s[90:91], v[134:135] op_sel_hi:[1,0,0] neg_lo:[0,0,1] neg_hi:[0,0,1]
    v_pk_fma_f32 v[182:183], v[182:183], s[90:91], v[134:135] op_sel_hi:[1,0,0] neg_lo:[0,0,1] neg_hi:[0,0,1]
    v_cvt_pk_bf16_f32 v208, v176, v177
    v_cvt_pk_bf16_f32 v209, v178, v179
    v_cvt_pk_bf16_f32 v210, v180, v181
    v_cvt_pk_bf16_f32 v211, v182, v183
    ds_write_b128 v121, v[208:211] offset:2048
    v_pk_fma_f32 v[184:185], v[184:185], s[90:91], v[134:135] op_sel_hi:[1,0,0] neg_lo:[0,0,1] neg_hi:[0,0,1]
    v_pk_fma_f32 v[186:187], v[186:187], s[90:91], v[134:135] op_sel_hi:[1,0,0] neg_lo:[0,0,1] neg_hi:[0,0,1]
    v_pk_fma_f32 v[188:189], v[188:189], s[90:91], v[134:135] op_sel_hi:[1,0,0] neg_lo:[0,0,1] neg_hi:[0,0,1]
    v_pk_fma_f32 v[190:191], v[190:191], s[90:91], v[134:135] op_sel_hi:[1,0,0] neg_lo:[0,0,1] neg_hi:[0,0,1]
    v_cvt_pk_bf16_f32 v212, v184, v185
    v_cvt_pk_bf16_f32 v213, v186, v187
    v_cvt_pk_bf16_f32 v214, v188, v189
    v_cvt_pk_bf16_f32 v215, v190, v191
    ds_write_b128 v121, v[212:215] offset:3072
    v_mov_b32 v2, 90368
    s_cmp_lg_u32 s28, 4
    s_cbranch_scc1 L1g_ne
    s_waitcnt vmcnt(1)
    v_cmp_eq_u32 vcc, 0, v36
    s_nop 1
    v_cndmask_b32 v36, v36, v38, vcc
    s_mov_b64 exec, 1
    ds_write_b32 v2, v36
    s_mov_b64 exec, -1
L1g_ne:
    s_waitcnt lgkmcnt(0)
    s_barrier
    ds_read_b32 v39, v2
    ds_read_b64_tr_b16 v[216:217], v122 offset:0
    ds_read_b64_tr_b16 v[218:219], v122 offset:8192
    ds_read_b64_tr_b16 v[220:221], v122 offset:512
    ds_read_b64_tr_b16 v[222:223], v122 offset:8704
    ds_read_b64_tr_b16 v[224:225], v122 offset:1024
    ds_read_b64_tr_b16 v[226:227], v122 offset:9216
    ds_read_b64_tr_b16 v[228:229], v122 offset:1536
    ds_read_b64_tr_b16 v[230:231], v122 offset:9728
    s_waitcnt lgkmcnt(6)
    buffer_store_dwordx4 v[216:219], v123, s[16:19], s36 offen sc1
    s_add_u32 s36, s36, 4096
    s_waitcnt lgkmcnt(4)
    buffer_store_dwordx4 v[220:223], v123, s[16:19], s36 offen sc1
    s_add_u32 s36, s36, 4096
    s_waitcnt lgkmcnt(2)
    buffer_store_dwordx4 v[224:227], v123, s[16:19], s36 offen sc1
    s_add_u32 s36, s36, 4096
    s_waitcnt lgkmcnt(0)
    buffer_store_dwordx4 v[228:231], v123, s[16:19], s36 offen sc1
    s_mov_b32 s8, s44
    s_mov_b32 s9, s45
    s_mov_b32 s10, 4194304
    s_mov_b32 s11, 0x20000
    s_mov_b32 s30, 0
    v_lshlrev_b32 v2, 4, v1
    s_lshr_b32 s34, s28, 1
    s_lshl_b32 s34, s34, 14
    s_and_b32 s35, s28, 1
    s_lshl_b32 s35, s35, 10
    s_add_u32 s34, s34, s35
    s_lshl_b32 s35, s37, 11
    s_add_u32 s34, s34, s35
    s_add_u32 s35, s34, 0
    v_add_u32 v8, s35, v2
    s_add_u32 s35, s34, 32768
    v_add_u32 v9, s35, v2
    s_add_u32 s35, s34, 65536
    v_add_u32 v10, s35, v2
    s_add_u32 s35, s34, 98304
    v_add_u32 v11, s35, v2
    s_mul_i32 s34, s38, 448
    s_and_b32 s35, s28, 1
    s_lshl_b32 s32, s35, 8
    s_add_u32 s32, s32, s34
    s_lshl_b32 s35, s35, 5
    s_add_u32 s34, s34, s35
    v_lshlrev_b32 v2, 3, v4
    buffer_load_dwordx2 v[76:77], v2, s[24:27], s32 offen offset:0
    buffer_load_dwordx2 v[78:79], v2, s[24:27], s32 offen offset:32
    buffer_load_dwordx2 v[80:81], v2, s[24:27], s32 offen offset:64
    buffer_load_dwordx2 v[82:83], v2, s[24:27], s32 offen offset:96
    buffer_load_dwordx2 v[84:85], v2, s[24:27], s32 offen offset:128
    buffer_load_dwordx2 v[86:87], v2, s[24:27], s32 offen offset:160
    buffer_load_dwordx2 v[88:89], v2, s[24:27], s34 offen offset:192
    s_bfe_u32 s40, s2, 0x10001
    s_lshl_b32 s40, s40, 2
    s_and_b32 s34, s37, 3
    s_add_u32 s40, s40, s34
    s_bfe_u32 s41, s2, 0x10002
    s_lshl_b32 s41, s41, 2
    s_and_b32 s34, s38, 3
    s_add_u32 s41, s41, s34
    s_and_b32 s32, s2, 1
    s_mul_i32 s34, s32, 32
    s_mul_i32 s35, s32, 24
    s_add_u32 s35, s35, 64
    s_add_u32 s33, s32, 2
    s_bitcmp1_b32 s2, 7
    s_cselect_b32 s42, s32, s33
    s_cselect_b32 s43, s34, s35
    v_lshlrev_b32 v2, 4, v1
    s_bfe_u32 s34, s28, 0x10001
    s_lshl_b32 s34, s34, 14
    s_and_b32 s35, s28, 1
    s_lshl_b32 s35, s35, 10
    s_add_u32 s34, s34, s35
    s_lshl_b32 s35, s40, 11
    s_add_u32 s34, s34, s35
    v_add_u32 v244, s34, v2
    s_lshl_b32 s34, s41, 12
    s_add_u32 s34, s34, s29
    v_add_u32 v245, s34, v2
    v_lshrrev_b32 v3, 5, v1
    v_lshlrev_b32 v3, 6, v3
    v_lshl_add_u32 v3, v6, 4, v3
    v_and_b32 v2, 16, v1
    v_lshlrev_b32 v2, 1, v2
    v_xor_b32 v3, v2, v3
    v_bfe_u32 v2, v1, 2, 3
    v_lshl_add_u32 v246, v2, 12, v3
    s_mul_i32 s34, s29, 32
    s_lshl_b32 s35, s41, 9
    s_add_u32 s34, s34, s35
    v_add_u32 v246, s34, v246
    v_lshl_add_u32 v247, v2, 11, v3
    s_mul_i32 s34, s29, 16
    s_lshl_b32 s35, s40, 8
    s_add_u32 s34, s34, s35
    v_add_u32 v247, s34, v247
    s_lshr_b32 s32, s28, 2
    v_and_b32 v252, 15, v1
    v_lshlrev_b32 v2, 4, v252
    v_lshl_add_u32 v248, v4, 11, v2
    v_lshl_add_u32 v248, s32, 10, v248
    v_lshl_add_u32 v249, v4, 12, v2
    v_add_u32 v249, s29, v249
    v_lshrrev_b32 v2, 1, v4
    v_lshlrev_b32 v2, 10, v2
    v_and_b32 v3, 1, v4
    v_mul_u32_u24 v3, 288, v3
    v_add_u32 v2, v3, v2
    v_lshl_add_u32 v2, v5, 6, v2
    v_lshl_add_u32 v2, v6, 3, v2
    v_lshl_add_u32 v250, s29, 2, v2
    v_add_u32 v250, 8192, v250
    v_lshl_add_u32 v251, s32, 12, v2
    v_add_u32 v251, 16384, v251
    s_lshl_b32 s34, s41, 8
    s_lshr_b32 s35, s29, 4
    s_add_u32 s34, s34, s35
    v_add_u32 v252, s34, v252
    s_lshl_b32 s46, s40, 7
    s_add_u32 s46, s46, 41951232
    s_lshl_b32 s47, s41, 7
    s_add_u32 s47, s47, 41955328
    s_lshl_b32 s48, s37, 7
    s_lshl_b32 s34, s38, 2
    s_add_u32 s48, s48, s34
    s_bitcmp1_b32 s2, 7
    s_cselect_b32 s47, s46, s47
    s_cselect_b32 s34, 0, 4096
    s_add_u32 s48, s48, s34
    s_add_u32 s48, s48, 41951232
    v_and_b32 v2, 15, v1
    v_lshlrev_b32 v2, 4, v2
    v_lshl_add_u32 v2, v4, 11, v2
    s_lshr_b32 s34, s28, 2
    s_lshl_b32 s34, s34, 13
    s_bfe_u32 s35, s28, 0x10001
    s_lshl_b32 s35, s35, 10
    s_add_u32 s34, s34, s35
    s_add_u32 s35, s34, 0
    v_add_u32 v20, s35, v2
    s_add_u32 s35, s34, 45056
    v_add_u32 v21, s35, v2
    s_add_u32 s35, s34, 90112
    v_add_u32 v22, s35, v2
    v_lshlrev_b32 v2, 9, v4
    v_lshl_add_u32 v2, v5, 6, v2
    v_and_b32 v3, 1, v4
    v_lshl_add_u32 v2, v3, 5, v2
    v_lshl_add_u32 v2, v6, 3, v2
    v_xor_b32 v3, 32, v2
    s_lshr_b32 s34, s28, 2
    s_lshl_b32 s34, s34, 11
    s_add_u32 s34, s34, 16384
    s_and_b32 s35, s28, 1
    s_lshl_b32 s32, s35, 5
    v_xor_b32 v7, s32, v2
    s_lshl_b32 s32, s35, 14
    s_add_u32 s32, s32, s34
    s_add_u32 s35, s32, 0
    v_add_u32 v23, s35, v2
    v_add_u32 v26, s35, v3
    s_add_u32 s35, s34, 12288
    v_add_u32 v29, s35, v7
    s_add_u32 s35, s32, 45056
    v_add_u32 v24, s35, v2
    v_add_u32 v27, s35, v3
    s_add_u32 s35, s34, 57344
    v_add_u32 v30, s35, v7
    s_add_u32 s35, s32, 90112
    v_add_u32 v25, s35, v2
    v_add_u32 v28, s35, v3
    s_add_u32 s35, s34, 102400
    v_add_u32 v31, s35, v7
    v_readfirstlane_b32 s51, v39
    v_lshlrev_b32 v2, 9, v1
    s_lshl_b32 s34, s39, 2
    s_add_u32 s34, s34, 41943040
    s_waitcnt vmcnt(0)
    s_barrier
    s_cmp_ge_u32 s28, 4
    s_cbranch_scc1 L1g_nold
    s_cmp_lg_u32 s28, 0
    s_cbranch_scc1 L1g_nf
    s_mov_b64 exec, 0xff
    buffer_store_dword v39, v2, s[16:19], s34 offen sc1
    s_mov_b64 exec, -1
L1g_nf:
    v_lshlrev_b32 v120, 16, v76
    v_and_b32 v121, 0xffff0000, v76
    v_lshlrev_b32 v122, 16, v77
    v_and_b32 v123, 0xffff0000, v77
    v_lshlrev_b32 v124, 16, v78
    v_and_b32 v125, 0xffff0000, v78
    v_lshlrev_b32 v126, 16, v79
    v_and_b32 v127, 0xffff0000, v79
    v_lshlrev_b32 v128, 16, v80
    v_and_b32 v129, 0xffff0000, v80
    v_lshlrev_b32 v130, 16, v81
    v_and_b32 v131, 0xffff0000, v81
    v_lshlrev_b32 v132, 16, v82
    v_and_b32 v133, 0xffff0000, v82
    v_lshlrev_b32 v134, 16, v83
    v_and_b32 v135, 0xffff0000, v83
    v_lshlrev_b32 v136, 16, v84
    v_and_b32 v137, 0xffff0000, v84
    v_lshlrev_b32 v138, 16, v85
    v_and_b32 v139, 0xffff0000, v85
    v_lshlrev_b32 v140, 16, v86
    v_and_b32 v141, 0xffff0000, v86
    v_lshlrev_b32 v142, 16, v87
    v_and_b32 v143, 0xffff0000, v87
    v_lshlrev_b32 v144, 16, v88
    v_and_b32 v145, 0xffff0000, v88
    v_lshlrev_b32 v146, 16, v89
    v_and_b32 v147, 0xffff0000, v89
    v_mov_b32 v148, v120
    v_mov_b32 v149, v121
    v_mov_b32 v150, v122
    v_mov_b32 v151, v123
    v_mov_b32 v152, v124
    v_mov_b32 v153, v125
    v_mov_b32 v154, v126
    v_mov_b32 v155, v127
    v_mov_b32 v156, v128
    v_mov_b32 v157, v129
    v_mov_b32 v158, v130
    v_mov_b32 v159, v131
    v_mov_b32 v160, v132
    v_mov_b32 v161, v133
    v_mov_b32 v162, v134
    v_mov_b32 v163, v135
    v_mov_b32 v164, v136
    v_mov_b32 v165, v137
    v_mov_b32 v166, v138
    v_mov_b32 v167, v139
    v_mov_b32 v168, v140
    v_mov_b32 v169, v141
    v_mov_b32 v170, v142
    v_mov_b32 v171, v143
    v_mov_b32 v172, v144
    v_mov_b32 v173, v145
    v_mov_b32 v174, v146
    v_mov_b32 v175, v147
    v_mov_b32 v176, v120
    v_mov_b32 v177, v121
    v_mov_b32 v178, v122
    v_mov_b32 v179, v123
    v_mov_b32 v180, v124
    v_mov_b32 v181, v125
    v_mov_b32 v182, v126
    v_mov_b32 v183, v127
    v_mov_b32 v184, v128
    v_mov_b32 v185, v129
    v_mov_b32 v186, v130
    v_mov_b32 v187, v131
    v_mov_b32 v188, v132
    v_mov_b32 v189, v133
    v_mov_b32 v190, v134
    v_mov_b32 v191, v135
    v_mov_b32 v192, v136
    v_mov_b32 v193, v137
    v_mov_b32 v194, v138
    v_mov_b32 v195, v139
    v_mov_b32 v196, v140
    v_mov_b32 v197, v141
    v_mov_b32 v198, v142
    v_mov_b32 v199, v143
    v_mov_b32 v200, v144
    v_mov_b32 v201, v145
    v_mov_b32 v202, v146
    v_mov_b32 v203, v147
    v_mov_b32 v204, v120
    v_mov_b32 v205, v121
    v_mov_b32 v206, v122
    v_mov_b32 v207, v123
    v_mov_b32 v208, v124
    v_mov_b32 v209, v125
    v_mov_b32 v210, v126
    v_mov_b32 v211, v127
    v_mov_b32 v212, v128
    v_mov_b32 v213, v129
    v_mov_b32 v214, v130
    v_mov_b32 v215, v131
    v_mov_b32 v216, v132
    v_mov_b32 v217, v133
    v_mov_b32 v218, v134
    v_mov_b32 v219, v135
    v_mov_b32 v220, v136
    v_mov_b32 v221, v137
    v_mov_b32 v222, v138
    v_mov_b32 v223, v139
    v_mov_b32 v224, v140
    v_mov_b32 v225, v141
    v_mov_b32 v226, v142
    v_mov_b32 v227, v143
    v_mov_b32 v228, v144
    v_mov_b32 v229, v145
    v_mov_b32 v230, v146
    v_mov_b32 v231, v147
    s_barrier
    s_mov_b32 s30, 0
    s_add_u32 s34, s30, s31
    s_and_b32 s34, s34, 3
    s_andn2_b32 s35, s30, 3
    s_or_b32 s34, s34, s35
    s_mul_i32 s32, s34, 131072
    s_mul_i32 s33, s34, 458752
    s_add_u32 s30, s30, 1
    s_add_u32 m0, s29, 0
    s_nop 0
    buffer_load_dwordx4 v8, s[8:11], s32 offen sc1 lds
    s_add_u32 m0, s29, 4096
    s_nop 0
    buffer_load_dwordx4 v9, s[8:11], s32 offen sc1 lds
    s_add_u32 m0, s29, 8192
    s_nop 0
    buffer_load_dwordx4 v10, s[8:11], s32 offen sc1 lds
    s_add_u32 m0, s29, 12288
    s_nop 0
    buffer_load_dwordx4 v11, s[8:11], s32 offen sc1 lds
    s_add_u32 s34, s30, s31
    s_and_b32 s34, s34, 3
    s_andn2_b32 s35, s30, 3
    s_or_b32 s34, s34, s35
    s_mul_i32 s32, s34, 131072
    s_mul_i32 s33, s34, 458752
    s_add_u32 s30, s30, 1
    s_add_u32 m0, s29, 45056
    s_nop 0
    buffer_load_dwordx4 v8, s[8:11], s32 offen sc1 lds
    s_add_u32 m0, s29, 49152
    s_nop 0
    buffer_load_dwordx4 v9, s[8:11], s32 offen sc1 lds
    s_add_u32 m0, s29, 53248
    s_nop 0
    buffer_load_dwordx4 v10, s[8:11], s32 offen sc1 lds
    s_add_u32 m0, s29, 57344
    s_nop 0
    buffer_load_dwordx4 v11, s[8:11], s32 offen sc1 lds
    s_add_u32 s34, s30, s31
    s_and_b32 s34, s34, 3
    s_andn2_b32 s35, s30, 3
    s_or_b32 s34, s34, s35
    s_mul_i32 s32, s34, 131072
    s_mul_i32 s33, s34, 458752
    s_add_u32 s30, s30, 1
    s_add_u32 m0, s29, 90112
    s_nop 0
    buffer_load_dwordx4 v8, s[8:11], s32 offen sc1 lds
    s_add_u32 m0, s29, 94208
    s_nop 0
    buffer_load_dwordx4 v9, s[8:11], s32 offen sc1 lds
    s_add_u32 m0, s29, 98304
    s_nop 0
    buffer_load_dwordx4 v10, s[8:11], s32 offen sc1 lds
    s_add_u32 m0, s29, 102400
    s_nop 0
    buffer_load_dwordx4 v11, s[8:11], s32 offen sc1 lds
    s_waitcnt vmcnt(0)
    s_barrier
    ds_read_b128 v[32:35], v20 offset:0
    ds_read_b64_tr_b16 v[48:49], v23 offset:0
    ds_read_b64_tr_b16 v[50:51], v23 offset:256
    ds_read_b128 v[36:39], v20 offset:256
    ds_read_b64_tr_b16 v[52:53], v26 offset:0
    ds_read_b64_tr_b16 v[54:55], v26 offset:256
    ds_read_b128 v[40:43], v20 offset:512
    ds_read_b64_tr_b16 v[56:57], v23 offset:4096
    ds_read_b64_tr_b16 v[58:59], v23 offset:4352
    ds_read_b128 v[44:47], v20 offset:768
    ds_read_b64_tr_b16 v[60:61], v26 offset:4096
    ds_read_b64_tr_b16 v[62:63], v26 offset:4352
    ds_read_b64_tr_b16 v[64:65], v23 offset:8192
    ds_read_b64_tr_b16 v[66:67], v23 offset:8448
    ds_read_b64_tr_b16 v[68:69], v26 offset:8192
    ds_read_b64_tr_b16 v[70:71], v26 offset:8448
    ds_read_b64_tr_b16 v[72:73], v29 offset:0
    ds_read_b64_tr_b16 v[74:75], v29 offset:256
    s_mov_b32 s36, 4
L_g_3035:
    s_waitcnt vmcnt(11) lgkmcnt(0)
    s_barrier
    v_mfma_f32_16x16x32_bf16 v[120:123], v[48:51], v[32:35], v[120:123]
    ds_read_b128 v[76:79], v21 offset:0
    s_add_u32 s34, s30, s31
    s_and_b32 s34, s34, 3
    s_andn2_b32 s35, s30, 3
    s_or_b32 s34, s34, s35
    s_mul_i32 s32, s34, 131072
    s_mul_i32 s33, s34, 458752
    s_add_u32 s30, s30, 1
    s_add_u32 m0, s29, 0
    s_nop 0
    buffer_load_dwordx4 v8, s[8:11], s32 offen sc1 lds
    v_mfma_f32_16x16x32_bf16 v[124:127], v[52:55], v[32:35], v[124:127]
    ds_read_b64_tr_b16 v[92:93], v24 offset:0
    v_mfma_f32_16x16x32_bf16 v[128:131], v[56:59], v[32:35], v[128:131]
    ds_read_b64_tr_b16 v[94:95], v24 offset:256
    s_add_u32 m0, s29, 4096
    s_nop 0
    buffer_load_dwordx4 v9, s[8:11], s32 offen sc1 lds
    v_mfma_f32_16x16x32_bf16 v[132:135], v[60:63], v[32:35], v[132:135]
    ds_read_b128 v[80:83], v21 offset:256
    v_mfma_f32_16x16x32_bf16 v[136:139], v[64:67], v[32:35], v[136:139]
    ds_read_b64_tr_b16 v[96:97], v27 offset:0
    v_mfma_f32_16x16x32_bf16 v[140:143], v[68:71], v[32:35], v[140:143]
    ds_read_b64_tr_b16 v[98:99], v27 offset:256
    s_add_u32 m0, s29, 8192
    s_nop 0
    buffer_load_dwordx4 v10, s[8:11], s32 offen sc1 lds
    v_mfma_f32_16x16x32_bf16 v[144:147], v[72:75], v[32:35], v[144:147]
    ds_read_b128 v[84:87], v21 offset:512
    v_mfma_f32_16x16x32_bf16 v[148:151], v[48:51], v[36:39], v[148:151]
    ds_read_b64_tr_b16 v[100:101], v24 offset:4096
    s_add_u32 m0, s29, 12288
    s_nop 0
    buffer_load_dwordx4 v11, s[8:11], s32 offen sc1 lds
    v_mfma_f32_16x16x32_bf16 v[152:155], v[52:55], v[36:39], v[152:155]
    ds_read_b64_tr_b16 v[102:103], v24 offset:4352
    v_mfma_f32_16x16x32_bf16 v[156:159], v[56:59], v[36:39], v[156:159]
    ds_read_b128 v[88:91], v21 offset:768
    v_mfma_f32_16x16x32_bf16 v[160:163], v[60:63], v[36:39], v[160:163]
    ds_read_b64_tr_b16 v[104:105], v27 offset:4096
    s_add_u32 m0, s29, 16384
    s_nop 0
    buffer_load_dwordx4 v12, s[12:15], s33 offen lds
    v_mfma_f32_16x16x32_bf16 v[164:167], v[64:67], v[36:39], v[164:167]
    ds_read_b64_tr_b16 v[106:107], v27 offset:4352
    v_mfma_f32_16x16x32_bf16 v[168:171], v[68:71], v[36:39], v[168:171]
    ds_read_b64_tr_b16 v[108:109], v24 offset:8192
    s_add_u32 m0, s29, 20480
    s_nop 0
    buffer_load_dwordx4 v13, s[12:15], s33 offen lds
    v_mfma_f32_16x16x32_bf16 v[172:175], v[72:75], v[36:39], v[172:175]
    ds_read_b64_tr_b16 v[110:111], v24 offset:8448
    v_mfma_f32_16x16x32_bf16 v[176:179], v[48:51], v[40:43], v[176:179]
    ds_read_b64_tr_b16 v[112:113], v27 offset:8192
    v_mfma_f32_16x16x32_bf16 v[180:183], v[52:55], v[40:43], v[180:183]
    ds_read_b64_tr_b16 v[114:115], v27 offset:8448
    s_add_u32 m0, s29, 24576
    s_nop 0
    buffer_load_dwordx4 v14, s[12:15], s33 offen lds
    v_mfma_f32_16x16x32_bf16 v[184:187], v[56:59], v[40:43], v[184:187]
    ds_read_b64_tr_b16 v[116:117], v30 offset:0
    v_mfma_f32_16x16x32_bf16 v[188:191], v[60:63], v[40:43], v[188:191]
    ds_read_b64_tr_b16 v[118:119], v30 offset:256
    s_add_u32 m0, s29, 28672
    s_nop 0
    buffer_load_dwordx4 v15, s[12:15], s33 offen lds
    v_mfma_f32_16x16x32_bf16 v[192:195], v[64:67], v[40:43], v[192:195]
    v_mfma_f32_16x16x32_bf16 v[196:199], v[68:71], v[40:43], v[196:199]
    v_mfma_f32_16x16x32_bf16 v[200:203], v[72:75], v[40:43], v[200:203]
    s_add_u32 m0, s29, 32768
    s_nop 0
    buffer_load_dwordx4 v16, s[12:15], s33 offen lds
    v_mfma_f32_16x16x32_bf16 v[204:207], v[48:51], v[44:47], v[204:207]
    v_mfma_f32_16x16x32_bf16 v[208:211], v[52:55], v[44:47], v[208:211]
    s_add_u32 m0, s29, 36864
    s_nop 0
    buffer_load_dwordx4 v17, s[12:15], s33 offen lds
    v_mfma_f32_16x16x32_bf16 v[212:215], v[56:59], v[44:47], v[212:215]
    v_mfma_f32_16x16x32_bf16 v[216:219], v[60:63], v[44:47], v[216:219]
    v_mfma_f32_16x16x32_bf16 v[220:223], v[64:67], v[44:47], v[220:223]
    s_add_u32 m0, s29, 40960
    s_nop 0
    buffer_load_dwordx4 v18, s[12:15], s33 offen lds
    v_mfma_f32_16x16x32_bf16 v[224:227], v[68:71], v[44:47], v[224:227]
    v_mfma_f32_16x16x32_bf16 v[228:231], v[72:75], v[44:47], v[228:231]
    s_waitcnt vmcnt(11) lgkmcnt(0)
    s_barrier
    v_mfma_f32_16x16x32_bf16 v[120:123], v[92:95], v[76:79], v[120:123]
    ds_read_b128 v[32:35], v22 offset:0
    s_add_u32 s34, s30, s31
    s_and_b32 s34, s34, 3
    s_andn2_b32 s35, s30, 3
    s_or_b32 s34, s34, s35
    s_mul_i32 s32, s34, 131072
    s_mul_i32 s33, s34, 458752
    s_add_u32 s30, s30, 1
    s_add_u32 m0, s29, 45056
    s_nop 0
    buffer_load_dwordx4 v8, s[8:11], s32 offen sc1 lds
    v_mfma_f32_16x16x32_bf16 v[124:127], v[96:99], v[76:79], v[124:127]
    ds_read_b64_tr_b16 v[48:49], v25 offset:0
    v_mfma_f32_16x16x32_bf16 v[128:131], v[100:103], v[76:79], v[128:131]
    ds_read_b64_tr_b16 v[50:51], v25 offset:256
    s_add_u32 m0, s29, 49152
    s_nop 0
    buffer_load_dwordx4 v9, s[8:11], s32 offen sc1 lds
    v_mfma_f32_16x16x32_bf16 v[132:135], v[104:107], v[76:79], v[132:135]
    ds_read_b128 v[36:39], v22 offset:256
    v_mfma_f32_16x16x32_bf16 v[136:139], v[108:111], v[76:79], v[136:139]
    ds_read_b64_tr_b16 v[52:53], v28 offset:0
    v_mfma_f32_16x16x32_bf16 v[140:143], v[112:115], v[76:79], v[140:143]
    ds_read_b64_tr_b16 v[54:55], v28 offset:256
    s_add_u32 m0, s29, 53248
    s_nop 0
    buffer_load_dwordx4 v10, s[8:11], s32 offen sc1 lds
    v_mfma_f32_16x16x32_bf16 v[144:147], v[116:119], v[76:79], v[144:147]
    ds_read_b128 v[40:43], v22 offset:512
    v_mfma_f32_16x16x32_bf16 v[148:151], v[92:95], v[80:83], v[148:151]
    ds_read_b64_tr_b16 v[56:57], v25 offset:4096
    s_add_u32 m0, s29, 57344
    s_nop 0
    buffer_load_dwordx4 v11, s[8:11], s32 offen sc1 lds
    v_mfma_f32_16x16x32_bf16 v[152:155], v[96:99], v[80:83], v[152:155]
    ds_read_b64_tr_b16 v[58:59], v25 offset:4352
    v_mfma_f32_16x16x32_bf16 v[156:159], v[100:103], v[80:83], v[156:159]
    ds_read_b128 v[44:47], v22 offset:768
    v_mfma_f32_16x16x32_bf16 v[160:163], v[104:107], v[80:83], v[160:163]
    ds_read_b64_tr_b16 v[60:61], v28 offset:4096
    s_add_u32 m0, s29, 61440
    s_nop 0
    buffer_load_dwordx4 v12, s[12:15], s33 offen lds
    v_mfma_f32_16x16x32_bf16 v[164:167], v[108:111], v[80:83], v[164:167]
    ds_read_b64_tr_b16 v[62:63], v28 offset:4352
    v_mfma_f32_16x16x32_bf16 v[168:171], v[112:115], v[80:83], v[168:171]
    ds_read_b64_tr_b16 v[64:65], v25 offset:8192
    s_add_u32 m0, s29, 65536
    s_nop 0
    buffer_load_dwordx4 v13, s[12:15], s33 offen lds
    v_mfma_f32_16x16x32_bf16 v[172:175], v[116:119], v[80:83], v[172:175]
    ds_read_b64_tr_b16 v[66:67], v25 offset:8448
    v_mfma_f32_16x16x32_bf16 v[176:179], v[92:95], v[84:87], v[176:179]
    ds_read_b64_tr_b16 v[68:69], v28 offset:8192
    v_mfma_f32_16x16x32_bf16 v[180:183], v[96:99], v[84:87], v[180:183]
    ds_read_b64_tr_b16 v[70:71], v28 offset:8448
    s_add_u32 m0, s29, 69632
    s_nop 0
    buffer_load_dwordx4 v14, s[12:15], s33 offen lds
    v_mfma_f32_16x16x32_bf16 v[184:187], v[100:103], v[84:87], v[184:187]
    ds_read_b64_tr_b16 v[72:73], v31 offset:0
    v_mfma_f32_16x16x32_bf16 v[188:191], v[104:107], v[84:87], v[188:191]
    ds_read_b64_tr_b16 v[74:75], v31 offset:256
    s_add_u32 m0, s29, 73728
    s_nop 0
    buffer_load_dwordx4 v15, s[12:15], s33 offen lds
    v_mfma_f32_16x16x32_bf16 v[192:195], v[108:111], v[84:87], v[192:195]
    v_mfma_f32_16x16x32_bf16 v[196:199], v[112:115], v[84:87], v[196:199]
    v_mfma_f32_16x16x32_bf16 v[200:203], v[116:119], v[84:87], v[200:203]
    s_add_u32 m0, s29, 77824
    s_nop 0
    buffer_load_dwordx4 v16, s[12:15], s33 offen lds
    v_mfma_f32_16x16x32_bf16 v[204:207], v[92:95], v[88:91], v[204:207]
    v_mfma_f32_16x16x32_bf16 v[208:211], v[96:99], v[88:91], v[208:211]
    s_add_u32 m0, s29, 81920
    s_nop 0
    buffer_load_dwordx4 v17, s[12:15], s33 offen lds
    v_mfma_f32_16x16x32_bf16 v[212:215], v[100:103], v[88:91], v[212:215]
    v_mfma_f32_16x16x32_bf16 v[216:219], v[104:107], v[88:91], v[216:219]
    v_mfma_f32_16x16x32_bf16 v[220:223], v[108:111], v[88:91], v[220:223]
    s_add_u32 m0, s29, 86016
    s_nop 0
    buffer_load_dwordx4 v18, s[12:15], s33 offen lds
    v_mfma_f32_16x16x32_bf16 v[224:227], v[112:115], v[88:91], v[224:227]
    v_mfma_f32_16x16x32_bf16 v[228:231], v[116:119], v[88:91], v[228:231]
    s_waitcnt vmcnt(11) lgkmcnt(0)
    s_barrier
    v_mfma_f32_16x16x32_bf16 v[120:123], v[48:51], v[32:35], v[120:123]
    ds_read_b128 v[76:79], v20 offset:0
    s_add_u32 s34, s30, s31
    s_and_b32 s34, s34, 3
    s_andn2_b32 s35, s30, 3
    s_or_b32 s34, s34, s35
    s_mul_i32 s32, s34, 131072
    s_mul_i32 s33, s34, 458752
    s_add_u32 s30, s30, 1
    s_add_u32 m0, s29, 90112
    s_nop 0
    buffer_load_dwordx4 v8, s[8:11], s32 offen sc1 lds
    v_mfma_f32_16x16x32_bf16 v[124:127], v[52:55], v[32:35], v[124:127]
    ds_read_b64_tr_b16 v[92:93], v23 offset:0
    v_mfma_f32_16x16x32_bf16 v[128:131], v[56:59], v[32:35], v[128:131]
    ds_read_b64_tr_b16 v[94:95], v23 offset:256
    s_add_u32 m0, s29, 94208
    s_nop 0
    buffer_load_dwordx4 v9, s[8:11], s32 offen sc1 lds
    v_mfma_f32_16x16x32_bf16 v[132:135], v[60:63], v[32:35], v[132:135]
    ds_read_b128 v[80:83], v20 offset:256
    v_mfma_f32_16x16x32_bf16 v[136:139], v[64:67], v[32:35], v[136:139]
    ds_read_b64_tr_b16 v[96:97], v26 offset:0
    v_mfma_f32_16x16x32_bf16 v[140:143], v[68:71], v[32:35], v[140:143]
    ds_read_b64_tr_b16 v[98:99], v26 offset:256
    s_add_u32 m0, s29, 98304
    s_nop 0
    buffer_load_dwordx4 v10, s[8:11], s32 offen sc1 lds
    v_mfma_f32_16x16x32_bf16 v[144:147], v[72:75], v[32:35], v[144:147]
    ds_read_b128 v[84:87], v20 offset:512
    v_mfma_f32_16x16x32_bf16 v[148:151], v[48:51], v[36:39], v[148:151]
    ds_read_b64_tr_b16 v[100:101], v23 offset:4096
    s_add_u32 m0, s29, 102400
    s_nop 0
    buffer_load_dwordx4 v11, s[8:11], s32 offen sc1 lds
    v_mfma_f32_16x16x32_bf16 v[152:155], v[52:55], v[36:39], v[152:155]
    ds_read_b64_tr_b16 v[102:103], v23 offset:4352
    v_mfma_f32_16x16x32_bf16 v[156:159], v[56:59], v[36:39], v[156:159]
    ds_read_b128 v[88:91], v20 offset:768
    v_mfma_f32_16x16x32_bf16 v[160:163], v[60:63], v[36:39], v[160:163]
    ds_read_b64_tr_b16 v[104:105], v26 offset:4096
    s_add_u32 m0, s29, 106496
    s_nop 0
    buffer_load_dwordx4 v12, s[12:15], s33 offen lds
    v_mfma_f32_16x16x32_bf16 v[164:167], v[64:67], v[36:39], v[164:167]
    ds_read_b64_tr_b16 v[106:107], v26 offset:4352
    v_mfma_f32_16x16x32_bf16 v[168:171], v[68:71], v[36:39], v[168:171]
    ds_read_b64_tr_b16 v[108:109], v23 offset:8192
    s_add_u32 m0, s29, 110592
    s_nop 0
    buffer_load_dwordx4 v13, s[12:15], s33 offen lds
    v_mfma_f32_16x16x32_bf16 v[172:175], v[72:75], v[36:39], v[172:175]
    ds_read_b64_tr_b16 v[110:111], v23 offset:8448
    v_mfma_f32_16x16x32_bf16 v[176:179], v[48:51], v[40:43], v[176:179]
    ds_read_b64_tr_b16 v[112:113], v26 offset:8192
    v_mfma_f32_16x16x32_bf16 v[180:183], v[52:55], v[40:43], v[180:183]
    ds_read_b64_tr_b16 v[114:115], v26 offset:8448
    s_add_u32 m0, s29, 114688
    s_nop 0
    buffer_load_dwordx4 v14, s[12:15], s33 offen lds
    v_mfma_f32_16x16x32_bf16 v[184:187], v[56:59], v[40:43], v[184:187]
    ds_read_b64_tr_b16 v[116:117], v29 offset:0
    v_mfma_f32_16x16x32_bf16 v[188:191], v[60:63], v[40:43], v[188:191]
    ds_read_b64_tr_b16 v[118:119], v29 offset:256
    s_add_u32 m0, s29, 118784
    s_nop 0
    buffer_load_dwordx4 v15, s[12:15], s33 offen lds
    v_mfma_f32_16x16x32_bf16 v[192:195], v[64:67], v[40:43], v[192:195]
    v_mfma_f32_16x16x32_bf16 v[196:199], v[68:71], v[40:43], v[196:199]
    v_mfma_f32_16x16x32_bf16 v[200:203], v[72:75], v[40:43], v[200:203]
    s_add_u32 m0, s29, 122880
    s_nop 0
    buffer_load_dwordx4 v16, s[12:15], s33 offen lds
    v_mfma_f32_16x16x32_bf16 v[204:207], v[48:51], v[44:47], v[204:207]
    v_mfma_f32_16x16x32_bf16 v[208:211], v[52:55], v[44:47], v[208:211]
    s_add_u32 m0, s29, 126976
    s_nop 0
    buffer_load_dwordx4 v17, s[12:15], s33 offen lds
    v_mfma_f32_16x16x32_bf16 v[212:215], v[56:59], v[44:47], v[212:215]
    v_mfma_f32_16x16x32_bf16 v[216:219], v[60:63], v[44:47], v[216:219]
    v_mfma_f32_16x16x32_bf16 v[220:223], v[64:67], v[44:47], v[220:223]
    s_add_u32 m0, s29, 131072
    s_nop 0
    buffer_load_dwordx4 v18, s[12:15], s33 offen lds
    v_mfma_f32_16x16x32_bf16 v[224:227], v[68:71], v[44:47], v[224:227]
    v_mfma_f32_16x16x32_bf16 v[228:231], v[72:75], v[44:47], v[228:231]
    s_waitcnt vmcnt(11) lgkmcnt(0)
    s_barrier
    v_mfma_f32_16x16x32_bf16 v[120:123], v[92:95], v[76:79], v[120:123]
    ds_read_b128 v[32:35], v21 offset:0
    s_add_u32 s34, s30, s31
    s_and_b32 s34, s34, 3
    s_andn2_b32 s35, s30, 3
    s_or_b32 s34, s34, s35
    s_mul_i32 s32, s34, 131072
    s_mul_i32 s33, s34, 458752
    s_add_u32 s30, s30, 1
    s_add_u32 m0, s29, 0
    s_nop 0
    buffer_load_dwordx4 v8, s[8:11], s32 offen sc1 lds
    v_mfma_f32_16x16x32_bf16 v[124:127], v[96:99], v[76:79], v[124:127]
    ds_read_b64_tr_b16 v[48:49], v24 offset:0
    v_mfma_f32_16x16x32_bf16 v[128:131], v[100:103], v[76:79], v[128:131]
    ds_read_b64_tr_b16 v[50:51], v24 offset:256
    s_add_u32 m0, s29, 4096
    s_nop 0
    buffer_load_dwordx4 v9, s[8:11], s32 offen sc1 lds
    v_mfma_f32_16x16x32_bf16 v[132:135], v[104:107], v[76:79], v[132:135]
    ds_read_b128 v[36:39], v21 offset:256
    v_mfma_f32_16x16x32_bf16 v[136:139], v[108:111], v[76:79], v[136:139]
    ds_read_b64_tr_b16 v[52:53], v27 offset:0
    v_mfma_f32_16x16x32_bf16 v[140:143], v[112:115], v[76:79], v[140:143]
    ds_read_b64_tr_b16 v[54:55], v27 offset:256
    s_add_u32 m0, s29, 8192
    s_nop 0
    buffer_load_dwordx4 v10, s[8:11], s32 offen sc1 lds
    v_mfma_f32_16x16x32_bf16 v[144:147], v[116:119], v[76:79], v[144:147]
    ds_read_b128 v[40:43], v21 offset:512
    v_mfma_f32_16x16x32_bf16 v[148:151], v[92:95], v[80:83], v[148:151]
    ds_read_b64_tr_b16 v[56:57], v24 offset:4096
    s_add_u32 m0, s29, 12288
    s_nop 0
    buffer_load_dwordx4 v11, s[8:11], s32 offen sc1 lds
    v_mfma_f32_16x16x32_bf16 v[152:155], v[96:99], v[80:83], v[152:155]
    ds_read_b64_tr_b16 v[58:59], v24 offset:4352
    v_mfma_f32_16x16x32_bf16 v[156:159], v[100:103], v[80:83], v[156:159]
    ds_read_b128 v[44:47], v21 offset:768
    v_mfma_f32_16x16x32_bf16 v[160:163], v[104:107], v[80:83], v[160:163]
    ds_read_b64_tr_b16 v[60:61], v27 offset:4096
    s_add_u32 m0, s29, 16384
    s_nop 0
    buffer_load_dwordx4 v12, s[12:15], s33 offen lds
    v_mfma_f32_16x16x32_bf16 v[164:167], v[108:111], v[80:83], v[164:167]
    ds_read_b64_tr_b16 v[62:63], v27 offset:4352
    v_mfma_f32_16x16x32_bf16 v[168:171], v[112:115], v[80:83], v[168:171]
    ds_read_b64_tr_b16 v[64:65], v24 offset:8192
    s_add_u32 m0, s29, 20480
    s_nop 0
    buffer_load_dwordx4 v13, s[12:15], s33 offen lds
    v_mfma_f32_16x16x32_bf16 v[172:175], v[116:119], v[80:83], v[172:175]
    ds_read_b64_tr_b16 v[66:67], v24 offset:8448
    v_mfma_f32_16x16x32_bf16 v[176:179], v[92:95], v[84:87], v[176:179]
    ds_read_b64_tr_b16 v[68:69], v27 offset:8192
    v_mfma_f32_16x16x32_bf16 v[180:183], v[96:99], v[84:87], v[180:183]
    ds_read_b64_tr_b16 v[70:71], v27 offset:8448
    s_add_u32 m0, s29, 24576
    s_nop 0
    buffer_load_dwordx4 v14, s[12:15], s33 offen lds
    v_mfma_f32_16x16x32_bf16 v[184:187], v[100:103], v[84:87], v[184:187]
    ds_read_b64_tr_b16 v[72:73], v30 offset:0
    v_mfma_f32_16x16x32_bf16 v[188:191], v[104:107], v[84:87], v[188:191]
    ds_read_b64_tr_b16 v[74:75], v30 offset:256
    s_add_u32 m0, s29, 28672
    s_nop 0
    buffer_load_dwordx4 v15, s[12:15], s33 offen lds
    v_mfma_f32_16x16x32_bf16 v[192:195], v[108:111], v[84:87], v[192:195]
    v_mfma_f32_16x16x32_bf16 v[196:199], v[112:115], v[84:87], v[196:199]
    v_mfma_f32_16x16x32_bf16 v[200:203], v[116:119], v[84:87], v[200:203]
    s_add_u32 m0, s29, 32768
    s_nop 0
    buffer_load_dwordx4 v16, s[12:15], s33 offen lds
    v_mfma_f32_16x16x32_bf16 v[204:207], v[92:95], v[88:91], v[204:207]
    v_mfma_f32_16x16x32_bf16 v[208:211], v[96:99], v[88:91], v[208:211]
    s_add_u32 m0, s29, 36864
    s_nop 0
    buffer_load_dwordx4 v17, s[12:15], s33 offen lds
    v_mfma_f32_16x16x32_bf16 v[212:215], v[100:103], v[88:91], v[212:215]
    v_mfma_f32_16x16x32_bf16 v[216:219], v[104:107], v[88:91], v[216:219]
    v_mfma_f32_16x16x32_bf16 v[220:223], v[108:111], v[88:91], v[220:223]
    s_add_u32 m0, s29, 40960
    s_nop 0
    buffer_load_dwordx4 v18, s[12:15], s33 offen lds
    v_mfma_f32_16x16x32_bf16 v[224:227], v[112:115], v[88:91], v[224:227]
    v_mfma_f32_16x16x32_bf16 v[228:231], v[116:119], v[88:91], v[228:231]
    s_waitcnt vmcnt(11) lgkmcnt(0)
    s_barrier
    v_mfma_f32_16x16x32_bf16 v[120:123], v[48:51], v[32:35], v[120:123]
    ds_read_b128 v[76:79], v22 offset:0
    s_add_u32 s34, s30, s31
    s_and_b32 s34, s34, 3
    s_andn2_b32 s35, s30, 3
    s_or_b32 s34, s34, s35
    s_mul_i32 s32, s34, 131072
    s_mul_i32 s33, s34, 458752
    s_add_u32 s30, s30, 1
    s_add_u32 m0, s29, 45056
    s_nop 0
    buffer_load_dwordx4 v8, s[8:11], s32 offen sc1 lds
    v_mfma_f32_16x16x32_bf16 v[124:127], v[52:55], v[32:35], v[124:127]
    ds_read_b64_tr_b16 v[92:93], v25 offset:0
    v_mfma_f32_16x16x32_bf16 v[128:131], v[56:59], v[32:35], v[128:131]
    ds_read_b64_tr_b16 v[94:95], v25 offset:256
    s_add_u32 m0, s29, 49152
    s_nop 0
    buffer_load_dwordx4 v9, s[8:11], s32 offen sc1 lds
    v_mfma_f32_16x16x32_bf16 v[132:135], v[60:63], v[32:35], v[132:135]
    ds_read_b128 v[80:83], v22 offset:256
    v_mfma_f32_16x16x32_bf16 v[136:139], v[64:67], v[32:35], v[136:139]
    ds_read_b64_tr_b16 v[96:97], v28 offset:0
    v_mfma_f32_16x16x32_bf16 v[140:143], v[68:71], v[32:35], v[140:143]
    ds_read_b64_tr_b16 v[98:99], v28 offset:256
    s_add_u32 m0, s29, 53248
    s_nop 0
    buffer_load_dwordx4 v10, s[8:11], s32 offen sc1 lds
    v_mfma_f32_16x16x32_bf16 v[144:147], v[72:75], v[32:35], v[144:147]
    ds_read_b128 v[84:87], v22 offset:512
    v_mfma_f32_16x16x32_bf16 v[148:151], v[48:51], v[36:39], v[148:151]
    ds_read_b64_tr_b16 v[100:101], v25 offset:4096
    s_add_u32 m0, s29, 57344
    s_nop 0
    buffer_load_dwordx4 v11, s[8:11], s32 offen sc1 lds
    v_mfma_f32_16x16x32_bf16 v[152:155], v[52:55], v[36:39], v[152:155]
    ds_read_b64_tr_b16 v[102:103], v25 offset:4352
    v_mfma_f32_16x16x32_bf16 v[156:159], v[56:59], v[36:39], v[156:159]
    ds_read_b128 v[88:91], v22 offset:768
    v_mfma_f32_16x16x32_bf16 v[160:163], v[60:63], v[36:39], v[160:163]
    ds_read_b64_tr_b16 v[104:105], v28 offset:4096
    s_add_u32 m0, s29, 61440
    s_nop 0
    buffer_load_dwordx4 v12, s[12:15], s33 offen lds
    v_mfma_f32_16x16x32_bf16 v[164:167], v[64:67], v[36:39], v[164:167]
    ds_read_b64_tr_b16 v[106:107], v28 offset:4352
    v_mfma_f32_16x16x32_bf16 v[168:171], v[68:71], v[36:39], v[168:171]
    ds_read_b64_tr_b16 v[108:109], v25 offset:8192
    s_add_u32 m0, s29, 65536
    s_nop 0
    buffer_load_dwordx4 v13, s[12:15], s33 offen lds
    v_mfma_f32_16x16x32_bf16 v[172:175], v[72:75], v[36:39], v[172:175]
    ds_read_b64_tr_b16 v[110:111], v25 offset:8448
    v_mfma_f32_16x16x32_bf16 v[176:179], v[48:51], v[40:43], v[176:179]
    ds_read_b64_tr_b16 v[112:113], v28 offset:8192
    v_mfma_f32_16x16x32_bf16 v[180:183], v[52:55], v[40:43], v[180:183]
    ds_read_b64_tr_b16 v[114:115], v28 offset:8448
    s_add_u32 m0, s29, 69632
    s_nop 0
    buffer_load_dwordx4 v14, s[12:15], s33 offen lds
    v_mfma_f32_16x16x32_bf16 v[184:187], v[56:59], v[40:43], v[184:187]
    ds_read_b64_tr_b16 v[116:117], v31 offset:0
    v_mfma_f32_16x16x32_bf16 v[188:191], v[60:63], v[40:43], v[188:191]
    ds_read_b64_tr_b16 v[118:119], v31 offset:256
    s_add_u32 m0, s29, 73728
    s_nop 0
    buffer_load_dwordx4 v15, s[12:15], s33 offen lds
    v_mfma_f32_16x16x32_bf16 v[192:195], v[64:67], v[40:43], v[192:195]
    v_mfma_f32_16x16x32_bf16 v[196:199], v[68:71], v[40:43], v[196:199]
    v_mfma_f32_16x16x32_bf16 v[200:203], v[72:75], v[40:43], v[200:203]
    s_add_u32 m0, s29, 77824
    s_nop 0
    buffer_load_dwordx4 v16, s[12:15], s33 offen lds
    v_mfma_f32_16x16x32_bf16 v[204:207], v[48:51], v[44:47], v[204:207]
    v_mfma_f32_16x16x32_bf16 v[208:211], v[52:55], v[44:47], v[208:211]
    s_add_u32 m0, s29, 81920
    s_nop 0
    buffer_load_dwordx4 v17, s[12:15], s33 offen lds
    v_mfma_f32_16x16x32_bf16 v[212:215], v[56:59], v[44:47], v[212:215]
    v_mfma_f32_16x16x32_bf16 v[216:219], v[60:63], v[44:47], v[216:219]
    v_mfma_f32_16x16x32_bf16 v[220:223], v[64:67], v[44:47], v[220:223]
    s_add_u32 m0, s29, 86016
    s_nop 0
    buffer_load_dwordx4 v18, s[12:15], s33 offen lds
    v_mfma_f32_16x16x32_bf16 v[224:227], v[68:71], v[44:47], v[224:227]
    v_mfma_f32_16x16x32_bf16 v[228:231], v[72:75], v[44:47], v[228:231]
    s_waitcnt vmcnt(11) lgkmcnt(0)
    s_barrier
    v_mfma_f32_16x16x32_bf16 v[120:123], v[92:95], v[76:79], v[120:123]
    ds_read_b128 v[32:35], v20 offset:0
    s_add_u32 s34, s30, s31
    s_and_b32 s34, s34, 3
    s_andn2_b32 s35, s30, 3
    s_or_b32 s34, s34, s35
    s_mul_i32 s32, s34, 131072
    s_mul_i32 s33, s34, 458752
    s_add_u32 s30, s30, 1
    s_add_u32 m0, s29, 90112
    s_nop 0
    buffer_load_dwordx4 v8, s[8:11], s32 offen sc1 lds
    v_mfma_f32_16x16x32_bf16 v[124:127], v[96:99], v[76:79], v[124:127]
    ds_read_b64_tr_b16 v[48:49], v23 offset:0
    v_mfma_f32_16x16x32_bf16 v[128:131], v[100:103], v[76:79], v[128:131]
    ds_read_b64_tr_b16 v[50:51], v23 offset:256
    s_add_u32 m0, s29, 94208
    s_nop 0
    buffer_load_dwordx4 v9, s[8:11], s32 offen sc1 lds
    v_mfma_f32_16x16x32_bf16 v[132:135], v[104:107], v[76:79], v[132:135]
    ds_read_b128 v[36:39], v20 offset:256
    v_mfma_f32_16x16x32_bf16 v[136:139], v[108:111], v[76:79], v[136:139]
    ds_read_b64_tr_b16 v[52:53], v26 offset:0
    v_mfma_f32_16x16x32_bf16 v[140:143], v[112:115], v[76:79], v[140:143]
    ds_read_b64_tr_b16 v[54:55], v26 offset:256
    s_add_u32 m0, s29, 98304
    s_nop 0
    buffer_load_dwordx4 v10, s[8:11], s32 offen sc1 lds
    v_mfma_f32_16x16x32_bf16 v[144:147], v[116:119], v[76:79], v[144:147]
    ds_read_b128 v[40:43], v20 offset:512
    v_mfma_f32_16x16x32_bf16 v[148:151], v[92:95], v[80:83], v[148:151]
    ds_read_b64_tr_b16 v[56:57], v23 offset:4096
    s_add_u32 m0, s29, 102400
    s_nop 0
    buffer_load_dwordx4 v11, s[8:11], s32 offen sc1 lds
    v_mfma_f32_16x16x32_bf16 v[152:155], v[96:99], v[80:83], v[152:155]
    ds_read_b64_tr_b16 v[58:59], v23 offset:4352
    v_mfma_f32_16x16x32_bf16 v[156:159], v[100:103], v[80:83], v[156:159]
    ds_read_b128 v[44:47], v20 offset:768
    v_mfma_f32_16x16x32_bf16 v[160:163], v[104:107], v[80:83], v[160:163]
    ds_read_b64_tr_b16 v[60:61], v26 offset:4096
    s_add_u32 m0, s29, 106496
    s_nop 0
    buffer_load_dwordx4 v12, s[12:15], s33 offen lds
    v_mfma_f32_16x16x32_bf16 v[164:167], v[108:111], v[80:83], v[164:167]
    ds_read_b64_tr_b16 v[62:63], v26 offset:4352
    v_mfma_f32_16x16x32_bf16 v[168:171], v[112:115], v[80:83], v[168:171]
    ds_read_b64_tr_b16 v[64:65], v23 offset:8192
    s_add_u32 m0, s29, 110592
    s_nop 0
    buffer_load_dwordx4 v13, s[12:15], s33 offen lds
    v_mfma_f32_16x16x32_bf16 v[172:175], v[116:119], v[80:83], v[172:175]
    ds_read_b64_tr_b16 v[66:67], v23 offset:8448
    v_mfma_f32_16x16x32_bf16 v[176:179], v[92:95], v[84:87], v[176:179]
    ds_read_b64_tr_b16 v[68:69], v26 offset:8192
    v_mfma_f32_16x16x32_bf16 v[180:183], v[96:99], v[84:87], v[180:183]
    ds_read_b64_tr_b16 v[70:71], v26 offset:8448
    s_add_u32 m0, s29, 114688
    s_nop 0
    buffer_load_dwordx4 v14, s[12:15], s33 offen lds
    v_mfma_f32_16x16x32_bf16 v[184:187], v[100:103], v[84:87], v[184:187]
    ds_read_b64_tr_b16 v[72:73], v29 offset:0
    v_mfma_f32_16x16x32_bf16 v[188:191], v[104:107], v[84:87], v[188:191]
    ds_read_b64_tr_b16 v[74:75], v29 offset:256
    s_add_u32 m0, s29, 118784
    s_nop 0
    buffer_load_dwordx4 v15, s[12:15], s33 offen lds
    v_mfma_f32_16x16x32_bf16 v[192:195], v[108:111], v[84:87], v[192:195]
    v_mfma_f32_16x16x32_bf16 v[196:199], v[112:115], v[84:87], v[196:199]
    v_mfma_f32_16x16x32_bf16 v[200:203], v[116:119], v[84:87], v[200:203]
    s_add_u32 m0, s29, 122880
    s_nop 0
    buffer_load_dwordx4 v16, s[12:15], s33 offen lds
    v_mfma_f32_16x16x32_bf16 v[204:207], v[92:95], v[88:91], v[204:207]
    v_mfma_f32_16x16x32_bf16 v[208:211], v[96:99], v[88:91], v[208:211]
    s_add_u32 m0, s29, 126976
    s_nop 0
    buffer_load_dwordx4 v17, s[12:15], s33 offen lds
    v_mfma_f32_16x16x32_bf16 v[212:215], v[100:103], v[88:91], v[212:215]
    v_mfma_f32_16x16x32_bf16 v[216:219], v[104:107], v[88:91], v[216:219]
    v_mfma_f32_16x16x32_bf16 v[220:223], v[108:111], v[88:91], v[220:223]
    s_add_u32 m0, s29, 131072
    s_nop 0
    buffer_load_dwordx4 v18, s[12:15], s33 offen lds
    v_mfma_f32_16x16x32_bf16 v[224:227], v[112:115], v[88:91], v[224:227]
    v_mfma_f32_16x16x32_bf16 v[228:231], v[116:119], v[88:91], v[228:231]
    s_sub_u32 s36, s36, 1
    s_cmp_lg_u32 s36, 0
    s_cbranch_scc1 L_g_3035
    s_waitcnt vmcnt(11) lgkmcnt(0)
    s_barrier
    v_mfma_f32_16x16x32_bf16 v[120:123], v[48:51], v[32:35], v[120:123]
    ds_read_b128 v[76:79], v21 offset:0
    s_add_u32 s34, s30, s31
    s_and_b32 s34, s34, 3
    s_andn2_b32 s35, s30, 3
    s_or_b32 s34, s34, s35
    s_mul_i32 s32, s34, 131072
    s_mul_i32 s33, s34, 458752
    s_add_u32 s30, s30, 1
    s_add_u32 m0, s29, 0
    s_nop 0
    buffer_load_dwordx4 v8, s[8:11], s32 offen sc1 lds
    v_mfma_f32_16x16x32_bf16 v[124:127], v[52:55], v[32:35], v[124:127]
    ds_read_b64_tr_b16 v[92:93], v24 offset:0
    v_mfma_f32_16x16x32_bf16 v[128:131], v[56:59], v[32:35], v[128:131]
    ds_read_b64_tr_b16 v[94:95], v24 offset:256
    s_add_u32 m0, s29, 4096
    s_nop 0
    buffer_load_dwordx4 v9, s[8:11], s32 offen sc1 lds
    v_mfma_f32_16x16x32_bf16 v[132:135], v[60:63], v[32:35], v[132:135]
    ds_read_b128 v[80:83], v21 offset:256
    v_mfma_f32_16x16x32_bf16 v[136:139], v[64:67], v[32:35], v[136:139]
    ds_read_b64_tr_b16 v[96:97], v27 offset:0
    v_mfma_f32_16x16x32_bf16 v[140:143], v[68:71], v[32:35], v[140:143]
    ds_read_b64_tr_b16 v[98:99], v27 offset:256
    s_add_u32 m0, s29, 8192
    s_nop 0
    buffer_load_dwordx4 v10, s[8:11], s32 offen sc1 lds
    v_mfma_f32_16x16x32_bf16 v[144:147], v[72:75], v[32:35], v[144:147]
    ds_read_b128 v[84:87], v21 offset:512
    v_mfma_f32_16x16x32_bf16 v[148:151], v[48:51], v[36:39], v[148:151]
    ds_read_b64_tr_b16 v[100:101], v24 offset:4096
    s_add_u32 m0, s29, 12288
    s_nop 0
    buffer_load_dwordx4 v11, s[8:11], s32 offen sc1 lds
    v_mfma_f32_16x16x32_bf16 v[152:155], v[52:55], v[36:39], v[152:155]
    ds_read_b64_tr_b16 v[102:103], v24 offset:4352
    v_mfma_f32_16x16x32_bf16 v[156:159], v[56:59], v[36:39], v[156:159]
    ds_read_b128 v[88:91], v21 offset:768
    v_mfma_f32_16x16x32_bf16 v[160:163], v[60:63], v[36:39], v[160:163]
    ds_read_b64_tr_b16 v[104:105], v27 offset:4096
    s_add_u32 m0, s29, 16384
    s_nop 0
    buffer_load_dwordx4 v12, s[12:15], s33 offen lds
    v_mfma_f32_16x16x32_bf16 v[164:167], v[64:67], v[36:39], v[164:167]
    ds_read_b64_tr_b16 v[106:107], v27 offset:4352
    v_mfma_f32_16x16x32_bf16 v[168:171], v[68:71], v[36:39], v[168:171]
    ds_read_b64_tr_b16 v[108:109], v24 offset:8192
    s_add_u32 m0, s29, 20480
    s_nop 0
    buffer_load_dwordx4 v13, s[12:15], s33 offen lds
    v_mfma_f32_16x16x32_bf16 v[172:175], v[72:75], v[36:39], v[172:175]
    ds_read_b64_tr_b16 v[110:111], v24 offset:8448
    v_mfma_f32_16x16x32_bf16 v[176:179], v[48:51], v[40:43], v[176:179]
    ds_read_b64_tr_b16 v[112:113], v27 offset:8192
    v_mfma_f32_16x16x32_bf16 v[180:183], v[52:55], v[40:43], v[180:183]
    ds_read_b64_tr_b16 v[114:115], v27 offset:8448
    s_add_u32 m0, s29, 24576
    s_nop 0
    buffer_load_dwordx4 v14, s[12:15], s33 offen lds
    v_mfma_f32_16x16x32_bf16 v[184:187], v[56:59], v[40:43], v[184:187]
    ds_read_b64_tr_b16 v[116:117], v30 offset:0
    v_mfma_f32_16x16x32_bf16 v[188:191], v[60:63], v[40:43], v[188:191]
    ds_read_b64_tr_b16 v[118:119], v30 offset:256
    s_add_u32 m0, s29, 28672
    s_nop 0
    buffer_load_dwordx4 v15, s[12:15], s33 offen lds
    v_mfma_f32_16x16x32_bf16 v[192:195], v[64:67], v[40:43], v[192:195]
    v_mfma_f32_16x16x32_bf16 v[196:199], v[68:71], v[40:43], v[196:199]
    v_mfma_f32_16x16x32_bf16 v[200:203], v[72:75], v[40:43], v[200:203]
    s_add_u32 m0, s29, 32768
    s_nop 0
    buffer_load_dwordx4 v16, s[12:15], s33 offen lds
    v_mfma_f32_16x16x32_bf16 v[204:207], v[48:51], v[44:47], v[204:207]
    v_mfma_f32_16x16x32_bf16 v[208:211], v[52:55], v[44:47], v[208:211]
    s_add_u32 m0, s29, 36864
    s_nop 0
    buffer_load_dwordx4 v17, s[12:15], s33 offen lds
    v_mfma_f32_16x16x32_bf16 v[212:215], v[56:59], v[44:47], v[212:215]
    v_mfma_f32_16x16x32_bf16 v[216:219], v[60:63], v[44:47], v[216:219]
    v_mfma_f32_16x16x32_bf16 v[220:223], v[64:67], v[44:47], v[220:223]
    s_add_u32 m0, s29, 40960
    s_nop 0
    buffer_load_dwordx4 v18, s[12:15], s33 offen lds
    v_mfma_f32_16x16x32_bf16 v[224:227], v[68:71], v[44:47], v[224:227]
    v_mfma_f32_16x16x32_bf16 v[228:231], v[72:75], v[44:47], v[228:231]
    s_waitcnt vmcnt(11) lgkmcnt(0)
    s_barrier
    v_mfma_f32_16x16x32_bf16 v[120:123], v[92:95], v[76:79], v[120:123]
    ds_read_b128 v[32:35], v22 offset:0
    s_add_u32 s34, s30, s31
    s_and_b32 s34, s34, 3
    s_andn2_b32 s35, s30, 3
    s_or_b32 s34, s34, s35
    s_mul_i32 s32, s34, 131072
    s_mul_i32 s33, s34, 458752
    s_add_u32 s30, s30, 1
    s_add_u32 m0, s29, 45056
    s_nop 0
    buffer_load_dwordx4 v8, s[8:11], s32 offen sc1 lds
    v_mfma_f32_16x16x32_bf16 v[124:127], v[96:99], v[76:79], v[124:127]
    ds_read_b64_tr_b16 v[48:49], v25 offset:0
    v_mfma_f32_16x16x32_bf16 v[128:131], v[100:103], v[76:79], v[128:131]
    ds_read_b64_tr_b16 v[50:51], v25 offset:256
    s_add_u32 m0, s29, 49152
    s_nop 0
    buffer_load_dwordx4 v9, s[8:11], s32 offen sc1 lds
    v_mfma_f32_16x16x32_bf16 v[132:135], v[104:107], v[76:79], v[132:135]
    ds_read_b128 v[36:39], v22 offset:256
    v_mfma_f32_16x16x32_bf16 v[136:139], v[108:111], v[76:79], v[136:139]
    ds_read_b64_tr_b16 v[52:53], v28 offset:0
    v_mfma_f32_16x16x32_bf16 v[140:143], v[112:115], v[76:79], v[140:143]
    ds_read_b64_tr_b16 v[54:55], v28 offset:256
    s_add_u32 m0, s29, 53248
    s_nop 0
    buffer_load_dwordx4 v10, s[8:11], s32 offen sc1 lds
    v_mfma_f32_16x16x32_bf16 v[144:147], v[116:119], v[76:79], v[144:147]
    ds_read_b128 v[40:43], v22 offset:512
    v_mfma_f32_16x16x32_bf16 v[148:151], v[92:95], v[80:83], v[148:151]
    ds_read_b64_tr_b16 v[56:57], v25 offset:4096
    s_add_u32 m0, s29, 57344
    s_nop 0
    buffer_load_dwordx4 v11, s[8:11], s32 offen sc1 lds
    v_mfma_f32_16x16x32_bf16 v[152:155], v[96:99], v[80:83], v[152:155]
    ds_read_b64_tr_b16 v[58:59], v25 offset:4352
    v_mfma_f32_16x16x32_bf16 v[156:159], v[100:103], v[80:83], v[156:159]
    ds_read_b128 v[44:47], v22 offset:768
    v_mfma_f32_16x16x32_bf16 v[160:163], v[104:107], v[80:83], v[160:163]
    ds_read_b64_tr_b16 v[60:61], v28 offset:4096
    s_add_u32 m0, s29, 61440
    s_nop 0
    buffer_load_dwordx4 v12, s[12:15], s33 offen lds
    v_mfma_f32_16x16x32_bf16 v[164:167], v[108:111], v[80:83], v[164:167]
    ds_read_b64_tr_b16 v[62:63], v28 offset:4352
    v_mfma_f32_16x16x32_bf16 v[168:171], v[112:115], v[80:83], v[168:171]
    ds_read_b64_tr_b16 v[64:65], v25 offset:8192
    s_add_u32 m0, s29, 65536
    s_nop 0
    buffer_load_dwordx4 v13, s[12:15], s33 offen lds
    v_mfma_f32_16x16x32_bf16 v[172:175], v[116:119], v[80:83], v[172:175]
    ds_read_b64_tr_b16 v[66:67], v25 offset:8448
    v_mfma_f32_16x16x32_bf16 v[176:179], v[92:95], v[84:87], v[176:179]
    ds_read_b64_tr_b16 v[68:69], v28 offset:8192
    v_mfma_f32_16x16x32_bf16 v[180:183], v[96:99], v[84:87], v[180:183]
    ds_read_b64_tr_b16 v[70:71], v28 offset:8448
    s_add_u32 m0, s29, 69632
    s_nop 0
    buffer_load_dwordx4 v14, s[12:15], s33 offen lds
    v_mfma_f32_16x16x32_bf16 v[184:187], v[100:103], v[84:87], v[184:187]
    ds_read_b64_tr_b16 v[72:73], v31 offset:0
    v_mfma_f32_16x16x32_bf16 v[188:191], v[104:107], v[84:87], v[188:191]
    ds_read_b64_tr_b16 v[74:75], v31 offset:256
    s_add_u32 m0, s29, 73728
    s_nop 0
    buffer_load_dwordx4 v15, s[12:15], s33 offen lds
    v_mfma_f32_16x16x32_bf16 v[192:195], v[108:111], v[84:87], v[192:195]
    v_mfma_f32_16x16x32_bf16 v[196:199], v[112:115], v[84:87], v[196:199]
    v_mfma_f32_16x16x32_bf16 v[200:203], v[116:119], v[84:87], v[200:203]
    s_add_u32 m0, s29, 77824
    s_nop 0
    buffer_load_dwordx4 v16, s[12:15], s33 offen lds
    v_mfma_f32_16x16x32_bf16 v[204:207], v[92:95], v[88:91], v[204:207]
    v_mfma_f32_16x16x32_bf16 v[208:211], v[96:99], v[88:91], v[208:211]
    s_add_u32 m0, s29, 81920
    s_nop 0
    buffer_load_dwordx4 v17, s[12:15], s33 offen lds
    v_mfma_f32_16x16x32_bf16 v[212:215], v[100:103], v[88:91], v[212:215]
    v_mfma_f32_16x16x32_bf16 v[216:219], v[104:107], v[88:91], v[216:219]
    v_mfma_f32_16x16x32_bf16 v[220:223], v[108:111], v[88:91], v[220:223]
    s_add_u32 m0, s29, 86016
    s_nop 0
    buffer_load_dwordx4 v18, s[12:15], s33 offen lds
    v_mfma_f32_16x16x32_bf16 v[224:227], v[112:115], v[88:91], v[224:227]
    v_mfma_f32_16x16x32_bf16 v[228:231], v[116:119], v[88:91], v[228:231]
    s_waitcnt vmcnt(11) lgkmcnt(0)
    s_barrier
    v_mfma_f32_16x16x32_bf16 v[120:123], v[48:51], v[32:35], v[120:123]
    ds_read_b128 v[76:79], v20 offset:0
    s_add_u32 s34, s30, s31
    s_and_b32 s34, s34, 3
    s_andn2_b32 s35, s30, 3
    s_or_b32 s34, s34, s35
    s_mul_i32 s32, s34, 131072
    s_mul_i32 s33, s34, 458752
    s_add_u32 s30, s30, 1
    s_add_u32 m0, s29, 90112
    s_nop 0
    buffer_load_dwordx4 v8, s[8:11], s32 offen sc1 lds
    v_mfma_f32_16x16x32_bf16 v[124:127], v[52:55], v[32:35], v[124:127]
    ds_read_b64_tr_b16 v[92:93], v23 offset:0
    v_mfma_f32_16x16x32_bf16 v[128:131], v[56:59], v[32:35], v[128:131]
    ds_read_b64_tr_b16 v[94:95], v23 offset:256
    s_add_u32 m0, s29, 94208
    s_nop 0
    buffer_load_dwordx4 v9, s[8:11], s32 offen sc1 lds
    v_mfma_f32_16x16x32_bf16 v[132:135], v[60:63], v[32:35], v[132:135]
    ds_read_b128 v[80:83], v20 offset:256
    v_mfma_f32_16x16x32_bf16 v[136:139], v[64:67], v[32:35], v[136:139]
    ds_read_b64_tr_b16 v[96:97], v26 offset:0
    v_mfma_f32_16x16x32_bf16 v[140:143], v[68:71], v[32:35], v[140:143]
    ds_read_b64_tr_b16 v[98:99], v26 offset:256
    s_add_u32 m0, s29, 98304
    s_nop 0
    buffer_load_dwordx4 v10, s[8:11], s32 offen sc1 lds
    v_mfma_f32_16x16x32_bf16 v[144:147], v[72:75], v[32:35], v[144:147]
    ds_read_b128 v[84:87], v20 offset:512
    v_mfma_f32_16x16x32_bf16 v[148:151], v[48:51], v[36:39], v[148:151]
    ds_read_b64_tr_b16 v[100:101], v23 offset:4096
    s_add_u32 m0, s29, 102400
    s_nop 0
    buffer_load_dwordx4 v11, s[8:11], s32 offen sc1 lds
    v_mfma_f32_16x16x32_bf16 v[152:155], v[52:55], v[36:39], v[152:155]
    ds_read_b64_tr_b16 v[102:103], v23 offset:4352
    v_mfma_f32_16x16x32_bf16 v[156:159], v[56:59], v[36:39], v[156:159]
    ds_read_b128 v[88:91], v20 offset:768
    v_mfma_f32_16x16x32_bf16 v[160:163], v[60:63], v[36:39], v[160:163]
    ds_read_b64_tr_b16 v[104:105], v26 offset:4096
    s_add_u32 m0, s29, 106496
    s_nop 0
    buffer_load_dwordx4 v12, s[12:15], s33 offen lds
    v_mfma_f32_16x16x32_bf16 v[164:167], v[64:67], v[36:39], v[164:167]
    ds_read_b64_tr_b16 v[106:107], v26 offset:4352
    v_mfma_f32_16x16x32_bf16 v[168:171], v[68:71], v[36:39], v[168:171]
    ds_read_b64_tr_b16 v[108:109], v23 offset:8192
    s_add_u32 m0, s29, 110592
    s_nop 0
    buffer_load_dwordx4 v13, s[12:15], s33 offen lds
    v_mfma_f32_16x16x32_bf16 v[172:175], v[72:75], v[36:39], v[172:175]
    ds_read_b64_tr_b16 v[110:111], v23 offset:8448
    v_mfma_f32_16x16x32_bf16 v[176:179], v[48:51], v[40:43], v[176:179]
    ds_read_b64_tr_b16 v[112:113], v26 offset:8192
    v_mfma_f32_16x16x32_bf16 v[180:183], v[52:55], v[40:43], v[180:183]
    ds_read_b64_tr_b16 v[114:115], v26 offset:8448
    s_add_u32 m0, s29, 114688
    s_nop 0
    buffer_load_dwordx4 v14, s[12:15], s33 offen lds
    v_mfma_f32_16x16x32_bf16 v[184:187], v[56:59], v[40:43], v[184:187]
    ds_read_b64_tr_b16 v[116:117], v29 offset:0
    v_mfma_f32_16x16x32_bf16 v[188:191], v[60:63], v[40:43], v[188:191]
    ds_read_b64_tr_b16 v[118:119], v29 offset:256
    s_add_u32 m0, s29, 118784
    s_nop 0
    buffer_load_dwordx4 v15, s[12:15], s33 offen lds
    v_mfma_f32_16x16x32_bf16 v[192:195], v[64:67], v[40:43], v[192:195]
    v_mfma_f32_16x16x32_bf16 v[196:199], v[68:71], v[40:43], v[196:199]
    v_mfma_f32_16x16x32_bf16 v[200:203], v[72:75], v[40:43], v[200:203]
    s_add_u32 m0, s29, 122880
    s_nop 0
    buffer_load_dwordx4 v16, s[12:15], s33 offen lds
    v_mfma_f32_16x16x32_bf16 v[204:207], v[48:51], v[44:47], v[204:207]
    v_mfma_f32_16x16x32_bf16 v[208:211], v[52:55], v[44:47], v[208:211]
    s_add_u32 m0, s29, 126976
    s_nop 0
    buffer_load_dwordx4 v17, s[12:15], s33 offen lds
    v_mfma_f32_16x16x32_bf16 v[212:215], v[56:59], v[44:47], v[212:215]
    v_mfma_f32_16x16x32_bf16 v[216:219], v[60:63], v[44:47], v[216:219]
    v_mfma_f32_16x16x32_bf16 v[220:223], v[64:67], v[44:47], v[220:223]
    s_add_u32 m0, s29, 131072
    s_nop 0
    buffer_load_dwordx4 v18, s[12:15], s33 offen lds
    v_mfma_f32_16x16x32_bf16 v[224:227], v[68:71], v[44:47], v[224:227]
    v_mfma_f32_16x16x32_bf16 v[228:231], v[72:75], v[44:47], v[228:231]
    s_waitcnt vmcnt(11) lgkmcnt(0)
    s_barrier
    v_mfma_f32_16x16x32_bf16 v[120:123], v[92:95], v[76:79], v[120:123]
    ds_read_b128 v[32:35], v21 offset:0
    s_add_u32 s34, s30, s31
    s_and_b32 s34, s34, 3
    s_andn2_b32 s35, s30, 3
    s_or_b32 s34, s34, s35
    s_mul_i32 s32, s34, 131072
    s_mul_i32 s33, s34, 458752
    s_add_u32 s30, s30, 1
    s_add_u32 m0, s29, 0
    s_nop 0
    buffer_load_dwordx4 v8, s[8:11], s32 offen sc1 lds
    v_mfma_f32_16x16x32_bf16 v[124:127], v[96:99], v[76:79], v[124:127]
    ds_read_b64_tr_b16 v[48:49], v24 offset:0
    v_mfma_f32_16x16x32_bf16 v[128:131], v[100:103], v[76:79], v[128:131]
    ds_read_b64_tr_b16 v[50:51], v24 offset:256
    s_add_u32 m0, s29, 4096
    s_nop 0
    buffer_load_dwordx4 v9, s[8:11], s32 offen sc1 lds
    v_mfma_f32_16x16x32_bf16 v[132:135], v[104:107], v[76:79], v[132:135]
    ds_read_b128 v[36:39], v21 offset:256
    v_mfma_f32_16x16x32_bf16 v[136:139], v[108:111], v[76:79], v[136:139]
    ds_read_b64_tr_b16 v[52:53], v27 offset:0
    v_mfma_f32_16x16x32_bf16 v[140:143], v[112:115], v[76:79], v[140:143]
    ds_read_b64_tr_b16 v[54:55], v27 offset:256
    s_add_u32 m0, s29, 8192
    s_nop 0
    buffer_load_dwordx4 v10, s[8:11], s32 offen sc1 lds
    v_mfma_f32_16x16x32_bf16 v[144:147], v[116:119], v[76:79], v[144:147]
    ds_read_b128 v[40:43], v21 offset:512
    v_mfma_f32_16x16x32_bf16 v[148:151], v[92:95], v[80:83], v[148:151]
    ds_read_b64_tr_b16 v[56:57], v24 offset:4096
    s_add_u32 m0, s29, 12288
    s_nop 0
    buffer_load_dwordx4 v11, s[8:11], s32 offen sc1 lds
    v_mfma_f32_16x16x32_bf16 v[152:155], v[96:99], v[80:83], v[152:155]
    ds_read_b64_tr_b16 v[58:59], v24 offset:4352
    v_mfma_f32_16x16x32_bf16 v[156:159], v[100:103], v[80:83], v[156:159]
    ds_read_b128 v[44:47], v21 offset:768
    v_mfma_f32_16x16x32_bf16 v[160:163], v[104:107], v[80:83], v[160:163]
    ds_read_b64_tr_b16 v[60:61], v27 offset:4096
    s_add_u32 m0, s29, 16384
    s_nop 0
    buffer_load_dwordx4 v12, s[12:15], s33 offen lds
    v_mfma_f32_16x16x32_bf16 v[164:167], v[108:111], v[80:83], v[164:167]
    ds_read_b64_tr_b16 v[62:63], v27 offset:4352
    v_mfma_f32_16x16x32_bf16 v[168:171], v[112:115], v[80:83], v[168:171]
    ds_read_b64_tr_b16 v[64:65], v24 offset:8192
    s_add_u32 m0, s29, 20480
    s_nop 0
    buffer_load_dwordx4 v13, s[12:15], s33 offen lds
    v_mfma_f32_16x16x32_bf16 v[172:175], v[116:119], v[80:83], v[172:175]
    ds_read_b64_tr_b16 v[66:67], v24 offset:8448
    v_mfma_f32_16x16x32_bf16 v[176:179], v[92:95], v[84:87], v[176:179]
    ds_read_b64_tr_b16 v[68:69], v27 offset:8192
    v_mfma_f32_16x16x32_bf16 v[180:183], v[96:99], v[84:87], v[180:183]
    ds_read_b64_tr_b16 v[70:71], v27 offset:8448
    s_add_u32 m0, s29, 24576
    s_nop 0
    buffer_load_dwordx4 v14, s[12:15], s33 offen lds
    v_mfma_f32_16x16x32_bf16 v[184:187], v[100:103], v[84:87], v[184:187]
    ds_read_b64_tr_b16 v[72:73], v30 offset:0
    v_mfma_f32_16x16x32_bf16 v[188:191], v[104:107], v[84:87], v[188:191]
    ds_read_b64_tr_b16 v[74:75], v30 offset:256
    s_add_u32 m0, s29, 28672
    s_nop 0
    buffer_load_dwordx4 v15, s[12:15], s33 offen lds
    v_mfma_f32_16x16x32_bf16 v[192:195], v[108:111], v[84:87], v[192:195]
    v_mfma_f32_16x16x32_bf16 v[196:199], v[112:115], v[84:87], v[196:199]
    v_mfma_f32_16x16x32_bf16 v[200:203], v[116:119], v[84:87], v[200:203]
    s_add_u32 m0, s29, 32768
    s_nop 0
    buffer_load_dwordx4 v16, s[12:15], s33 offen lds
    v_mfma_f32_16x16x32_bf16 v[204:207], v[92:95], v[88:91], v[204:207]
    v_mfma_f32_16x16x32_bf16 v[208:211], v[96:99], v[88:91], v[208:211]
    s_add_u32 m0, s29, 36864
    s_nop 0
    buffer_load_dwordx4 v17, s[12:15], s33 offen lds
    v_mfma_f32_16x16x32_bf16 v[212:215], v[100:103], v[88:91], v[212:215]
    v_mfma_f32_16x16x32_bf16 v[216:219], v[104:107], v[88:91], v[216:219]
    v_mfma_f32_16x16x32_bf16 v[220:223], v[108:111], v[88:91], v[220:223]
    s_add_u32 m0, s29, 40960
    s_nop 0
    buffer_load_dwordx4 v18, s[12:15], s33 offen lds
    v_mfma_f32_16x16x32_bf16 v[224:227], v[112:115], v[88:91], v[224:227]
    v_mfma_f32_16x16x32_bf16 v[228:231], v[116:119], v[88:91], v[228:231]
    s_waitcnt vmcnt(11) lgkmcnt(0)
    s_barrier
    v_mfma_f32_16x16x32_bf16 v[120:123], v[48:51], v[32:35], v[120:123]
    ds_read_b128 v[76:79], v22 offset:0
    s_add_u32 s34, s30, s31
    s_and_b32 s34, s34, 3
    s_andn2_b32 s35, s30, 3
    s_or_b32 s34, s34, s35
    s_mul_i32 s32, s34, 131072
    s_mul_i32 s33, s34, 458752
    s_add_u32 s30, s30, 1
    s_add_u32 m0, s29, 45056
    s_nop 0
    buffer_load_dwordx4 v8, s[8:11], s32 offen sc1 lds
    v_mfma_f32_16x16x32_bf16 v[124:127], v[52:55], v[32:35], v[124:127]
    ds_read_b64_tr_b16 v[92:93], v25 offset:0
    v_mfma_f32_16x16x32_bf16 v[128:131], v[56:59], v[32:35], v[128:131]
    ds_read_b64_tr_b16 v[94:95], v25 offset:256
    s_add_u32 m0, s29, 49152
    s_nop 0
    buffer_load_dwordx4 v9, s[8:11], s32 offen sc1 lds
    v_mfma_f32_16x16x32_bf16 v[132:135], v[60:63], v[32:35], v[132:135]
    ds_read_b128 v[80:83], v22 offset:256
    v_mfma_f32_16x16x32_bf16 v[136:139], v[64:67], v[32:35], v[136:139]
    ds_read_b64_tr_b16 v[96:97], v28 offset:0
    v_mfma_f32_16x16x32_bf16 v[140:143], v[68:71], v[32:35], v[140:143]
    ds_read_b64_tr_b16 v[98:99], v28 offset:256
    s_add_u32 m0, s29, 53248
    s_nop 0
    buffer_load_dwordx4 v10, s[8:11], s32 offen sc1 lds
    v_mfma_f32_16x16x32_bf16 v[144:147], v[72:75], v[32:35], v[144:147]
    ds_read_b128 v[84:87], v22 offset:512
    v_mfma_f32_16x16x32_bf16 v[148:151], v[48:51], v[36:39], v[148:151]
    ds_read_b64_tr_b16 v[100:101], v25 offset:4096
    s_add_u32 m0, s29, 57344
    s_nop 0
    buffer_load_dwordx4 v11, s[8:11], s32 offen sc1 lds
    v_mfma_f32_16x16x32_bf16 v[152:155], v[52:55], v[36:39], v[152:155]
    ds_read_b64_tr_b16 v[102:103], v25 offset:4352
    v_mfma_f32_16x16x32_bf16 v[156:159], v[56:59], v[36:39], v[156:159]
    ds_read_b128 v[88:91], v22 offset:768
    v_mfma_f32_16x16x32_bf16 v[160:163], v[60:63], v[36:39], v[160:163]
    ds_read_b64_tr_b16 v[104:105], v28 offset:4096
    s_add_u32 m0, s29, 61440
    s_nop 0
    buffer_load_dwordx4 v12, s[12:15], s33 offen lds
    v_mfma_f32_16x16x32_bf16 v[164:167], v[64:67], v[36:39], v[164:167]
    ds_read_b64_tr_b16 v[106:107], v28 offset:4352
    v_mfma_f32_16x16x32_bf16 v[168:171], v[68:71], v[36:39], v[168:171]
    ds_read_b64_tr_b16 v[108:109], v25 offset:8192
    s_add_u32 m0, s29, 65536
    s_nop 0
    buffer_load_dwordx4 v13, s[12:15], s33 offen lds
    v_mfma_f32_16x16x32_bf16 v[172:175], v[72:75], v[36:39], v[172:175]
    ds_read_b64_tr_b16 v[110:111], v25 offset:8448
    v_mfma_f32_16x16x32_bf16 v[176:179], v[48:51], v[40:43], v[176:179]
    ds_read_b64_tr_b16 v[112:113], v28 offset:8192
    v_mfma_f32_16x16x32_bf16 v[180:183], v[52:55], v[40:43], v[180:183]
    ds_read_b64_tr_b16 v[114:115], v28 offset:8448
    s_add_u32 m0, s29, 69632
    s_nop 0
    buffer_load_dwordx4 v14, s[12:15], s33 offen lds
    v_mfma_f32_16x16x32_bf16 v[184:187], v[56:59], v[40:43], v[184:187]
    ds_read_b64_tr_b16 v[116:117], v31 offset:0
    v_mfma_f32_16x16x32_bf16 v[188:191], v[60:63], v[40:43], v[188:191]
    ds_read_b64_tr_b16 v[118:119], v31 offset:256
    s_add_u32 m0, s29, 73728
    s_nop 0
    buffer_load_dwordx4 v15, s[12:15], s33 offen lds
    v_mfma_f32_16x16x32_bf16 v[192:195], v[64:67], v[40:43], v[192:195]
    v_mfma_f32_16x16x32_bf16 v[196:199], v[68:71], v[40:43], v[196:199]
    v_mfma_f32_16x16x32_bf16 v[200:203], v[72:75], v[40:43], v[200:203]
    s_add_u32 m0, s29, 77824
    s_nop 0
    buffer_load_dwordx4 v16, s[12:15], s33 offen lds
    v_mfma_f32_16x16x32_bf16 v[204:207], v[48:51], v[44:47], v[204:207]
    v_mfma_f32_16x16x32_bf16 v[208:211], v[52:55], v[44:47], v[208:211]
    s_add_u32 m0, s29, 81920
    s_nop 0
    buffer_load_dwordx4 v17, s[12:15], s33 offen lds
    v_mfma_f32_16x16x32_bf16 v[212:215], v[56:59], v[44:47], v[212:215]
    v_mfma_f32_16x16x32_bf16 v[216:219], v[60:63], v[44:47], v[216:219]
    v_mfma_f32_16x16x32_bf16 v[220:223], v[64:67], v[44:47], v[220:223]
    s_add_u32 m0, s29, 86016
    s_nop 0
    buffer_load_dwordx4 v18, s[12:15], s33 offen lds
    v_mfma_f32_16x16x32_bf16 v[224:227], v[68:71], v[44:47], v[224:227]
    v_mfma_f32_16x16x32_bf16 v[228:231], v[72:75], v[44:47], v[228:231]
    s_waitcnt vmcnt(11) lgkmcnt(0)
    s_barrier
    v_mfma_f32_16x16x32_bf16 v[120:123], v[92:95], v[76:79], v[120:123]
    ds_read_b128 v[32:35], v20 offset:0
    v_mfma_f32_16x16x32_bf16 v[124:127], v[96:99], v[76:79], v[124:127]
    ds_read_b64_tr_b16 v[48:49], v23 offset:0
    v_mfma_f32_16x16x32_bf16 v[128:131], v[100:103], v[76:79], v[128:131]
    ds_read_b64_tr_b16 v[50:51], v23 offset:256
    v_mfma_f32_16x16x32_bf16 v[132:135], v[104:107], v[76:79], v[132:135]
    ds_read_b128 v[36:39], v20 offset:256
    v_mfma_f32_16x16x32_bf16 v[136:139], v[108:111], v[76:79], v[136:139]
    ds_read_b64_tr_b16 v[52:53], v26 offset:0
    v_mfma_f32_16x16x32_bf16 v[140:143], v[112:115], v[76:79], v[140:143]
    ds_read_b64_tr_b16 v[54:55], v26 offset:256
    v_mfma_f32_16x16x32_bf16 v[144:147], v[116:119], v[76:79], v[144:147]
    ds_read_b128 v[40:43], v20 offset:512
    v_mfma_f32_16x16x32_bf16 v[148:151], v[92:95], v[80:83], v[148:151]
    ds_read_b64_tr_b16 v[56:57], v23 offset:4096
    v_mfma_f32_16x16x32_bf16 v[152:155], v[96:99], v[80:83], v[152:155]
    ds_read_b64_tr_b16 v[58:59], v23 offset:4352
    v_mfma_f32_16x16x32_bf16 v[156:159], v[100:103], v[80:83], v[156:159]
    ds_read_b128 v[44:47], v20 offset:768
    v_mfma_f32_16x16x32_bf16 v[160:163], v[104:107], v[80:83], v[160:163]
    ds_read_b64_tr_b16 v[60:61], v26 offset:4096
    v_mfma_f32_16x16x32_bf16 v[164:167], v[108:111], v[80:83], v[164:167]
    ds_read_b64_tr_b16 v[62:63], v26 offset:4352
    v_mfma_f32_16x16x32_bf16 v[168:171], v[112:115], v[80:83], v[168:171]
    ds_read_b64_tr_b16 v[64:65], v23 offset:8192
    v_mfma_f32_16x16x32_bf16 v[172:175], v[116:119], v[80:83], v[172:175]
    ds_read_b64_tr_b16 v[66:67], v23 offset:8448
    v_mfma_f32_16x16x32_bf16 v[176:179], v[92:95], v[84:87], v[176:179]
    ds_read_b64_tr_b16 v[68:69], v26 offset:8192
    v_mfma_f32_16x16x32_bf16 v[180:183], v[96:99], v[84:87], v[180:183]
    ds_read_b64_tr_b16 v[70:71], v26 offset:8448
    v_mfma_f32_16x16x32_bf16 v[184:187], v[100:103], v[84:87], v[184:187]
    ds_read_b64_tr_b16 v[72:73], v29 offset:0
    v_mfma_f32_16x16x32_bf16 v[188:191], v[104:107], v[84:87], v[188:191]
    ds_read_b64_tr_b16 v[74:75], v29 offset:256
    v_mfma_f32_16x16x32_bf16 v[192:195], v[108:111], v[84:87], v[192:195]
    v_mfma_f32_16x16x32_bf16 v[196:199], v[112:115], v[84:87], v[196:199]
    v_mfma_f32_16x16x32_bf16 v[200:203], v[116:119], v[84:87], v[200:203]
    v_mfma_f32_16x16x32_bf16 v[204:207], v[92:95], v[88:91], v[204:207]
    v_mfma_f32_16x16x32_bf16 v[208:211], v[96:99], v[88:91], v[208:211]
    v_mfma_f32_16x16x32_bf16 v[212:215], v[100:103], v[88:91], v[212:215]
    v_mfma_f32_16x16x32_bf16 v[216:219], v[104:107], v[88:91], v[216:219]
    v_mfma_f32_16x16x32_bf16 v[220:223], v[108:111], v[88:91], v[220:223]
    v_mfma_f32_16x16x32_bf16 v[224:227], v[112:115], v[88:91], v[224:227]
    v_mfma_f32_16x16x32_bf16 v[228:231], v[116:119], v[88:91], v[228:231]
    s_waitcnt vmcnt(0) lgkmcnt(0)
    s_barrier
    v_mfma_f32_16x16x32_bf16 v[120:123], v[48:51], v[32:35], v[120:123]
    ds_read_b128 v[76:79], v21 offset:0
    v_mfma_f32_16x16x32_bf16 v[124:127], v[52:55], v[32:35], v[124:127]
    ds_read_b64_tr_b16 v[92:93], v24 offset:0
    v_mfma_f32_16x16x32_bf16 v[128:131], v[56:59], v[32:35], v[128:131]
    ds_read_b64_tr_b16 v[94:95], v24 offset:256
    v_mfma_f32_16x16x32_bf16 v[132:135], v[60:63], v[32:35], v[132:135]
    ds_read_b128 v[80:83], v21 offset:256
    v_mfma_f32_16x16x32_bf16 v[136:139], v[64:67], v[32:35], v[136:139]
    ds_read_b64_tr_b16 v[96:97], v27 offset:0
    v_mfma_f32_16x16x32_bf16 v[140:143], v[68:71], v[32:35], v[140:143]
    ds_read_b64_tr_b16 v[98:99], v27 offset:256
    v_mfma_f32_16x16x32_bf16 v[144:147], v[72:75], v[32:35], v[144:147]
    ds_read_b128 v[84:87], v21 offset:512
    v_mfma_f32_16x16x32_bf16 v[148:151], v[48:51], v[36:39], v[148:151]
    ds_read_b64_tr_b16 v[100:101], v24 offset:4096
    v_mfma_f32_16x16x32_bf16 v[152:155], v[52:55], v[36:39], v[152:155]
    ds_read_b64_tr_b16 v[102:103], v24 offset:4352
    v_mfma_f32_16x16x32_bf16 v[156:159], v[56:59], v[36:39], v[156:159]
    ds_read_b128 v[88:91], v21 offset:768
    v_mfma_f32_16x16x32_bf16 v[160:163], v[60:63], v[36:39], v[160:163]
    ds_read_b64_tr_b16 v[104:105], v27 offset:4096
    v_mfma_f32_16x16x32_bf16 v[164:167], v[64:67], v[36:39], v[164:167]
    ds_read_b64_tr_b16 v[106:107], v27 offset:4352
    v_mfma_f32_16x16x32_bf16 v[168:171], v[68:71], v[36:39], v[168:171]
    ds_read_b64_tr_b16 v[108:109], v24 offset:8192
    v_mfma_f32_16x16x32_bf16 v[172:175], v[72:75], v[36:39], v[172:175]
    ds_read_b64_tr_b16 v[110:111], v24 offset:8448
    v_mfma_f32_16x16x32_bf16 v[176:179], v[48:51], v[40:43], v[176:179]
    ds_read_b64_tr_b16 v[112:113], v27 offset:8192
    v_mfma_f32_16x16x32_bf16 v[180:183], v[52:55], v[40:43], v[180:183]
    ds_read_b64_tr_b16 v[114:115], v27 offset:8448
    v_mfma_f32_16x16x32_bf16 v[184:187], v[56:59], v[40:43], v[184:187]
    ds_read_b64_tr_b16 v[116:117], v30 offset:0
    v_mfma_f32_16x16x32_bf16 v[188:191], v[60:63], v[40:43], v[188:191]
    ds_read_b64_tr_b16 v[118:119], v30 offset:256
    v_mfma_f32_16x16x32_bf16 v[192:195], v[64:67], v[40:43], v[192:195]
    v_mfma_f32_16x16x32_bf16 v[196:199], v[68:71], v[40:43], v[196:199]
    v_mfma_f32_16x16x32_bf16 v[200:203], v[72:75], v[40:43], v[200:203]
    v_mfma_f32_16x16x32_bf16 v[204:207], v[48:51], v[44:47], v[204:207]
    v_mfma_f32_16x16x32_bf16 v[208:211], v[52:55], v[44:47], v[208:211]
    v_mfma_f32_16x16x32_bf16 v[212:215], v[56:59], v[44:47], v[212:215]
    v_mfma_f32_16x16x32_bf16 v[216:219], v[60:63], v[44:47], v[216:219]
    v_mfma_f32_16x16x32_bf16 v[220:223], v[64:67], v[44:47], v[220:223]
    v_mfma_f32_16x16x32_bf16 v[224:227], v[68:71], v[44:47], v[224:227]
    v_mfma_f32_16x16x32_bf16 v[228:231], v[72:75], v[44:47], v[228:231]
    s_waitcnt lgkmcnt(0)
    v_mfma_f32_16x16x32_bf16 v[120:123], v[92:95], v[76:79], v[120:123]
    v_mfma_f32_16x16x32_bf16 v[124:127], v[96:99], v[76:79], v[124:127]
    v_mfma_f32_16x16x32_bf16 v[128:131], v[100:103], v[76:79], v[128:131]
    v_mfma_f32_16x16x32_bf16 v[132:135], v[104:107], v[76:79], v[132:135]
    v_mfma_f32_16x16x32_bf16 v[136:139], v[108:111], v[76:79], v[136:139]
    v_mfma_f32_16x16x32_bf16 v[140:143], v[112:115], v[76:79], v[140:143]
    v_mfma_f32_16x16x32_bf16 v[144:147], v[116:119], v[76:79], v[144:147]
    v_mfma_f32_16x16x32_bf16 v[148:151], v[92:95], v[80:83], v[148:151]
    v_mfma_f32_16x16x32_bf16 v[152:155], v[96:99], v[80:83], v[152:155]
    v_mfma_f32_16x16x32_bf16 v[156:159], v[100:103], v[80:83], v[156:159]
    v_mfma_f32_16x16x32_bf16 v[160:163], v[104:107], v[80:83], v[160:163]
    v_mfma_f32_16x16x32_bf16 v[164:167], v[108:111], v[80:83], v[164:167]
    v_mfma_f32_16x16x32_bf16 v[168:171], v[112:115], v[80:83], v[168:171]
    v_mfma_f32_16x16x32_bf16 v[172:175], v[116:119], v[80:83], v[172:175]
    v_mfma_f32_16x16x32_bf16 v[176:179], v[92:95], v[84:87], v[176:179]
    v_mfma_f32_16x16x32_bf16 v[180:183], v[96:99], v[84:87], v[180:183]
    v_mfma_f32_16x16x32_bf16 v[184:187], v[100:103], v[84:87], v[184:187]
    v_mfma_f32_16x16x32_bf16 v[188:191], v[104:107], v[84:87], v[188:191]
    v_mfma_f32_16x16x32_bf16 v[192:195], v[108:111], v[84:87], v[192:195]
    v_mfma_f32_16x16x32_bf16 v[196:199], v[112:115], v[84:87], v[196:199]
    v_mfma_f32_16x16x32_bf16 v[200:203], v[116:119], v[84:87], v[200:203]
    v_mfma_f32_16x16x32_bf16 v[204:207], v[92:95], v[88:91], v[204:207]
    v_mfma_f32_16x16x32_bf16 v[208:211], v[96:99], v[88:91], v[208:211]
    v_mfma_f32_16x16x32_bf16 v[212:215], v[100:103], v[88:91], v[212:215]
    v_mfma_f32_16x16x32_bf16 v[216:219], v[104:107], v[88:91], v[216:219]
    v_mfma_f32_16x16x32_bf16 v[220:223], v[108:111], v[88:91], v[220:223]
    v_mfma_f32_16x16x32_bf16 v[224:227], v[112:115], v[88:91], v[224:227]
    v_mfma_f32_16x16x32_bf16 v[228:231], v[116:119], v[88:91], v[228:231]
    s_mul_i32 s34, s29, 22
    s_cmp_ge_u32 s29, 2048
    s_cselect_b32 s35, 45056, 0
    s_add_u32 s34, s34, s35
    s_mul_i32 s35, s29, 6
    s_add_u32 s35, s35, 135168
    v_lshlrev_b32 v2, 4, v1
    v_add_u32 v7, s35, v2
    v_add_u32 v2, s34, v2
    v_and_b32 v3, 15, v1
    v_lshlrev_b32 v3, 4, v3
    v_lshl_add_u32 v3, v4, 14, v3
    s_lshl_b32 s34, s37, 11
    s_bfe_u32 s35, s28, 0x10001
    s_lshl_b32 s35, s35, 10
    s_add_u32 s34, s34, s35
    s_add_u32 s34, s34, 8388608
    v_add_u32 v3, s34, v3
    s_mul_i32 s30, s38, 7
    s_and_b32 s35, s28, 1
    s_add_u32 s33, s30, 3
    s_lshl_b32 s33, s33, 16
    s_lshl_b32 s34, s35, 3
    s_add_u32 s33, s33, s34
    s_lshl_b32 s35, s35, 2
    s_add_u32 s30, s30, s35
    s_lshl_b32 s30, s30, 16
    s_nop 4
    ds_write_b128 v2, v[176:179] offset:0
    ds_write_b128 v2, v[180:183] offset:1024
    ds_write_b128 v2, v[184:187] offset:2048
    ds_write_b128 v2, v[188:191] offset:3072
    ds_write_b128 v2, v[192:195] offset:4096
    ds_write_b128 v2, v[196:199] offset:5120
    ds_write_b128 v2, v[200:203] offset:6144
    ds_write_b128 v2, v[204:207] offset:7168
    ds_write_b128 v2, v[208:211] offset:8192
    ds_write_b128 v2, v[212:215] offset:9216
    ds_write_b128 v2, v[216:219] offset:10240
    ds_write_b128 v7, v[220:223] offset:0
    ds_write_b128 v7, v[224:227] offset:1024
    ds_write_b128 v7, v[228:231] offset:2048
    s_waitcnt lgkmcnt(0)
    s_barrier
    ds_read_b128 v[32:35], v2 offset:11264
    ds_read_b128 v[36:39], v2 offset:12288
    ds_read_b128 v[40:43], v2 offset:13312
    ds_read_b128 v[44:47], v2 offset:14336
    ds_read_b128 v[48:51], v2 offset:15360
    ds_read_b128 v[52:55], v2 offset:16384
    ds_read_b128 v[56:59], v2 offset:17408
    ds_read_b128 v[60:63], v2 offset:18432
    ds_read_b128 v[64:67], v2 offset:19456
    ds_read_b128 v[68:71], v2 offset:20480
    ds_read_b128 v[72:75], v2 offset:21504
    ds_read_b128 v[76:79], v7 offset:3072
    ds_read_b128 v[80:83], v7 offset:4096
    ds_read_b128 v[84:87], v7 offset:5120
    s_mov_b32 s32, 0xbdd2d3e8
    v_mov_b32 v6, 0xc0135761
    s_waitcnt lgkmcnt(13)
    v_pk_add_f32 v[120:121], v[120:121], v[32:33]
    v_pk_add_f32 v[122:123], v[122:123], v[34:35]
    v_pk_mul_f32 v[32:33], v[120:121], v[120:121]
    v_pk_mul_f32 v[34:35], v[122:123], v[122:123]
    v_pk_fma_f32 v[32:33], v[32:33], s[32:33], v[6:7] op_sel:[0,0,0] op_sel_hi:[1,0,0] neg_lo:[0,0,0] neg_hi:[0,0,0]
    v_pk_fma_f32 v[34:35], v[34:35], s[32:33], v[6:7] op_sel:[0,0,0] op_sel_hi:[1,0,0] neg_lo:[0,0,0] neg_hi:[0,0,0]
    v_pk_mul_f32 v[32:33], v[32:33], v[120:121]
    v_pk_mul_f32 v[34:35], v[34:35], v[122:123]
    v_exp_f32 v32, v32
    v_exp_f32 v33, v33
    v_exp_f32 v34, v34
    v_exp_f32 v35, v35
    s_nop 0
    v_pk_add_f32 v[32:33], v[32:33], 1.0 op_sel_hi:[1,0]
    v_pk_add_f32 v[34:35], v[34:35], 1.0 op_sel_hi:[1,0]
    v_rcp_f32 v32, v32
    v_rcp_f32 v33, v33
    v_rcp_f32 v34, v34
    v_rcp_f32 v35, v35
    s_nop 0
    v_pk_mul_f32 v[120:121], v[120:121], v[32:33]
    v_pk_mul_f32 v[122:123], v[122:123], v[34:35]
    v_cvt_pk_bf16_f32 v96, v120, v121
    v_cvt_pk_bf16_f32 v97, v122, v123
    s_waitcnt lgkmcnt(12)
    v_pk_add_f32 v[124:125], v[124:125], v[36:37]
    v_pk_add_f32 v[126:127], v[126:127], v[38:39]
    v_pk_mul_f32 v[36:37], v[124:125], v[124:125]
    v_pk_mul_f32 v[38:39], v[126:127], v[126:127]
    v_pk_fma_f32 v[36:37], v[36:37], s[32:33], v[6:7] op_sel:[0,0,0] op_sel_hi:[1,0,0] neg_lo:[0,0,0] neg_hi:[0,0,0]
    v_pk_fma_f32 v[38:39], v[38:39], s[32:33], v[6:7] op_sel:[0,0,0] op_sel_hi:[1,0,0] neg_lo:[0,0,0] neg_hi:[0,0,0]
    v_pk_mul_f32 v[36:37], v[36:37], v[124:125]
    v_pk_mul_f32 v[38:39], v[38:39], v[126:127]
    v_exp_f32 v36, v36
    v_exp_f32 v37, v37
    v_exp_f32 v38, v38
    v_exp_f32 v39, v39
    s_add_u32 s34, s30, 0
    v_pk_add_f32 v[36:37], v[36:37], 1.0 op_sel_hi:[1,0]
    v_pk_add_f32 v[38:39], v[38:39], 1.0 op_sel_hi:[1,0]
    v_rcp_f32 v36, v36
    v_rcp_f32 v37, v37
    v_rcp_f32 v38, v38
    v_rcp_f32 v39, v39
    s_nop 0
    v_pk_mul_f32 v[124:125], v[124:125], v[36:37]
    v_pk_mul_f32 v[126:127], v[126:127], v[38:39]
    v_cvt_pk_bf16_f32 v98, v124, v125
    v_cvt_pk_bf16_f32 v99, v126, v127
    buffer_store_dwordx4 v[96:99], v3, s[16:19], s34 offen offset:0 sc1
    s_waitcnt lgkmcnt(11)
    v_pk_add_f32 v[128:129], v[128:129], v[40:41]
    v_pk_add_f32 v[130:131], v[130:131], v[42:43]
    v_pk_mul_f32 v[40:41], v[128:129], v[128:129]
    v_pk_mul_f32 v[42:43], v[130:131], v[130:131]
    v_pk_fma_f32 v[40:41], v[40:41], s[32:33], v[6:7] op_sel:[0,0,0] op_sel_hi:[1,0,0] neg_lo:[0,0,0] neg_hi:[0,0,0]
    v_pk_fma_f32 v[42:43], v[42:43], s[32:33], v[6:7] op_sel:[0,0,0] op_sel_hi:[1,0,0] neg_lo:[0,0,0] neg_hi:[0,0,0]
    v_pk_mul_f32 v[40:41], v[40:41], v[128:129]
    v_pk_mul_f32 v[42:43], v[42:43], v[130:131]
    v_exp_f32 v40, v40
    v_exp_f32 v41, v41
    v_exp_f32 v42, v42
    v_exp_f32 v43, v43
    s_nop 0
    v_pk_add_f32 v[40:41], v[40:41], 1.0 op_sel_hi:[1,0]
    v_pk_add_f32 v[42:43], v[42:43], 1.0 op_sel_hi:[1,0]
    v_rcp_f32 v40, v40
    v_rcp_f32 v41, v41
    v_rcp_f32 v42, v42
    v_rcp_f32 v43, v43
    s_nop 0
    v_pk_mul_f32 v[128:129], v[128:129], v[40:41]
    v_pk_mul_f32 v[130:131], v[130:131], v[42:43]
    v_cvt_pk_bf16_f32 v100, v128, v129
    v_cvt_pk_bf16_f32 v101, v130, v131
    s_waitcnt lgkmcnt(10)
    v_pk_add_f32 v[132:133], v[132:133], v[44:45]
    v_pk_add_f32 v[134:135], v[134:135], v[46:47]
    v_pk_mul_f32 v[44:45], v[132:133], v[132:133]
    v_pk_mul_f32 v[46:47], v[134:135], v[134:135]
    v_pk_fma_f32 v[44:45], v[44:45], s[32:33], v[6:7] op_sel:[0,0,0] op_sel_hi:[1,0,0] neg_lo:[0,0,0] neg_hi:[0,0,0]
    v_pk_fma_f32 v[46:47], v[46:47], s[32:33], v[6:7] op_sel:[0,0,0] op_sel_hi:[1,0,0] neg_lo:[0,0,0] neg_hi:[0,0,0]
    v_pk_mul_f32 v[44:45], v[44:45], v[132:133]
    v_pk_mul_f32 v[46:47], v[46:47], v[134:135]
    v_exp_f32 v44, v44
    v_exp_f32 v45, v45
    v_exp_f32 v46, v46
    v_exp_f32 v47, v47
    s_add_u32 s34, s30, 65536
    v_pk_add_f32 v[44:45], v[44:45], 1.0 op_sel_hi:[1,0]
    v_pk_add_f32 v[46:47], v[46:47], 1.0 op_sel_hi:[1,0]
    v_rcp_f32 v44, v44
    v_rcp_f32 v45, v45
    v_rcp_f32 v46, v46
    v_rcp_f32 v47, v47
    s_nop 0
    v_pk_mul_f32 v[132:133], v[132:133], v[44:45]
    v_pk_mul_f32 v[134:135], v[134:135], v[46:47]
    v_cvt_pk_bf16_f32 v102, v132, v133
    v_cvt_pk_bf16_f32 v103, v134, v135
    buffer_store_dwordx4 v[100:103], v3, s[16:19], s34 offen offset:0 sc1
    s_waitcnt lgkmcnt(9)
    v_pk_add_f32 v[136:137], v[136:137], v[48:49]
    v_pk_add_f32 v[138:139], v[138:139], v[50:51]
    v_pk_mul_f32 v[48:49], v[136:137], v[136:137]
    v_pk_mul_f32 v[50:51], v[138:139], v[138:139]
    v_pk_fma_f32 v[48:49], v[48:49], s[32:33], v[6:7] op_sel:[0,0,0] op_sel_hi:[1,0,0] neg_lo:[0,0,0] neg_hi:[0,0,0]
    v_pk_fma_f32 v[50:51], v[50:51], s[32:33], v[6:7] op_sel:[0,0,0] op_sel_hi:[1,0,0] neg_lo:[0,0,0] neg_hi:[0,0,0]
    v_pk_mul_f32 v[48:49], v[48:49], v[136:137]
    v_pk_mul_f32 v[50:51], v[50:51], v[138:139]
    v_exp_f32 v48, v48
    v_exp_f32 v49, v49
    v_exp_f32 v50, v50
    v_exp_f32 v51, v51
    s_nop 0
    v_pk_add_f32 v[48:49], v[48:49], 1.0 op_sel_hi:[1,0]
    v_pk_add_f32 v[50:51], v[50:51], 1.0 op_sel_hi:[1,0]
    v_rcp_f32 v48, v48
    v_rcp_f32 v49, v49
    v_rcp_f32 v50, v50
    v_rcp_f32 v51, v51
    s_nop 0
    v_pk_mul_f32 v[136:137], v[136:137], v[48:49]
    v_pk_mul_f32 v[138:139], v[138:139], v[50:51]
    v_cvt_pk_bf16_f32 v104, v136, v137
    v_cvt_pk_bf16_f32 v105, v138, v139
    s_waitcnt lgkmcnt(8)
    v_pk_add_f32 v[140:141], v[140:141], v[52:53]
    v_pk_add_f32 v[142:143], v[142:143], v[54:55]
    v_pk_mul_f32 v[52:53], v[140:141], v[140:141]
    v_pk_mul_f32 v[54:55], v[142:143], v[142:143]
    v_pk_fma_f32 v[52:53], v[52:53], s[32:33], v[6:7] op_sel:[0,0,0] op_sel_hi:[1,0,0] neg_lo:[0,0,0] neg_hi:[0,0,0]
    v_pk_fma_f32 v[54:55], v[54:55], s[32:33], v[6:7] op_sel:[0,0,0] op_sel_hi:[1,0,0] neg_lo:[0,0,0] neg_hi:[0,0,0]
    v_pk_mul_f32 v[52:53], v[52:53], v[140:141]
    v_pk_mul_f32 v[54:55], v[54:55], v[142:143]
    v_exp_f32 v52, v52
    v_exp_f32 v53, v53
    v_exp_f32 v54, v54
    v_exp_f32 v55, v55
    s_add_u32 s34, s30, 131072
    v_pk_add_f32 v[52:53], v[52:53], 1.0 op_sel_hi:[1,0]
    v_pk_add_f32 v[54:55], v[54:55], 1.0 op_sel_hi:[1,0]
    v_rcp_f32 v52, v52
    v_rcp_f32 v53, v53
    v_rcp_f32 v54, v54
    v_rcp_f32 v55, v55
    s_nop 0
    v_pk_mul_f32 v[140:141], v[140:141], v[52:53]
    v_pk_mul_f32 v[142:143], v[142:143], v[54:55]
    v_cvt_pk_bf16_f32 v106, v140, v141
    v_cvt_pk_bf16_f32 v107, v142, v143
    buffer_store_dwordx4 v[104:107], v3, s[16:19], s34 offen offset:0 sc1
    s_waitcnt lgkmcnt(7)
    v_pk_add_f32 v[144:145], v[144:145], v[56:57]
    v_pk_add_f32 v[146:147], v[146:147], v[58:59]
    v_pk_mul_f32 v[56:57], v[144:145], v[144:145]
    v_pk_mul_f32 v[58:59], v[146:147], v[146:147]
    v_pk_fma_f32 v[56:57], v[56:57], s[32:33], v[6:7] op_sel:[0,0,0] op_sel_hi:[1,0,0] neg_lo:[0,0,0] neg_hi:[0,0,0]
    v_pk_fma_f32 v[58:59], v[58:59], s[32:33], v[6:7] op_sel:[0,0,0] op_sel_hi:[1,0,0] neg_lo:[0,0,0] neg_hi:[0,0,0]
    v_pk_mul_f32 v[56:57], v[56:57], v[144:145]
    v_pk_mul_f32 v[58:59], v[58:59], v[146:147]
    v_exp_f32 v56, v56
    v_exp_f32 v57, v57
    v_exp_f32 v58, v58
    v_exp_f32 v59, v59
    s_nop 0
    v_pk_add_f32 v[56:57], v[56:57], 1.0 op_sel_hi:[1,0]
    v_pk_add_f32 v[58:59], v[58:59], 1.0 op_sel_hi:[1,0]
    v_rcp_f32 v56, v56
    v_rcp_f32 v57, v57
    v_rcp_f32 v58, v58
    v_rcp_f32 v59, v59
    s_nop 0
    v_pk_mul_f32 v[144:145], v[144:145], v[56:57]
    v_pk_mul_f32 v[146:147], v[146:147], v[58:59]
    v_cvt_pk_bf16_f32 v108, v144, v145
    v_cvt_pk_bf16_f32 v109, v146, v147
    buffer_store_dwordx2 v[108:109], v3, s[16:19], s33 offen offset:0 sc1
    s_waitcnt lgkmcnt(6)
    v_pk_add_f32 v[148:149], v[148:149], v[60:61]
    v_pk_add_f32 v[150:151], v[150:151], v[62:63]
    v_pk_mul_f32 v[60:61], v[148:149], v[148:149]
    v_pk_mul_f32 v[62:63], v[150:151], v[150:151]
    v_pk_fma_f32 v[60:61], v[60:61], s[32:33], v[6:7] op_sel:[0,0,0] op_sel_hi:[1,0,0] neg_lo:[0,0,0] neg_hi:[0,0,0]
    v_pk_fma_f32 v[62:63], v[62:63], s[32:33], v[6:7] op_sel:[0,0,0] op_sel_hi:[1,0,0] neg_lo:[0,0,0] neg_hi:[0,0,0]
    v_pk_mul_f32 v[60:61], v[60:61], v[148:149]
    v_pk_mul_f32 v[62:63], v[62:63], v[150:151]
    v_exp_f32 v60, v60
    v_exp_f32 v61, v61
    v_exp_f32 v62, v62
    v_exp_f32 v63, v63
    s_nop 0
    v_pk_add_f32 v[60:61], v[60:61], 1.0 op_sel_hi:[1,0]
    v_pk_add_f32 v[62:63], v[62:63], 1.0 op_sel_hi:[1,0]
    v_rcp_f32 v60, v60
    v_rcp_f32 v61, v61
    v_rcp_f32 v62, v62
    v_rcp_f32 v63, v63
    s_nop 0
    v_pk_mul_f32 v[148:149], v[148:149], v[60:61]
    v_pk_mul_f32 v[150:151], v[150:151], v[62:63]
    v_cvt_pk_bf16_f32 v96, v148, v149
    v_cvt_pk_bf16_f32 v97, v150, v151
    s_waitcnt lgkmcnt(5)
    v_pk_add_f32 v[152:153], v[152:153], v[64:65]
    v_pk_add_f32 v[154:155], v[154:155], v[66:67]
    v_pk_mul_f32 v[64:65], v[152:153], v[152:153]
    v_pk_mul_f32 v[66:67], v[154:155], v[154:155]
    v_pk_fma_f32 v[64:65], v[64:65], s[32:33], v[6:7] op_sel:[0,0,0] op_sel_hi:[1,0,0] neg_lo:[0,0,0] neg_hi:[0,0,0]
    v_pk_fma_f32 v[66:67], v[66:67], s[32:33], v[6:7] op_sel:[0,0,0] op_sel_hi:[1,0,0] neg_lo:[0,0,0] neg_hi:[0,0,0]
    v_pk_mul_f32 v[64:65], v[64:65], v[152:153]
    v_pk_mul_f32 v[66:67], v[66:67], v[154:155]
    v_exp_f32 v64, v64
    v_exp_f32 v65, v65
    v_exp_f32 v66, v66
    v_exp_f32 v67, v67
    s_add_u32 s34, s30, 0
    v_pk_add_f32 v[64:65], v[64:65], 1.0 op_sel_hi:[1,0]
    v_pk_add_f32 v[66:67], v[66:67], 1.0 op_sel_hi:[1,0]
    v_rcp_f32 v64, v64
    v_rcp_f32 v65, v65
    v_rcp_f32 v66, v66
    v_rcp_f32 v67, v67
    s_nop 0
    v_pk_mul_f32 v[152:153], v[152:153], v[64:65]
    v_pk_mul_f32 v[154:155], v[154:155], v[66:67]
    v_cvt_pk_bf16_f32 v98, v152, v153
    v_cvt_pk_bf16_f32 v99, v154, v155
    buffer_store_dwordx4 v[96:99], v3, s[16:19], s34 offen offset:256 sc1
    s_waitcnt lgkmcnt(4)
    v_pk_add_f32 v[156:157], v[156:157], v[68:69]
    v_pk_add_f32 v[158:159], v[158:159], v[70:71]
    v_pk_mul_f32 v[68:69], v[156:157], v[156:157]
    v_pk_mul_f32 v[70:71], v[158:159], v[158:159]
    v_pk_fma_f32 v[68:69], v[68:69], s[32:33], v[6:7] op_sel:[0,0,0] op_sel_hi:[1,0,0] neg_lo:[0,0,0] neg_hi:[0,0,0]
    v_pk_fma_f32 v[70:71], v[70:71], s[32:33], v[6:7] op_sel:[0,0,0] op_sel_hi:[1,0,0] neg_lo:[0,0,0] neg_hi:[0,0,0]
    v_pk_mul_f32 v[68:69], v[68:69], v[156:157]
    v_pk_mul_f32 v[70:71], v[70:71], v[158:159]
    v_exp_f32 v68, v68
    v_exp_f32 v69, v69
    v_exp_f32 v70, v70
    v_exp_f32 v71, v71
    s_nop 0
    v_pk_add_f32 v[68:69], v[68:69], 1.0 op_sel_hi:[1,0]
    v_pk_add_f32 v[70:71], v[70:71], 1.0 op_sel_hi:[1,0]
    v_rcp_f32 v68, v68
    v_rcp_f32 v69, v69
    v_rcp_f32 v70, v70
    v_rcp_f32 v71, v71
    s_nop 0
    v_pk_mul_f32 v[156:157], v[156:157], v[68:69]
    v_pk_mul_f32 v[158:159], v[158:159], v[70:71]
    v_cvt_pk_bf16_f32 v100, v156, v157
    v_cvt_pk_bf16_f32 v101, v158, v159
    s_waitcnt lgkmcnt(3)
    v_pk_add_f32 v[160:161], v[160:161], v[72:73]
    v_pk_add_f32 v[162:163], v[162:163], v[74:75]
    v_pk_mul_f32 v[72:73], v[160:161], v[160:161]
    v_pk_mul_f32 v[74:75], v[162:163], v[162:163]
    v_pk_fma_f32 v[72:73], v[72:73], s[32:33], v[6:7] op_sel:[0,0,0] op_sel_hi:[1,0,0] neg_lo:[0,0,0] neg_hi:[0,0,0]
    v_pk_fma_f32 v[74:75], v[74:75], s[32:33], v[6:7] op_sel:[0,0,0] op_sel_hi:[1,0,0] neg_lo:[0,0,0] neg_hi:[0,0,0]
    v_pk_mul_f32 v[72:73], v[72:73], v[160:161]
    v_pk_mul_f32 v[74:75], v[74:75], v[162:163]
    v_exp_f32 v72, v72
    v_exp_f32 v73, v73
    v_exp_f32 v74, v74
    v_exp_f32 v75, v75
    s_add_u32 s34, s30, 65536
    v_pk_add_f32 v[72:73], v[72:73], 1.0 op_sel_hi:[1,0]
    v_pk_add_f32 v[74:75], v[74:75], 1.0 op_sel_hi:[1,0]
    v_rcp_f32 v72, v72
    v_rcp_f32 v73, v73
    v_rcp_f32 v74, v74
    v_rcp_f32 v75, v75
    s_nop 0
    v_pk_mul_f32 v[160:161], v[160:161], v[72:73]
    v_pk_mul_f32 v[162:163], v[162:163], v[74:75]
    v_cvt_pk_bf16_f32 v102, v160, v161
    v_cvt_pk_bf16_f32 v103, v162, v163
    buffer_store_dwordx4 v[100:103], v3, s[16:19], s34 offen offset:256 sc1
    s_waitcnt lgkmcnt(2)
    v_pk_add_f32 v[164:165], v[164:165], v[76:77]
    v_pk_add_f32 v[166:167], v[166:167], v[78:79]
    v_pk_mul_f32 v[76:77], v[164:165], v[164:165]
    v_pk_mul_f32 v[78:79], v[166:167], v[166:167]
    v_pk_fma_f32 v[76:77], v[76:77], s[32:33], v[6:7] op_sel:[0,0,0] op_sel_hi:[1,0,0] neg_lo:[0,0,0] neg_hi:[0,0,0]
    v_pk_fma_f32 v[78:79], v[78:79], s[32:33], v[6:7] op_sel:[0,0,0] op_sel_hi:[1,0,0] neg_lo:[0,0,0] neg_hi:[0,0,0]
    v_pk_mul_f32 v[76:77], v[76:77], v[164:165]
    v_pk_mul_f32 v[78:79], v[78:79], v[166:167]
    v_exp_f32 v76, v76
    v_exp_f32 v77, v77
    v_exp_f32 v78, v78
    v_exp_f32 v79, v79
    s_nop 0
    v_pk_add_f32 v[76:77], v[76:77], 1.0 op_sel_hi:[1,0]
    v_pk_add_f32 v[78:79], v[78:79], 1.0 op_sel_hi:[1,0]
    v_rcp_f32 v76, v76
    v_rcp_f32 v77, v77
    v_rcp_f32 v78, v78
    v_rcp_f32 v79, v79
    s_nop 0
    v_pk_mul_f32 v[164:165], v[164:165], v[76:77]
    v_pk_mul_f32 v[166:167], v[166:167], v[78:79]
    v_cvt_pk_bf16_f32 v104, v164, v165
    v_cvt_pk_bf16_f32 v105, v166, v167
    s_waitcnt lgkmcnt(1)
    v_pk_add_f32 v[168:169], v[168:169], v[80:81]
    v_pk_add_f32 v[170:171], v[170:171], v[82:83]
    v_pk_mul_f32 v[80:81], v[168:169], v[168:169]
    v_pk_mul_f32 v[82:83], v[170:171], v[170:171]
    v_pk_fma_f32 v[80:81], v[80:81], s[32:33], v[6:7] op_sel:[0,0,0] op_sel_hi:[1,0,0] neg_lo:[0,0,0] neg_hi:[0,0,0]
    v_pk_fma_f32 v[82:83], v[82:83], s[32:33], v[6:7] op_sel:[0,0,0] op_sel_hi:[1,0,0] neg_lo:[0,0,0] neg_hi:[0,0,0]
    v_pk_mul_f32 v[80:81], v[80:81], v[168:169]
    v_pk_mul_f32 v[82:83], v[82:83], v[170:171]
    v_exp_f32 v80, v80
    v_exp_f32 v81, v81
    v_exp_f32 v82, v82
    v_exp_f32 v83, v83
    s_add_u32 s34, s30, 131072
    v_pk_add_f32 v[80:81], v[80:81], 1.0 op_sel_hi:[1,0]
    v_pk_add_f32 v[82:83], v[82:83], 1.0 op_sel_hi:[1,0]
    v_rcp_f32 v80, v80
    v_rcp_f32 v81, v81
    v_rcp_f32 v82, v82
    v_rcp_f32 v83, v83
    s_nop 0
    v_pk_mul_f32 v[168:169], v[168:169], v[80:81]
    v_pk_mul_f32 v[170:171], v[170:171], v[82:83]
    v_cvt_pk_bf16_f32 v106, v168, v169
    v_cvt_pk_bf16_f32 v107, v170, v171
    buffer_store_dwordx4 v[104:107], v3, s[16:19], s34 offen offset:256 sc1
    s_waitcnt lgkmcnt(0)
    v_pk_add_f32 v[172:173], v[172:173], v[84:85]
    v_pk_add_f32 v[174:175], v[174:175], v[86:87]
    v_pk_mul_f32 v[84:85], v[172:173], v[172:173]
    v_pk_mul_f32 v[86:87], v[174:175], v[174:175]
    v_pk_fma_f32 v[84:85], v[84:85], s[32:33], v[6:7] op_sel:[0,0,0] op_sel_hi:[1,0,0] neg_lo:[0,0,0] neg_hi:[0,0,0]
    v_pk_fma_f32 v[86:87], v[86:87], s[32:33], v[6:7] op_sel:[0,0,0] op_sel_hi:[1,0,0] neg_lo:[0,0,0] neg_hi:[0,0,0]
    v_pk_mul_f32 v[84:85], v[84:85], v[172:173]
    v_pk_mul_f32 v[86:87], v[86:87], v[174:175]
    v_exp_f32 v84, v84
    v_exp_f32 v85, v85
    v_exp_f32 v86, v86
    v_exp_f32 v87, v87
    s_nop 0
    v_pk_add_f32 v[84:85], v[84:85], 1.0 op_sel_hi:[1,0]
    v_pk_add_f32 v[86:87], v[86:87], 1.0 op_sel_hi:[1,0]
    v_rcp_f32 v84, v84
    v_rcp_f32 v85, v85
    v_rcp_f32 v86, v86
    v_rcp_f32 v87, v87
    s_nop 0
    v_pk_mul_f32 v[172:173], v[172:173], v[84:85]
    v_pk_mul_f32 v[174:175], v[174:175], v[86:87]
    v_cvt_pk_bf16_f32 v108, v172, v173
    v_cvt_pk_bf16_f32 v109, v174, v175
    buffer_store_dwordx2 v[108:109], v3, s[16:19], s33 offen offset:256 sc1
    s_branch L1_fin
L1g_nold:
    v_mov_b32 v120, 0
    v_mov_b32 v121, 0
    v_mov_b32 v122, 0
    v_mov_b32 v123, 0
    v_mov_b32 v124, 0
    v_mov_b32 v125, 0
    v_mov_b32 v126, 0
    v_mov_b32 v127, 0
    v_mov_b32 v128, 0
    v_mov_b32 v129, 0
    v_mov_b32 v130, 0
    v_mov_b32 v131, 0
    v_mov_b32 v132, 0
    v_mov_b32 v133, 0
    v_mov_b32 v134, 0
    v_mov_b32 v135, 0
    v_mov_b32 v136, 0
    v_mov_b32 v137, 0
    v_mov_b32 v138, 0
    v_mov_b32 v139, 0
    v_mov_b32 v140, 0
    v_mov_b32 v141, 0
    v_mov_b32 v142, 0
    v_mov_b32 v143, 0
    v_mov_b32 v144, 0
    v_mov_b32 v145, 0
    v_mov_b32 v146, 0
    v_mov_b32 v147, 0
    v_mov_b32 v148, 0
    v_mov_b32 v149, 0
    v_mov_b32 v150, 0
    v_mov_b32 v151, 0
    v_mov_b32 v152, 0
    v_mov_b32 v153, 0
    v_mov_b32 v154, 0
    v_mov_b32 v155, 0
    v_mov_b32 v156, 0
    v_mov_b32 v157, 0
    v_mov_b32 v158, 0
    v_mov_b32 v159, 0
    v_mov_b32 v160, 0
    v_mov_b32 v161, 0
    v_mov_b32 v162, 0
    v_mov_b32 v163, 0
    v_mov_b32 v164, 0
    v_mov_b32 v165, 0
    v_mov_b32 v166, 0
    v_mov_b32 v167, 0
    v_mov_b32 v168, 0
    v_mov_b32 v169, 0
    v_mov_b32 v170, 0
    v_mov_b32 v171, 0
    v_mov_b32 v172, 0
    v_mov_b32 v173, 0
    v_mov_b32 v174, 0
    v_mov_b32 v175, 0
    v_mov_b32 v176, 0
    v_mov_b32 v177, 0
    v_mov_b32 v178, 0
    v_mov_b32 v179, 0
    v_mov_b32 v180, 0
    v_mov_b32 v181, 0
    v_mov_b32 v182, 0
    v_mov_b32 v183, 0
    v_mov_b32 v184, 0
    v_mov_b32 v185, 0
    v_mov_b32 v186, 0
    v_mov_b32 v187, 0
    v_mov_b32 v188, 0
    v_mov_b32 v189, 0
    v_mov_b32 v190, 0
    v_mov_b32 v191, 0
    v_mov_b32 v192, 0
    v_mov_b32 v193, 0
    v_mov_b32 v194, 0
    v_mov_b32 v195, 0
    v_mov_b32 v196, 0
    v_mov_b32 v197, 0
    v_mov_b32 v198, 0
    v_mov_b32 v199, 0
    v_mov_b32 v200, 0
    v_mov_b32 v201, 0
    v_mov_b32 v202, 0
    v_mov_b32 v203, 0
    v_mov_b32 v204, 0
    v_mov_b32 v205, 0
    v_mov_b32 v206, 0
    v_mov_b32 v207, 0
    v_mov_b32 v208, 0
    v_mov_b32 v209, 0
    v_mov_b32 v210, 0
    v_mov_b32 v211, 0
    v_mov_b32 v212, 0
    v_mov_b32 v213, 0
    v_mov_b32 v214, 0
    v_mov_b32 v215, 0
    v_mov_b32 v216, 0
    v_mov_b32 v217, 0
    v_mov_b32 v218, 0
    v_mov_b32 v219, 0
    v_mov_b32 v220, 0
    v_mov_b32 v221, 0
    v_mov_b32 v222, 0
    v_mov_b32 v223, 0
    v_mov_b32 v224, 0
    v_mov_b32 v225, 0
    v_mov_b32 v226, 0
    v_mov_b32 v227, 0
    v_mov_b32 v228, 0
    v_mov_b32 v229, 0
    v_mov_b32 v230, 0
    v_mov_b32 v231, 0
    v_lshlrev_b32 v232, 3, v1
    v_and_b32 v233, 15, v1
    v_lshlrev_b32 v233, 3, v233
    s_and_b32 s33, s2, 7
    s_lshl_b32 s33, s33, 9
    s_add_u32 s33, s33, 41943040
    s_cmp_lg_u32 s28, 4
    s_cbranch_scc1 Lq_lng
    s_mov_b32 s34, 0
Lp_lng:
    buffer_load_dwordx2 v[36:37], v232, s[16:19], s33 offen sc1
    s_add_u32 s34, s34, 1
    s_waitcnt vmcnt(0)
    v_xor_b32 v36, s51, v36
    v_xor_b32 v37, s51, v37
    v_or_b32 v36, v36, v37
    v_cmp_ne_u32 vcc, 0, v36
    s_cbranch_vccz Lq_lng
    s_cmp_ge_u32 s34, 0x40000
    s_cbranch_scc1 Lq_lng
    s_sleep 1
    s_branch Lp_lng
Lq_lng:
    s_barrier
    s_barrier
    ds_read_b128 v[32:35], v20 offset:0
    ds_read_b64_tr_b16 v[48:49], v23 offset:0
    ds_read_b64_tr_b16 v[50:51], v23 offset:256
    ds_read_b128 v[36:39], v20 offset:256
    ds_read_b64_tr_b16 v[52:53], v26 offset:0
    ds_read_b64_tr_b16 v[54:55], v26 offset:256
    ds_read_b128 v[40:43], v20 offset:512
    ds_read_b64_tr_b16 v[56:57], v23 offset:4096
    ds_read_b64_tr_b16 v[58:59], v23 offset:4352
    ds_read_b128 v[44:47], v20 offset:768
    ds_read_b64_tr_b16 v[60:61], v26 offset:4096
    ds_read_b64_tr_b16 v[62:63], v26 offset:4352
    ds_read_b64_tr_b16 v[64:65], v23 offset:8192
    ds_read_b64_tr_b16 v[66:67], v23 offset:8448
    ds_read_b64_tr_b16 v[68:69], v26 offset:8192
    ds_read_b64_tr_b16 v[70:71], v26 offset:8448
    ds_read_b64_tr_b16 v[72:73], v29 offset:0
    ds_read_b64_tr_b16 v[74:75], v29 offset:256
    s_mov_b32 s36, 4
L_g_4708:
    s_waitcnt lgkmcnt(0)
    s_barrier
    v_mfma_f32_16x16x32_bf16 v[120:123], v[48:51], v[32:35], v[120:123]
    ds_read_b128 v[76:79], v21 offset:0
    v_mfma_f32_16x16x32_bf16 v[124:127], v[52:55], v[32:35], v[124:127]
    ds_read_b64_tr_b16 v[92:93], v24 offset:0
    v_mfma_f32_16x16x32_bf16 v[128:131], v[56:59], v[32:35], v[128:131]
    ds_read_b64_tr_b16 v[94:95], v24 offset:256
    v_mfma_f32_16x16x32_bf16 v[132:135], v[60:63], v[32:35], v[132:135]
    ds_read_b128 v[80:83], v21 offset:256
    v_mfma_f32_16x16x32_bf16 v[136:139], v[64:67], v[32:35], v[136:139]
    ds_read_b64_tr_b16 v[96:97], v27 offset:0
    v_mfma_f32_16x16x32_bf16 v[140:143], v[68:71], v[32:35], v[140:143]
    ds_read_b64_tr_b16 v[98:99], v27 offset:256
    v_mfma_f32_16x16x32_bf16 v[144:147], v[72:75], v[32:35], v[144:147]
    ds_read_b128 v[84:87], v21 offset:512
    v_mfma_f32_16x16x32_bf16 v[148:151], v[48:51], v[36:39], v[148:151]
    ds_read_b64_tr_b16 v[100:101], v24 offset:4096
    v_mfma_f32_16x16x32_bf16 v[152:155], v[52:55], v[36:39], v[152:155]
    ds_read_b64_tr_b16 v[102:103], v24 offset:4352
    v_mfma_f32_16x16x32_bf16 v[156:159], v[56:59], v[36:39], v[156:159]
    ds_read_b128 v[88:91], v21 offset:768
    v_mfma_f32_16x16x32_bf16 v[160:163], v[60:63], v[36:39], v[160:163]
    ds_read_b64_tr_b16 v[104:105], v27 offset:4096
    v_mfma_f32_16x16x32_bf16 v[164:167], v[64:67], v[36:39], v[164:167]
    ds_read_b64_tr_b16 v[106:107], v27 offset:4352
    v_mfma_f32_16x16x32_bf16 v[168:171], v[68:71], v[36:39], v[168:171]
    ds_read_b64_tr_b16 v[108:109], v24 offset:8192
    v_mfma_f32_16x16x32_bf16 v[172:175], v[72:75], v[36:39], v[172:175]
    ds_read_b64_tr_b16 v[110:111], v24 offset:8448
    v_mfma_f32_16x16x32_bf16 v[176:179], v[48:51], v[40:43], v[176:179]
    ds_read_b64_tr_b16 v[112:113], v27 offset:8192
    v_mfma_f32_16x16x32_bf16 v[180:183], v[52:55], v[40:43], v[180:183]
    ds_read_b64_tr_b16 v[114:115], v27 offset:8448
    v_mfma_f32_16x16x32_bf16 v[184:187], v[56:59], v[40:43], v[184:187]
    ds_read_b64_tr_b16 v[116:117], v30 offset:0
    v_mfma_f32_16x16x32_bf16 v[188:191], v[60:63], v[40:43], v[188:191]
    ds_read_b64_tr_b16 v[118:119], v30 offset:256
    v_mfma_f32_16x16x32_bf16 v[192:195], v[64:67], v[40:43], v[192:195]
    v_mfma_f32_16x16x32_bf16 v[196:199], v[68:71], v[40:43], v[196:199]
    v_mfma_f32_16x16x32_bf16 v[200:203], v[72:75], v[40:43], v[200:203]
    v_mfma_f32_16x16x32_bf16 v[204:207], v[48:51], v[44:47], v[204:207]
    v_mfma_f32_16x16x32_bf16 v[208:211], v[52:55], v[44:47], v[208:211]
    v_mfma_f32_16x16x32_bf16 v[212:215], v[56:59], v[44:47], v[212:215]
    v_mfma_f32_16x16x32_bf16 v[216:219], v[60:63], v[44:47], v[216:219]
    v_mfma_f32_16x16x32_bf16 v[220:223], v[64:67], v[44:47], v[220:223]
    v_mfma_f32_16x16x32_bf16 v[224:227], v[68:71], v[44:47], v[224:227]
    v_mfma_f32_16x16x32_bf16 v[228:231], v[72:75], v[44:47], v[228:231]
    s_waitcnt lgkmcnt(0)
    s_barrier
    v_mfma_f32_16x16x32_bf16 v[120:123], v[92:95], v[76:79], v[120:123]
    ds_read_b128 v[32:35], v22 offset:0
    v_mfma_f32_16x16x32_bf16 v[124:127], v[96:99], v[76:79], v[124:127]
    ds_read_b64_tr_b16 v[48:49], v25 offset:0
    v_mfma_f32_16x16x32_bf16 v[128:131], v[100:103], v[76:79], v[128:131]
    ds_read_b64_tr_b16 v[50:51], v25 offset:256
    v_mfma_f32_16x16x32_bf16 v[132:135], v[104:107], v[76:79], v[132:135]
    ds_read_b128 v[36:39], v22 offset:256
    v_mfma_f32_16x16x32_bf16 v[136:139], v[108:111], v[76:79], v[136:139]
    ds_read_b64_tr_b16 v[52:53], v28 offset:0
    v_mfma_f32_16x16x32_bf16 v[140:143], v[112:115], v[76:79], v[140:143]
    ds_read_b64_tr_b16 v[54:55], v28 offset:256
    v_mfma_f32_16x16x32_bf16 v[144:147], v[116:119], v[76:79], v[144:147]
    ds_read_b128 v[40:43], v22 offset:512
    v_mfma_f32_16x16x32_bf16 v[148:151], v[92:95], v[80:83], v[148:151]
    ds_read_b64_tr_b16 v[56:57], v25 offset:4096
    v_mfma_f32_16x16x32_bf16 v[152:155], v[96:99], v[80:83], v[152:155]
    ds_read_b64_tr_b16 v[58:59], v25 offset:4352
    v_mfma_f32_16x16x32_bf16 v[156:159], v[100:103], v[80:83], v[156:159]
    ds_read_b128 v[44:47], v22 offset:768
    v_mfma_f32_16x16x32_bf16 v[160:163], v[104:107], v[80:83], v[160:163]
    ds_read_b64_tr_b16 v[60:61], v28 offset:4096
    v_mfma_f32_16x16x32_bf16 v[164:167], v[108:111], v[80:83], v[164:167]
    ds_read_b64_tr_b16 v[62:63], v28 offset:4352
    v_mfma_f32_16x16x32_bf16 v[168:171], v[112:115], v[80:83], v[168:171]
    ds_read_b64_tr_b16 v[64:65], v25 offset:8192
    v_mfma_f32_16x16x32_bf16 v[172:175], v[116:119], v[80:83], v[172:175]
    ds_read_b64_tr_b16 v[66:67], v25 offset:8448
    v_mfma_f32_16x16x32_bf16 v[176:179], v[92:95], v[84:87], v[176:179]
    ds_read_b64_tr_b16 v[68:69], v28 offset:8192
    v_mfma_f32_16x16x32_bf16 v[180:183], v[96:99], v[84:87], v[180:183]
    ds_read_b64_tr_b16 v[70:71], v28 offset:8448
    v_mfma_f32_16x16x32_bf16 v[184:187], v[100:103], v[84:87], v[184:187]
    ds_read_b64_tr_b16 v[72:73], v31 offset:0
    v_mfma_f32_16x16x32_bf16 v[188:191], v[104:107], v[84:87], v[188:191]
    ds_read_b64_tr_b16 v[74:75], v31 offset:256
    v_mfma_f32_16x16x32_bf16 v[192:195], v[108:111], v[84:87], v[192:195]
    v_mfma_f32_16x16x32_bf16 v[196:199], v[112:115], v[84:87], v[196:199]
    v_mfma_f32_16x16x32_bf16 v[200:203], v[116:119], v[84:87], v[200:203]
    v_mfma_f32_16x16x32_bf16 v[204:207], v[92:95], v[88:91], v[204:207]
    v_mfma_f32_16x16x32_bf16 v[208:211], v[96:99], v[88:91], v[208:211]
    v_mfma_f32_16x16x32_bf16 v[212:215], v[100:103], v[88:91], v[212:215]
    v_mfma_f32_16x16x32_bf16 v[216:219], v[104:107], v[88:91], v[216:219]
    v_mfma_f32_16x16x32_bf16 v[220:223], v[108:111], v[88:91], v[220:223]
    v_mfma_f32_16x16x32_bf16 v[224:227], v[112:115], v[88:91], v[224:227]
    v_mfma_f32_16x16x32_bf16 v[228:231], v[116:119], v[88:91], v[228:231]
    s_waitcnt lgkmcnt(0)
    s_barrier
    v_mfma_f32_16x16x32_bf16 v[120:123], v[48:51], v[32:35], v[120:123]
    ds_read_b128 v[76:79], v20 offset:0
    v_mfma_f32_16x16x32_bf16 v[124:127], v[52:55], v[32:35], v[124:127]
    ds_read_b64_tr_b16 v[92:93], v23 offset:0
    v_mfma_f32_16x16x32_bf16 v[128:131], v[56:59], v[32:35], v[128:131]
    ds_read_b64_tr_b16 v[94:95], v23 offset:256
    v_mfma_f32_16x16x32_bf16 v[132:135], v[60:63], v[32:35], v[132:135]
    ds_read_b128 v[80:83], v20 offset:256
    v_mfma_f32_16x16x32_bf16 v[136:139], v[64:67], v[32:35], v[136:139]
    ds_read_b64_tr_b16 v[96:97], v26 offset:0
    v_mfma_f32_16x16x32_bf16 v[140:143], v[68:71], v[32:35], v[140:143]
    ds_read_b64_tr_b16 v[98:99], v26 offset:256
    v_mfma_f32_16x16x32_bf16 v[144:147], v[72:75], v[32:35], v[144:147]
    ds_read_b128 v[84:87], v20 offset:512
    v_mfma_f32_16x16x32_bf16 v[148:151], v[48:51], v[36:39], v[148:151]
    ds_read_b64_tr_b16 v[100:101], v23 offset:4096
    v_mfma_f32_16x16x32_bf16 v[152:155], v[52:55], v[36:39], v[152:155]
    ds_read_b64_tr_b16 v[102:103], v23 offset:4352
    v_mfma_f32_16x16x32_bf16 v[156:159], v[56:59], v[36:39], v[156:159]
    ds_read_b128 v[88:91], v20 offset:768
    v_mfma_f32_16x16x32_bf16 v[160:163], v[60:63], v[36:39], v[160:163]
    ds_read_b64_tr_b16 v[104:105], v26 offset:4096
    v_mfma_f32_16x16x32_bf16 v[164:167], v[64:67], v[36:39], v[164:167]
    ds_read_b64_tr_b16 v[106:107], v26 offset:4352
    v_mfma_f32_16x16x32_bf16 v[168:171], v[68:71], v[36:39], v[168:171]
    ds_read_b64_tr_b16 v[108:109], v23 offset:8192
    v_mfma_f32_16x16x32_bf16 v[172:175], v[72:75], v[36:39], v[172:175]
    ds_read_b64_tr_b16 v[110:111], v23 offset:8448
    v_mfma_f32_16x16x32_bf16 v[176:179], v[48:51], v[40:43], v[176:179]
    ds_read_b64_tr_b16 v[112:113], v26 offset:8192
    v_mfma_f32_16x16x32_bf16 v[180:183], v[52:55], v[40:43], v[180:183]
    ds_read_b64_tr_b16 v[114:115], v26 offset:8448
    v_mfma_f32_16x16x32_bf16 v[184:187], v[56:59], v[40:43], v[184:187]
    ds_read_b64_tr_b16 v[116:117], v29 offset:0
    v_mfma_f32_16x16x32_bf16 v[188:191], v[60:63], v[40:43], v[188:191]
    ds_read_b64_tr_b16 v[118:119], v29 offset:256
    v_mfma_f32_16x16x32_bf16 v[192:195], v[64:67], v[40:43], v[192:195]
    v_mfma_f32_16x16x32_bf16 v[196:199], v[68:71], v[40:43], v[196:199]
    v_mfma_f32_16x16x32_bf16 v[200:203], v[72:75], v[40:43], v[200:203]
    v_mfma_f32_16x16x32_bf16 v[204:207], v[48:51], v[44:47], v[204:207]
    v_mfma_f32_16x16x32_bf16 v[208:211], v[52:55], v[44:47], v[208:211]
    v_mfma_f32_16x16x32_bf16 v[212:215], v[56:59], v[44:47], v[212:215]
    v_mfma_f32_16x16x32_bf16 v[216:219], v[60:63], v[44:47], v[216:219]
    v_mfma_f32_16x16x32_bf16 v[220:223], v[64:67], v[44:47], v[220:223]
    v_mfma_f32_16x16x32_bf16 v[224:227], v[68:71], v[44:47], v[224:227]
    v_mfma_f32_16x16x32_bf16 v[228:231], v[72:75], v[44:47], v[228:231]
    s_waitcnt lgkmcnt(0)
    s_barrier
    v_mfma_f32_16x16x32_bf16 v[120:123], v[92:95], v[76:79], v[120:123]
    ds_read_b128 v[32:35], v21 offset:0
    v_mfma_f32_16x16x32_bf16 v[124:127], v[96:99], v[76:79], v[124:127]
    ds_read_b64_tr_b16 v[48:49], v24 offset:0
    v_mfma_f32_16x16x32_bf16 v[128:131], v[100:103], v[76:79], v[128:131]
    ds_read_b64_tr_b16 v[50:51], v24 offset:256
    v_mfma_f32_16x16x32_bf16 v[132:135], v[104:107], v[76:79], v[132:135]
    ds_read_b128 v[36:39], v21 offset:256
    v_mfma_f32_16x16x32_bf16 v[136:139], v[108:111], v[76:79], v[136:139]
    ds_read_b64_tr_b16 v[52:53], v27 offset:0
    v_mfma_f32_16x16x32_bf16 v[140:143], v[112:115], v[76:79], v[140:143]
    ds_read_b64_tr_b16 v[54:55], v27 offset:256
    v_mfma_f32_16x16x32_bf16 v[144:147], v[116:119], v[76:79], v[144:147]
    ds_read_b128 v[40:43], v21 offset:512
    v_mfma_f32_16x16x32_bf16 v[148:151], v[92:95], v[80:83], v[148:151]
    ds_read_b64_tr_b16 v[56:57], v24 offset:4096
    v_mfma_f32_16x16x32_bf16 v[152:155], v[96:99], v[80:83], v[152:155]
    ds_read_b64_tr_b16 v[58:59], v24 offset:4352
    v_mfma_f32_16x16x32_bf16 v[156:159], v[100:103], v[80:83], v[156:159]
    ds_read_b128 v[44:47], v21 offset:768
    v_mfma_f32_16x16x32_bf16 v[160:163], v[104:107], v[80:83], v[160:163]
    ds_read_b64_tr_b16 v[60:61], v27 offset:4096
    v_mfma_f32_16x16x32_bf16 v[164:167], v[108:111], v[80:83], v[164:167]
    ds_read_b64_tr_b16 v[62:63], v27 offset:4352
    v_mfma_f32_16x16x32_bf16 v[168:171], v[112:115], v[80:83], v[168:171]
    ds_read_b64_tr_b16 v[64:65], v24 offset:8192
    v_mfma_f32_16x16x32_bf16 v[172:175], v[116:119], v[80:83], v[172:175]
    ds_read_b64_tr_b16 v[66:67], v24 offset:8448
    v_mfma_f32_16x16x32_bf16 v[176:179], v[92:95], v[84:87], v[176:179]
    ds_read_b64_tr_b16 v[68:69], v27 offset:8192
    v_mfma_f32_16x16x32_bf16 v[180:183], v[96:99], v[84:87], v[180:183]
    ds_read_b64_tr_b16 v[70:71], v27 offset:8448
    v_mfma_f32_16x16x32_bf16 v[184:187], v[100:103], v[84:87], v[184:187]
    ds_read_b64_tr_b16 v[72:73], v30 offset:0
    v_mfma_f32_16x16x32_bf16 v[188:191], v[104:107], v[84:87], v[188:191]
    ds_read_b64_tr_b16 v[74:75], v30 offset:256
    v_mfma_f32_16x16x32_bf16 v[192:195], v[108:111], v[84:87], v[192:195]
    v_mfma_f32_16x16x32_bf16 v[196:199], v[112:115], v[84:87], v[196:199]
    v_mfma_f32_16x16x32_bf16 v[200:203], v[116:119], v[84:87], v[200:203]
    v_mfma_f32_16x16x32_bf16 v[204:207], v[92:95], v[88:91], v[204:207]
    v_mfma_f32_16x16x32_bf16 v[208:211], v[96:99], v[88:91], v[208:211]
    v_mfma_f32_16x16x32_bf16 v[212:215], v[100:103], v[88:91], v[212:215]
    v_mfma_f32_16x16x32_bf16 v[216:219], v[104:107], v[88:91], v[216:219]
    v_mfma_f32_16x16x32_bf16 v[220:223], v[108:111], v[88:91], v[220:223]
    v_mfma_f32_16x16x32_bf16 v[224:227], v[112:115], v[88:91], v[224:227]
    v_mfma_f32_16x16x32_bf16 v[228:231], v[116:119], v[88:91], v[228:231]
    s_waitcnt lgkmcnt(0)
    s_barrier
    v_mfma_f32_16x16x32_bf16 v[120:123], v[48:51], v[32:35], v[120:123]
    ds_read_b128 v[76:79], v22 offset:0
    v_mfma_f32_16x16x32_bf16 v[124:127], v[52:55], v[32:35], v[124:127]
    ds_read_b64_tr_b16 v[92:93], v25 offset:0
    v_mfma_f32_16x16x32_bf16 v[128:131], v[56:59], v[32:35], v[128:131]
    ds_read_b64_tr_b16 v[94:95], v25 offset:256
    v_mfma_f32_16x16x32_bf16 v[132:135], v[60:63], v[32:35], v[132:135]
    ds_read_b128 v[80:83], v22 offset:256
    v_mfma_f32_16x16x32_bf16 v[136:139], v[64:67], v[32:35], v[136:139]
    ds_read_b64_tr_b16 v[96:97], v28 offset:0
    v_mfma_f32_16x16x32_bf16 v[140:143], v[68:71], v[32:35], v[140:143]
    ds_read_b64_tr_b16 v[98:99], v28 offset:256
    v_mfma_f32_16x16x32_bf16 v[144:147], v[72:75], v[32:35], v[144:147]
    ds_read_b128 v[84:87], v22 offset:512
    v_mfma_f32_16x16x32_bf16 v[148:151], v[48:51], v[36:39], v[148:151]
    ds_read_b64_tr_b16 v[100:101], v25 offset:4096
    v_mfma_f32_16x16x32_bf16 v[152:155], v[52:55], v[36:39], v[152:155]
    ds_read_b64_tr_b16 v[102:103], v25 offset:4352
    v_mfma_f32_16x16x32_bf16 v[156:159], v[56:59], v[36:39], v[156:159]
    ds_read_b128 v[88:91], v22 offset:768
    v_mfma_f32_16x16x32_bf16 v[160:163], v[60:63], v[36:39], v[160:163]
    ds_read_b64_tr_b16 v[104:105], v28 offset:4096
    v_mfma_f32_16x16x32_bf16 v[164:167], v[64:67], v[36:39], v[164:167]
    ds_read_b64_tr_b16 v[106:107], v28 offset:4352
    v_mfma_f32_16x16x32_bf16 v[168:171], v[68:71], v[36:39], v[168:171]
    ds_read_b64_tr_b16 v[108:109], v25 offset:8192
    v_mfma_f32_16x16x32_bf16 v[172:175], v[72:75], v[36:39], v[172:175]
    ds_read_b64_tr_b16 v[110:111], v25 offset:8448
    v_mfma_f32_16x16x32_bf16 v[176:179], v[48:51], v[40:43], v[176:179]
    ds_read_b64_tr_b16 v[112:113], v28 offset:8192
    v_mfma_f32_16x16x32_bf16 v[180:183], v[52:55], v[40:43], v[180:183]
    ds_read_b64_tr_b16 v[114:115], v28 offset:8448
    v_mfma_f32_16x16x32_bf16 v[184:187], v[56:59], v[40:43], v[184:187]
    ds_read_b64_tr_b16 v[116:117], v31 offset:0
    v_mfma_f32_16x16x32_bf16 v[188:191], v[60:63], v[40:43], v[188:191]
    ds_read_b64_tr_b16 v[118:119], v31 offset:256
    v_mfma_f32_16x16x32_bf16 v[192:195], v[64:67], v[40:43], v[192:195]
    v_mfma_f32_16x16x32_bf16 v[196:199], v[68:71], v[40:43], v[196:199]
    v_mfma_f32_16x16x32_bf16 v[200:203], v[72:75], v[40:43], v[200:203]
    v_mfma_f32_16x16x32_bf16 v[204:207], v[48:51], v[44:47], v[204:207]
    v_mfma_f32_16x16x32_bf16 v[208:211], v[52:55], v[44:47], v[208:211]
    v_mfma_f32_16x16x32_bf16 v[212:215], v[56:59], v[44:47], v[212:215]
    v_mfma_f32_16x16x32_bf16 v[216:219], v[60:63], v[44:47], v[216:219]
    v_mfma_f32_16x16x32_bf16 v[220:223], v[64:67], v[44:47], v[220:223]
    v_mfma_f32_16x16x32_bf16 v[224:227], v[68:71], v[44:47], v[224:227]
    v_mfma_f32_16x16x32_bf16 v[228:231], v[72:75], v[44:47], v[228:231]
    s_waitcnt lgkmcnt(0)
    s_barrier
    v_mfma_f32_16x16x32_bf16 v[120:123], v[92:95], v[76:79], v[120:123]
    ds_read_b128 v[32:35], v20 offset:0
    v_mfma_f32_16x16x32_bf16 v[124:127], v[96:99], v[76:79], v[124:127]
    ds_read_b64_tr_b16 v[48:49], v23 offset:0
    v_mfma_f32_16x16x32_bf16 v[128:131], v[100:103], v[76:79], v[128:131]
    ds_read_b64_tr_b16 v[50:51], v23 offset:256
    v_mfma_f32_16x16x32_bf16 v[132:135], v[104:107], v[76:79], v[132:135]
    ds_read_b128 v[36:39], v20 offset:256
    v_mfma_f32_16x16x32_bf16 v[136:139], v[108:111], v[76:79], v[136:139]
    ds_read_b64_tr_b16 v[52:53], v26 offset:0
    v_mfma_f32_16x16x32_bf16 v[140:143], v[112:115], v[76:79], v[140:143]
    ds_read_b64_tr_b16 v[54:55], v26 offset:256
    v_mfma_f32_16x16x32_bf16 v[144:147], v[116:119], v[76:79], v[144:147]
    ds_read_b128 v[40:43], v20 offset:512
    v_mfma_f32_16x16x32_bf16 v[148:151], v[92:95], v[80:83], v[148:151]
    ds_read_b64_tr_b16 v[56:57], v23 offset:4096
    v_mfma_f32_16x16x32_bf16 v[152:155], v[96:99], v[80:83], v[152:155]
    ds_read_b64_tr_b16 v[58:59], v23 offset:4352
    v_mfma_f32_16x16x32_bf16 v[156:159], v[100:103], v[80:83], v[156:159]
    ds_read_b128 v[44:47], v20 offset:768
    v_mfma_f32_16x16x32_bf16 v[160:163], v[104:107], v[80:83], v[160:163]
    ds_read_b64_tr_b16 v[60:61], v26 offset:4096
    v_mfma_f32_16x16x32_bf16 v[164:167], v[108:111], v[80:83], v[164:167]
    ds_read_b64_tr_b16 v[62:63], v26 offset:4352
    v_mfma_f32_16x16x32_bf16 v[168:171], v[112:115], v[80:83], v[168:171]
    ds_read_b64_tr_b16 v[64:65], v23 offset:8192
    v_mfma_f32_16x16x32_bf16 v[172:175], v[116:119], v[80:83], v[172:175]
    ds_read_b64_tr_b16 v[66:67], v23 offset:8448
    v_mfma_f32_16x16x32_bf16 v[176:179], v[92:95], v[84:87], v[176:179]
    ds_read_b64_tr_b16 v[68:69], v26 offset:8192
    v_mfma_f32_16x16x32_bf16 v[180:183], v[96:99], v[84:87], v[180:183]
    ds_read_b64_tr_b16 v[70:71], v26 offset:8448
    v_mfma_f32_16x16x32_bf16 v[184:187], v[100:103], v[84:87], v[184:187]
    ds_read_b64_tr_b16 v[72:73], v29 offset:0
    v_mfma_f32_16x16x32_bf16 v[188:191], v[104:107], v[84:87], v[188:191]
    ds_read_b64_tr_b16 v[74:75], v29 offset:256
    v_mfma_f32_16x16x32_bf16 v[192:195], v[108:111], v[84:87], v[192:195]
    v_mfma_f32_16x16x32_bf16 v[196:199], v[112:115], v[84:87], v[196:199]
    v_mfma_f32_16x16x32_bf16 v[200:203], v[116:119], v[84:87], v[200:203]
    v_mfma_f32_16x16x32_bf16 v[204:207], v[92:95], v[88:91], v[204:207]
    v_mfma_f32_16x16x32_bf16 v[208:211], v[96:99], v[88:91], v[208:211]
    v_mfma_f32_16x16x32_bf16 v[212:215], v[100:103], v[88:91], v[212:215]
    v_mfma_f32_16x16x32_bf16 v[216:219], v[104:107], v[88:91], v[216:219]
    v_mfma_f32_16x16x32_bf16 v[220:223], v[108:111], v[88:91], v[220:223]
    v_mfma_f32_16x16x32_bf16 v[224:227], v[112:115], v[88:91], v[224:227]
    v_mfma_f32_16x16x32_bf16 v[228:231], v[116:119], v[88:91], v[228:231]
    s_sub_u32 s36, s36, 1
    s_cmp_lg_u32 s36, 0
    s_cbranch_scc1 L_g_4708
    s_waitcnt lgkmcnt(0)
    s_barrier
    v_mfma_f32_16x16x32_bf16 v[120:123], v[48:51], v[32:35], v[120:123]
    ds_read_b128 v[76:79], v21 offset:0
    v_mfma_f32_16x16x32_bf16 v[124:127], v[52:55], v[32:35], v[124:127]
    ds_read_b64_tr_b16 v[92:93], v24 offset:0
    v_mfma_f32_16x16x32_bf16 v[128:131], v[56:59], v[32:35], v[128:131]
    ds_read_b64_tr_b16 v[94:95], v24 offset:256
    v_mfma_f32_16x16x32_bf16 v[132:135], v[60:63], v[32:35], v[132:135]
    ds_read_b128 v[80:83], v21 offset:256
    v_mfma_f32_16x16x32_bf16 v[136:139], v[64:67], v[32:35], v[136:139]
    ds_read_b64_tr_b16 v[96:97], v27 offset:0
    v_mfma_f32_16x16x32_bf16 v[140:143], v[68:71], v[32:35], v[140:143]
    ds_read_b64_tr_b16 v[98:99], v27 offset:256
    v_mfma_f32_16x16x32_bf16 v[144:147], v[72:75], v[32:35], v[144:147]
    ds_read_b128 v[84:87], v21 offset:512
    v_mfma_f32_16x16x32_bf16 v[148:151], v[48:51], v[36:39], v[148:151]
    ds_read_b64_tr_b16 v[100:101], v24 offset:4096
    v_mfma_f32_16x16x32_bf16 v[152:155], v[52:55], v[36:39], v[152:155]
    ds_read_b64_tr_b16 v[102:103], v24 offset:4352
    v_mfma_f32_16x16x32_bf16 v[156:159], v[56:59], v[36:39], v[156:159]
    ds_read_b128 v[88:91], v21 offset:768
    v_mfma_f32_16x16x32_bf16 v[160:163], v[60:63], v[36:39], v[160:163]
    ds_read_b64_tr_b16 v[104:105], v27 offset:4096
    v_mfma_f32_16x16x32_bf16 v[164:167], v[64:67], v[36:39], v[164:167]
    ds_read_b64_tr_b16 v[106:107], v27 offset:4352
    v_mfma_f32_16x16x32_bf16 v[168:171], v[68:71], v[36:39], v[168:171]
    ds_read_b64_tr_b16 v[108:109], v24 offset:8192
    v_mfma_f32_16x16x32_bf16 v[172:175], v[72:75], v[36:39], v[172:175]
    ds_read_b64_tr_b16 v[110:111], v24 offset:8448
    v_mfma_f32_16x16x32_bf16 v[176:179], v[48:51], v[40:43], v[176:179]
    ds_read_b64_tr_b16 v[112:113], v27 offset:8192
    v_mfma_f32_16x16x32_bf16 v[180:183], v[52:55], v[40:43], v[180:183]
    ds_read_b64_tr_b16 v[114:115], v27 offset:8448
    v_mfma_f32_16x16x32_bf16 v[184:187], v[56:59], v[40:43], v[184:187]
    ds_read_b64_tr_b16 v[116:117], v30 offset:0
    v_mfma_f32_16x16x32_bf16 v[188:191], v[60:63], v[40:43], v[188:191]
    ds_read_b64_tr_b16 v[118:119], v30 offset:256
    v_mfma_f32_16x16x32_bf16 v[192:195], v[64:67], v[40:43], v[192:195]
    v_mfma_f32_16x16x32_bf16 v[196:199], v[68:71], v[40:43], v[196:199]
    v_mfma_f32_16x16x32_bf16 v[200:203], v[72:75], v[40:43], v[200:203]
    v_mfma_f32_16x16x32_bf16 v[204:207], v[48:51], v[44:47], v[204:207]
    v_mfma_f32_16x16x32_bf16 v[208:211], v[52:55], v[44:47], v[208:211]
    v_mfma_f32_16x16x32_bf16 v[212:215], v[56:59], v[44:47], v[212:215]
    v_mfma_f32_16x16x32_bf16 v[216:219], v[60:63], v[44:47], v[216:219]
    v_mfma_f32_16x16x32_bf16 v[220:223], v[64:67], v[44:47], v[220:223]
    v_mfma_f32_16x16x32_bf16 v[224:227], v[68:71], v[44:47], v[224:227]
    v_mfma_f32_16x16x32_bf16 v[228:231], v[72:75], v[44:47], v[228:231]
    s_waitcnt lgkmcnt(0)
    s_barrier
    v_mfma_f32_16x16x32_bf16 v[120:123], v[92:95], v[76:79], v[120:123]
    ds_read_b128 v[32:35], v22 offset:0
    v_mfma_f32_16x16x32_bf16 v[124:127], v[96:99], v[76:79], v[124:127]
    ds_read_b64_tr_b16 v[48:49], v25 offset:0
    v_mfma_f32_16x16x32_bf16 v[128:131], v[100:103], v[76:79], v[128:131]
    ds_read_b64_tr_b16 v[50:51], v25 offset:256
    v_mfma_f32_16x16x32_bf16 v[132:135], v[104:107], v[76:79], v[132:135]
    ds_read_b128 v[36:39], v22 offset:256
    v_mfma_f32_16x16x32_bf16 v[136:139], v[108:111], v[76:79], v[136:139]
    ds_read_b64_tr_b16 v[52:53], v28 offset:0
    v_mfma_f32_16x16x32_bf16 v[140:143], v[112:115], v[76:79], v[140:143]
    ds_read_b64_tr_b16 v[54:55], v28 offset:256
    v_mfma_f32_16x16x32_bf16 v[144:147], v[116:119], v[76:79], v[144:147]
    ds_read_b128 v[40:43], v22 offset:512
    v_mfma_f32_16x16x32_bf16 v[148:151], v[92:95], v[80:83], v[148:151]
    ds_read_b64_tr_b16 v[56:57], v25 offset:4096
    v_mfma_f32_16x16x32_bf16 v[152:155], v[96:99], v[80:83], v[152:155]
    ds_read_b64_tr_b16 v[58:59], v25 offset:4352
    v_mfma_f32_16x16x32_bf16 v[156:159], v[100:103], v[80:83], v[156:159]
    ds_read_b128 v[44:47], v22 offset:768
    v_mfma_f32_16x16x32_bf16 v[160:163], v[104:107], v[80:83], v[160:163]
    ds_read_b64_tr_b16 v[60:61], v28 offset:4096
    v_mfma_f32_16x16x32_bf16 v[164:167], v[108:111], v[80:83], v[164:167]
    ds_read_b64_tr_b16 v[62:63], v28 offset:4352
    v_mfma_f32_16x16x32_bf16 v[168:171], v[112:115], v[80:83], v[168:171]
    ds_read_b64_tr_b16 v[64:65], v25 offset:8192
    v_mfma_f32_16x16x32_bf16 v[172:175], v[116:119], v[80:83], v[172:175]
    ds_read_b64_tr_b16 v[66:67], v25 offset:8448
    v_mfma_f32_16x16x32_bf16 v[176:179], v[92:95], v[84:87], v[176:179]
    ds_read_b64_tr_b16 v[68:69], v28 offset:8192
    v_mfma_f32_16x16x32_bf16 v[180:183], v[96:99], v[84:87], v[180:183]
    ds_read_b64_tr_b16 v[70:71], v28 offset:8448
    v_mfma_f32_16x16x32_bf16 v[184:187], v[100:103], v[84:87], v[184:187]
    ds_read_b64_tr_b16 v[72:73], v31 offset:0
    v_mfma_f32_16x16x32_bf16 v[188:191], v[104:107], v[84:87], v[188:191]
    ds_read_b64_tr_b16 v[74:75], v31 offset:256
    v_mfma_f32_16x16x32_bf16 v[192:195], v[108:111], v[84:87], v[192:195]
    v_mfma_f32_16x16x32_bf16 v[196:199], v[112:115], v[84:87], v[196:199]
    v_mfma_f32_16x16x32_bf16 v[200:203], v[116:119], v[84:87], v[200:203]
    v_mfma_f32_16x16x32_bf16 v[204:207], v[92:95], v[88:91], v[204:207]
    v_mfma_f32_16x16x32_bf16 v[208:211], v[96:99], v[88:91], v[208:211]
    v_mfma_f32_16x16x32_bf16 v[212:215], v[100:103], v[88:91], v[212:215]
    v_mfma_f32_16x16x32_bf16 v[216:219], v[104:107], v[88:91], v[216:219]
    v_mfma_f32_16x16x32_bf16 v[220:223], v[108:111], v[88:91], v[220:223]
    v_mfma_f32_16x16x32_bf16 v[224:227], v[112:115], v[88:91], v[224:227]
    v_mfma_f32_16x16x32_bf16 v[228:231], v[116:119], v[88:91], v[228:231]
    s_waitcnt lgkmcnt(0)
    s_barrier
    v_mfma_f32_16x16x32_bf16 v[120:123], v[48:51], v[32:35], v[120:123]
    ds_read_b128 v[76:79], v20 offset:0
    v_mfma_f32_16x16x32_bf16 v[124:127], v[52:55], v[32:35], v[124:127]
    ds_read_b64_tr_b16 v[92:93], v23 offset:0
    v_mfma_f32_16x16x32_bf16 v[128:131], v[56:59], v[32:35], v[128:131]
    ds_read_b64_tr_b16 v[94:95], v23 offset:256
    v_mfma_f32_16x16x32_bf16 v[132:135], v[60:63], v[32:35], v[132:135]
    ds_read_b128 v[80:83], v20 offset:256
    v_mfma_f32_16x16x32_bf16 v[136:139], v[64:67], v[32:35], v[136:139]
    ds_read_b64_tr_b16 v[96:97], v26 offset:0
    v_mfma_f32_16x16x32_bf16 v[140:143], v[68:71], v[32:35], v[140:143]
    ds_read_b64_tr_b16 v[98:99], v26 offset:256
    v_mfma_f32_16x16x32_bf16 v[144:147], v[72:75], v[32:35], v[144:147]
    ds_read_b128 v[84:87], v20 offset:512
    v_mfma_f32_16x16x32_bf16 v[148:151], v[48:51], v[36:39], v[148:151]
    ds_read_b64_tr_b16 v[100:101], v23 offset:4096
    v_mfma_f32_16x16x32_bf16 v[152:155], v[52:55], v[36:39], v[152:155]
    ds_read_b64_tr_b16 v[102:103], v23 offset:4352
    v_mfma_f32_16x16x32_bf16 v[156:159], v[56:59], v[36:39], v[156:159]
    ds_read_b128 v[88:91], v20 offset:768
    v_mfma_f32_16x16x32_bf16 v[160:163], v[60:63], v[36:39], v[160:163]
    ds_read_b64_tr_b16 v[104:105], v26 offset:4096
    v_mfma_f32_16x16x32_bf16 v[164:167], v[64:67], v[36:39], v[164:167]
    ds_read_b64_tr_b16 v[106:107], v26 offset:4352
    v_mfma_f32_16x16x32_bf16 v[168:171], v[68:71], v[36:39], v[168:171]
    ds_read_b64_tr_b16 v[108:109], v23 offset:8192
    v_mfma_f32_16x16x32_bf16 v[172:175], v[72:75], v[36:39], v[172:175]
    ds_read_b64_tr_b16 v[110:111], v23 offset:8448
    v_mfma_f32_16x16x32_bf16 v[176:179], v[48:51], v[40:43], v[176:179]
    ds_read_b64_tr_b16 v[112:113], v26 offset:8192
    v_mfma_f32_16x16x32_bf16 v[180:183], v[52:55], v[40:43], v[180:183]
    ds_read_b64_tr_b16 v[114:115], v26 offset:8448
    v_mfma_f32_16x16x32_bf16 v[184:187], v[56:59], v[40:43], v[184:187]
    ds_read_b64_tr_b16 v[116:117], v29 offset:0
    v_mfma_f32_16x16x32_bf16 v[188:191], v[60:63], v[40:43], v[188:191]
    ds_read_b64_tr_b16 v[118:119], v29 offset:256
    v_mfma_f32_16x16x32_bf16 v[192:195], v[64:67], v[40:43], v[192:195]
    v_mfma_f32_16x16x32_bf16 v[196:199], v[68:71], v[40:43], v[196:199]
    v_mfma_f32_16x16x32_bf16 v[200:203], v[72:75], v[40:43], v[200:203]
    v_mfma_f32_16x16x32_bf16 v[204:207], v[48:51], v[44:47], v[204:207]
    v_mfma_f32_16x16x32_bf16 v[208:211], v[52:55], v[44:47], v[208:211]
    v_mfma_f32_16x16x32_bf16 v[212:215], v[56:59], v[44:47], v[212:215]
    v_mfma_f32_16x16x32_bf16 v[216:219], v[60:63], v[44:47], v[216:219]
    v_mfma_f32_16x16x32_bf16 v[220:223], v[64:67], v[44:47], v[220:223]
    v_mfma_f32_16x16x32_bf16 v[224:227], v[68:71], v[44:47], v[224:227]
    v_mfma_f32_16x16x32_bf16 v[228:231], v[72:75], v[44:47], v[228:231]
    s_waitcnt lgkmcnt(0)
    s_barrier
    v_mfma_f32_16x16x32_bf16 v[120:123], v[92:95], v[76:79], v[120:123]
    ds_read_b128 v[32:35], v21 offset:0
    v_mfma_f32_16x16x32_bf16 v[124:127], v[96:99], v[76:79], v[124:127]
    ds_read_b64_tr_b16 v[48:49], v24 offset:0
    v_mfma_f32_16x16x32_bf16 v[128:131], v[100:103], v[76:79], v[128:131]
    ds_read_b64_tr_b16 v[50:51], v24 offset:256
    v_mfma_f32_16x16x32_bf16 v[132:135], v[104:107], v[76:79], v[132:135]
    ds_read_b128 v[36:39], v21 offset:256
    v_mfma_f32_16x16x32_bf16 v[136:139], v[108:111], v[76:79], v[136:139]
    ds_read_b64_tr_b16 v[52:53], v27 offset:0
    v_mfma_f32_16x16x32_bf16 v[140:143], v[112:115], v[76:79], v[140:143]
    ds_read_b64_tr_b16 v[54:55], v27 offset:256
    v_mfma_f32_16x16x32_bf16 v[144:147], v[116:119], v[76:79], v[144:147]
    ds_read_b128 v[40:43], v21 offset:512
    v_mfma_f32_16x16x32_bf16 v[148:151], v[92:95], v[80:83], v[148:151]
    ds_read_b64_tr_b16 v[56:57], v24 offset:4096
    v_mfma_f32_16x16x32_bf16 v[152:155], v[96:99], v[80:83], v[152:155]
    ds_read_b64_tr_b16 v[58:59], v24 offset:4352
    v_mfma_f32_16x16x32_bf16 v[156:159], v[100:103], v[80:83], v[156:159]
    ds_read_b128 v[44:47], v21 offset:768
    v_mfma_f32_16x16x32_bf16 v[160:163], v[104:107], v[80:83], v[160:163]
    ds_read_b64_tr_b16 v[60:61], v27 offset:4096
    v_mfma_f32_16x16x32_bf16 v[164:167], v[108:111], v[80:83], v[164:167]
    ds_read_b64_tr_b16 v[62:63], v27 offset:4352
    v_mfma_f32_16x16x32_bf16 v[168:171], v[112:115], v[80:83], v[168:171]
    ds_read_b64_tr_b16 v[64:65], v24 offset:8192
    v_mfma_f32_16x16x32_bf16 v[172:175], v[116:119], v[80:83], v[172:175]
    ds_read_b64_tr_b16 v[66:67], v24 offset:8448
    v_mfma_f32_16x16x32_bf16 v[176:179], v[92:95], v[84:87], v[176:179]
    ds_read_b64_tr_b16 v[68:69], v27 offset:8192
    v_mfma_f32_16x16x32_bf16 v[180:183], v[96:99], v[84:87], v[180:183]
    ds_read_b64_tr_b16 v[70:71], v27 offset:8448
    v_mfma_f32_16x16x32_bf16 v[184:187], v[100:103], v[84:87], v[184:187]
    ds_read_b64_tr_b16 v[72:73], v30 offset:0
    v_mfma_f32_16x16x32_bf16 v[188:191], v[104:107], v[84:87], v[188:191]
    ds_read_b64_tr_b16 v[74:75], v30 offset:256
    v_mfma_f32_16x16x32_bf16 v[192:195], v[108:111], v[84:87], v[192:195]
    v_mfma_f32_16x16x32_bf16 v[196:199], v[112:115], v[84:87], v[196:199]
    v_mfma_f32_16x16x32_bf16 v[200:203], v[116:119], v[84:87], v[200:203]
    v_mfma_f32_16x16x32_bf16 v[204:207], v[92:95], v[88:91], v[204:207]
    v_mfma_f32_16x16x32_bf16 v[208:211], v[96:99], v[88:91], v[208:211]
    v_mfma_f32_16x16x32_bf16 v[212:215], v[100:103], v[88:91], v[212:215]
    v_mfma_f32_16x16x32_bf16 v[216:219], v[104:107], v[88:91], v[216:219]
    v_mfma_f32_16x16x32_bf16 v[220:223], v[108:111], v[88:91], v[220:223]
    v_mfma_f32_16x16x32_bf16 v[224:227], v[112:115], v[88:91], v[224:227]
    v_mfma_f32_16x16x32_bf16 v[228:231], v[116:119], v[88:91], v[228:231]
    s_waitcnt lgkmcnt(0)
    s_barrier
    v_mfma_f32_16x16x32_bf16 v[120:123], v[48:51], v[32:35], v[120:123]
    ds_read_b128 v[76:79], v22 offset:0
    v_mfma_f32_16x16x32_bf16 v[124:127], v[52:55], v[32:35], v[124:127]
    ds_read_b64_tr_b16 v[92:93], v25 offset:0
    v_mfma_f32_16x16x32_bf16 v[128:131], v[56:59], v[32:35], v[128:131]
    ds_read_b64_tr_b16 v[94:95], v25 offset:256
    v_mfma_f32_16x16x32_bf16 v[132:135], v[60:63], v[32:35], v[132:135]
    ds_read_b128 v[80:83], v22 offset:256
    v_mfma_f32_16x16x32_bf16 v[136:139], v[64:67], v[32:35], v[136:139]
    ds_read_b64_tr_b16 v[96:97], v28 offset:0
    v_mfma_f32_16x16x32_bf16 v[140:143], v[68:71], v[32:35], v[140:143]
    ds_read_b64_tr_b16 v[98:99], v28 offset:256
    v_mfma_f32_16x16x32_bf16 v[144:147], v[72:75], v[32:35], v[144:147]
    ds_read_b128 v[84:87], v22 offset:512
    v_mfma_f32_16x16x32_bf16 v[148:151], v[48:51], v[36:39], v[148:151]
    ds_read_b64_tr_b16 v[100:101], v25 offset:4096
    v_mfma_f32_16x16x32_bf16 v[152:155], v[52:55], v[36:39], v[152:155]
    ds_read_b64_tr_b16 v[102:103], v25 offset:4352
    v_mfma_f32_16x16x32_bf16 v[156:159], v[56:59], v[36:39], v[156:159]
    ds_read_b128 v[88:91], v22 offset:768
    v_mfma_f32_16x16x32_bf16 v[160:163], v[60:63], v[36:39], v[160:163]
    ds_read_b64_tr_b16 v[104:105], v28 offset:4096
    v_mfma_f32_16x16x32_bf16 v[164:167], v[64:67], v[36:39], v[164:167]
    ds_read_b64_tr_b16 v[106:107], v28 offset:4352
    v_mfma_f32_16x16x32_bf16 v[168:171], v[68:71], v[36:39], v[168:171]
    ds_read_b64_tr_b16 v[108:109], v25 offset:8192
    v_mfma_f32_16x16x32_bf16 v[172:175], v[72:75], v[36:39], v[172:175]
    ds_read_b64_tr_b16 v[110:111], v25 offset:8448
    v_mfma_f32_16x16x32_bf16 v[176:179], v[48:51], v[40:43], v[176:179]
    ds_read_b64_tr_b16 v[112:113], v28 offset:8192
    v_mfma_f32_16x16x32_bf16 v[180:183], v[52:55], v[40:43], v[180:183]
    ds_read_b64_tr_b16 v[114:115], v28 offset:8448
    v_mfma_f32_16x16x32_bf16 v[184:187], v[56:59], v[40:43], v[184:187]
    ds_read_b64_tr_b16 v[116:117], v31 offset:0
    v_mfma_f32_16x16x32_bf16 v[188:191], v[60:63], v[40:43], v[188:191]
    ds_read_b64_tr_b16 v[118:119], v31 offset:256
    v_mfma_f32_16x16x32_bf16 v[192:195], v[64:67], v[40:43], v[192:195]
    v_mfma_f32_16x16x32_bf16 v[196:199], v[68:71], v[40:43], v[196:199]
    v_mfma_f32_16x16x32_bf16 v[200:203], v[72:75], v[40:43], v[200:203]
    v_mfma_f32_16x16x32_bf16 v[204:207], v[48:51], v[44:47], v[204:207]
    v_mfma_f32_16x16x32_bf16 v[208:211], v[52:55], v[44:47], v[208:211]
    v_mfma_f32_16x16x32_bf16 v[212:215], v[56:59], v[44:47], v[212:215]
    v_mfma_f32_16x16x32_bf16 v[216:219], v[60:63], v[44:47], v[216:219]
    v_mfma_f32_16x16x32_bf16 v[220:223], v[64:67], v[44:47], v[220:223]
    v_mfma_f32_16x16x32_bf16 v[224:227], v[68:71], v[44:47], v[224:227]
    v_mfma_f32_16x16x32_bf16 v[228:231], v[72:75], v[44:47], v[228:231]
    s_waitcnt lgkmcnt(0)
    s_barrier
    v_mfma_f32_16x16x32_bf16 v[120:123], v[92:95], v[76:79], v[120:123]
    ds_read_b128 v[32:35], v20 offset:0
    v_mfma_f32_16x16x32_bf16 v[124:127], v[96:99], v[76:79], v[124:127]
    ds_read_b64_tr_b16 v[48:49], v23 offset:0
    v_mfma_f32_16x16x32_bf16 v[128:131], v[100:103], v[76:79], v[128:131]
    ds_read_b64_tr_b16 v[50:51], v23 offset:256
    v_mfma_f32_16x16x32_bf16 v[132:135], v[104:107], v[76:79], v[132:135]
    ds_read_b128 v[36:39], v20 offset:256
    v_mfma_f32_16x16x32_bf16 v[136:139], v[108:111], v[76:79], v[136:139]
    ds_read_b64_tr_b16 v[52:53], v26 offset:0
    v_mfma_f32_16x16x32_bf16 v[140:143], v[112:115], v[76:79], v[140:143]
    ds_read_b64_tr_b16 v[54:55], v26 offset:256
    v_mfma_f32_16x16x32_bf16 v[144:147], v[116:119], v[76:79], v[144:147]
    ds_read_b128 v[40:43], v20 offset:512
    v_mfma_f32_16x16x32_bf16 v[148:151], v[92:95], v[80:83], v[148:151]
    ds_read_b64_tr_b16 v[56:57], v23 offset:4096
    v_mfma_f32_16x16x32_bf16 v[152:155], v[96:99], v[80:83], v[152:155]
    ds_read_b64_tr_b16 v[58:59], v23 offset:4352
    v_mfma_f32_16x16x32_bf16 v[156:159], v[100:103], v[80:83], v[156:159]
    ds_read_b128 v[44:47], v20 offset:768
    v_mfma_f32_16x16x32_bf16 v[160:163], v[104:107], v[80:83], v[160:163]
    ds_read_b64_tr_b16 v[60:61], v26 offset:4096
    v_mfma_f32_16x16x32_bf16 v[164:167], v[108:111], v[80:83], v[164:167]
    ds_read_b64_tr_b16 v[62:63], v26 offset:4352
    v_mfma_f32_16x16x32_bf16 v[168:171], v[112:115], v[80:83], v[168:171]
    ds_read_b64_tr_b16 v[64:65], v23 offset:8192
    v_mfma_f32_16x16x32_bf16 v[172:175], v[116:119], v[80:83], v[172:175]
    ds_read_b64_tr_b16 v[66:67], v23 offset:8448
    v_mfma_f32_16x16x32_bf16 v[176:179], v[92:95], v[84:87], v[176:179]
    ds_read_b64_tr_b16 v[68:69], v26 offset:8192
    v_mfma_f32_16x16x32_bf16 v[180:183], v[96:99], v[84:87], v[180:183]
    ds_read_b64_tr_b16 v[70:71], v26 offset:8448
    v_mfma_f32_16x16x32_bf16 v[184:187], v[100:103], v[84:87], v[184:187]
    ds_read_b64_tr_b16 v[72:73], v29 offset:0
    v_mfma_f32_16x16x32_bf16 v[188:191], v[104:107], v[84:87], v[188:191]
    ds_read_b64_tr_b16 v[74:75], v29 offset:256
    v_mfma_f32_16x16x32_bf16 v[192:195], v[108:111], v[84:87], v[192:195]
    v_mfma_f32_16x16x32_bf16 v[196:199], v[112:115], v[84:87], v[196:199]
    v_mfma_f32_16x16x32_bf16 v[200:203], v[116:119], v[84:87], v[200:203]
    v_mfma_f32_16x16x32_bf16 v[204:207], v[92:95], v[88:91], v[204:207]
    v_mfma_f32_16x16x32_bf16 v[208:211], v[96:99], v[88:91], v[208:211]
    v_mfma_f32_16x16x32_bf16 v[212:215], v[100:103], v[88:91], v[212:215]
    v_mfma_f32_16x16x32_bf16 v[216:219], v[104:107], v[88:91], v[216:219]
    v_mfma_f32_16x16x32_bf16 v[220:223], v[108:111], v[88:91], v[220:223]
    v_mfma_f32_16x16x32_bf16 v[224:227], v[112:115], v[88:91], v[224:227]
    v_mfma_f32_16x16x32_bf16 v[228:231], v[116:119], v[88:91], v[228:231]
    s_waitcnt lgkmcnt(0)
    s_barrier
    v_mfma_f32_16x16x32_bf16 v[120:123], v[48:51], v[32:35], v[120:123]
    ds_read_b128 v[76:79], v21 offset:0
    v_mfma_f32_16x16x32_bf16 v[124:127], v[52:55], v[32:35], v[124:127]
    ds_read_b64_tr_b16 v[92:93], v24 offset:0
    v_mfma_f32_16x16x32_bf16 v[128:131], v[56:59], v[32:35], v[128:131]
    ds_read_b64_tr_b16 v[94:95], v24 offset:256
    v_mfma_f32_16x16x32_bf16 v[132:135], v[60:63], v[32:35], v[132:135]
    ds_read_b128 v[80:83], v21 offset:256
    v_mfma_f32_16x16x32_bf16 v[136:139], v[64:67], v[32:35], v[136:139]
    ds_read_b64_tr_b16 v[96:97], v27 offset:0
    v_mfma_f32_16x16x32_bf16 v[140:143], v[68:71], v[32:35], v[140:143]
    ds_read_b64_tr_b16 v[98:99], v27 offset:256
    v_mfma_f32_16x16x32_bf16 v[144:147], v[72:75], v[32:35], v[144:147]
    ds_read_b128 v[84:87], v21 offset:512
    v_mfma_f32_16x16x32_bf16 v[148:151], v[48:51], v[36:39], v[148:151]
    ds_read_b64_tr_b16 v[100:101], v24 offset:4096
    v_mfma_f32_16x16x32_bf16 v[152:155], v[52:55], v[36:39], v[152:155]
    ds_read_b64_tr_b16 v[102:103], v24 offset:4352
    v_mfma_f32_16x16x32_bf16 v[156:159], v[56:59], v[36:39], v[156:159]
    ds_read_b128 v[88:91], v21 offset:768
    v_mfma_f32_16x16x32_bf16 v[160:163], v[60:63], v[36:39], v[160:163]
    ds_read_b64_tr_b16 v[104:105], v27 offset:4096
    v_mfma_f32_16x16x32_bf16 v[164:167], v[64:67], v[36:39], v[164:167]
    ds_read_b64_tr_b16 v[106:107], v27 offset:4352
    v_mfma_f32_16x16x32_bf16 v[168:171], v[68:71], v[36:39], v[168:171]
    ds_read_b64_tr_b16 v[108:109], v24 offset:8192
    v_mfma_f32_16x16x32_bf16 v[172:175], v[72:75], v[36:39], v[172:175]
    ds_read_b64_tr_b16 v[110:111], v24 offset:8448
    v_mfma_f32_16x16x32_bf16 v[176:179], v[48:51], v[40:43], v[176:179]
    ds_read_b64_tr_b16 v[112:113], v27 offset:8192
    v_mfma_f32_16x16x32_bf16 v[180:183], v[52:55], v[40:43], v[180:183]
    ds_read_b64_tr_b16 v[114:115], v27 offset:8448
    v_mfma_f32_16x16x32_bf16 v[184:187], v[56:59], v[40:43], v[184:187]
    ds_read_b64_tr_b16 v[116:117], v30 offset:0
    v_mfma_f32_16x16x32_bf16 v[188:191], v[60:63], v[40:43], v[188:191]
    ds_read_b64_tr_b16 v[118:119], v30 offset:256
    v_mfma_f32_16x16x32_bf16 v[192:195], v[64:67], v[40:43], v[192:195]
    v_mfma_f32_16x16x32_bf16 v[196:199], v[68:71], v[40:43], v[196:199]
    v_mfma_f32_16x16x32_bf16 v[200:203], v[72:75], v[40:43], v[200:203]
    v_mfma_f32_16x16x32_bf16 v[204:207], v[48:51], v[44:47], v[204:207]
    v_mfma_f32_16x16x32_bf16 v[208:211], v[52:55], v[44:47], v[208:211]
    v_mfma_f32_16x16x32_bf16 v[212:215], v[56:59], v[44:47], v[212:215]
    v_mfma_f32_16x16x32_bf16 v[216:219], v[60:63], v[44:47], v[216:219]
    v_mfma_f32_16x16x32_bf16 v[220:223], v[64:67], v[44:47], v[220:223]
    v_mfma_f32_16x16x32_bf16 v[224:227], v[68:71], v[44:47], v[224:227]
    v_mfma_f32_16x16x32_bf16 v[228:231], v[72:75], v[44:47], v[228:231]
    s_waitcnt lgkmcnt(0)
    v_mfma_f32_16x16x32_bf16 v[120:123], v[92:95], v[76:79], v[120:123]
    v_mfma_f32_16x16x32_bf16 v[124:127], v[96:99], v[76:79], v[124:127]
    v_mfma_f32_16x16x32_bf16 v[128:131], v[100:103], v[76:79], v[128:131]
    v_mfma_f32_16x16x32_bf16 v[132:135], v[104:107], v[76:79], v[132:135]
    v_mfma_f32_16x16x32_bf16 v[136:139], v[108:111], v[76:79], v[136:139]
    v_mfma_f32_16x16x32_bf16 v[140:143], v[112:115], v[76:79], v[140:143]
    v_mfma_f32_16x16x32_bf16 v[144:147], v[116:119], v[76:79], v[144:147]
    v_mfma_f32_16x16x32_bf16 v[148:151], v[92:95], v[80:83], v[148:151]
    v_mfma_f32_16x16x32_bf16 v[152:155], v[96:99], v[80:83], v[152:155]
    v_mfma_f32_16x16x32_bf16 v[156:159], v[100:103], v[80:83], v[156:159]
    v_mfma_f32_16x16x32_bf16 v[160:163], v[104:107], v[80:83], v[160:163]
    v_mfma_f32_16x16x32_bf16 v[164:167], v[108:111], v[80:83], v[164:167]
    v_mfma_f32_16x16x32_bf16 v[168:171], v[112:115], v[80:83], v[168:171]
    v_mfma_f32_16x16x32_bf16 v[172:175], v[116:119], v[80:83], v[172:175]
    v_mfma_f32_16x16x32_bf16 v[176:179], v[92:95], v[84:87], v[176:179]
    v_mfma_f32_16x16x32_bf16 v[180:183], v[96:99], v[84:87], v[180:183]
    v_mfma_f32_16x16x32_bf16 v[184:187], v[100:103], v[84:87], v[184:187]
    v_mfma_f32_16x16x32_bf16 v[188:191], v[104:107], v[84:87], v[188:191]
    v_mfma_f32_16x16x32_bf16 v[192:195], v[108:111], v[84:87], v[192:195]
    v_mfma_f32_16x16x32_bf16 v[196:199], v[112:115], v[84:87], v[196:199]
    v_mfma_f32_16x16x32_bf16 v[200:203], v[116:119], v[84:87], v[200:203]
    v_mfma_f32_16x16x32_bf16 v[204:207], v[92:95], v[88:91], v[204:207]
    v_mfma_f32_16x16x32_bf16 v[208:211], v[96:99], v[88:91], v[208:211]
    v_mfma_f32_16x16x32_bf16 v[212:215], v[100:103], v[88:91], v[212:215]
    v_mfma_f32_16x16x32_bf16 v[216:219], v[104:107], v[88:91], v[216:219]
    v_mfma_f32_16x16x32_bf16 v[220:223], v[108:111], v[88:91], v[220:223]
    v_mfma_f32_16x16x32_bf16 v[224:227], v[112:115], v[88:91], v[224:227]
    v_mfma_f32_16x16x32_bf16 v[228:231], v[116:119], v[88:91], v[228:231]
    s_mul_i32 s34, s29, 22
    s_cmp_ge_u32 s29, 2048
    s_cselect_b32 s35, 45056, 0
    s_add_u32 s34, s34, s35
    s_mul_i32 s35, s29, 6
    s_add_u32 s35, s35, 135168
    v_lshlrev_b32 v2, 4, v1
    v_add_u32 v7, s35, v2
    v_add_u32 v2, s34, v2
    v_and_b32 v3, 15, v1
    v_lshlrev_b32 v3, 4, v3
    v_lshl_add_u32 v3, v4, 14, v3
    s_lshl_b32 s34, s37, 11
    s_bfe_u32 s35, s28, 0x10001
    s_lshl_b32 s35, s35, 10
    s_add_u32 s34, s34, s35
    s_add_u32 s34, s34, 8388608
    v_add_u32 v3, s34, v3
    s_mul_i32 s30, s38, 7
    s_and_b32 s35, s28, 1
    s_add_u32 s33, s30, 3
    s_lshl_b32 s33, s33, 16
    s_lshl_b32 s34, s35, 3
    s_add_u32 s33, s33, s34
    s_lshl_b32 s35, s35, 2
    s_add_u32 s30, s30, s35
    s_lshl_b32 s30, s30, 16
    s_nop 4
    ds_write_b128 v2, v[120:123] offset:11264
    ds_write_b128 v2, v[124:127] offset:12288
    ds_write_b128 v2, v[128:131] offset:13312
    ds_write_b128 v2, v[132:135] offset:14336
    ds_write_b128 v2, v[136:139] offset:15360
    ds_write_b128 v2, v[140:143] offset:16384
    ds_write_b128 v2, v[144:147] offset:17408
    ds_write_b128 v2, v[148:151] offset:18432
    ds_write_b128 v2, v[152:155] offset:19456
    ds_write_b128 v2, v[156:159] offset:20480
    ds_write_b128 v2, v[160:163] offset:21504
    ds_write_b128 v7, v[164:167] offset:3072
    ds_write_b128 v7, v[168:171] offset:4096
    ds_write_b128 v7, v[172:175] offset:5120
    s_waitcnt lgkmcnt(0)
    s_barrier
    ds_read_b128 v[32:35], v2 offset:0
    ds_read_b128 v[36:39], v2 offset:1024
    ds_read_b128 v[40:43], v2 offset:2048
    ds_read_b128 v[44:47], v2 offset:3072
    ds_read_b128 v[48:51], v2 offset:4096
    ds_read_b128 v[52:55], v2 offset:5120
    ds_read_b128 v[56:59], v2 offset:6144
    ds_read_b128 v[60:63], v2 offset:7168
    ds_read_b128 v[64:67], v2 offset:8192
    ds_read_b128 v[68:71], v2 offset:9216
    ds_read_b128 v[72:75], v2 offset:10240
    ds_read_b128 v[76:79], v7 offset:0
    ds_read_b128 v[80:83], v7 offset:1024
    ds_read_b128 v[84:87], v7 offset:2048
    s_mov_b32 s32, 0xbdd2d3e8
    v_mov_b32 v6, 0xc0135761
    s_waitcnt lgkmcnt(13)
    v_pk_add_f32 v[176:177], v[176:177], v[32:33]
    v_pk_add_f32 v[178:179], v[178:179], v[34:35]
    v_pk_mul_f32 v[32:33], v[176:177], v[176:177]
    v_pk_mul_f32 v[34:35], v[178:179], v[178:179]
    v_pk_fma_f32 v[32:33], v[32:33], s[32:33], v[6:7] op_sel:[0,0,0] op_sel_hi:[1,0,0] neg_lo:[0,0,0] neg_hi:[0,0,0]
    v_pk_fma_f32 v[34:35], v[34:35], s[32:33], v[6:7] op_sel:[0,0,0] op_sel_hi:[1,0,0] neg_lo:[0,0,0] neg_hi:[0,0,0]
    v_pk_mul_f32 v[32:33], v[32:33], v[176:177]
    v_pk_mul_f32 v[34:35], v[34:35], v[178:179]
    v_exp_f32 v32, v32
    v_exp_f32 v33, v33
    v_exp_f32 v34, v34
    v_exp_f32 v35, v35
    s_nop 0
    v_pk_add_f32 v[32:33], v[32:33], 1.0 op_sel_hi:[1,0]
    v_pk_add_f32 v[34:35], v[34:35], 1.0 op_sel_hi:[1,0]
    v_rcp_f32 v32, v32
    v_rcp_f32 v33, v33
    v_rcp_f32 v34, v34
    v_rcp_f32 v35, v35
    s_nop 0
    v_pk_mul_f32 v[176:177], v[176:177], v[32:33]
    v_pk_mul_f32 v[178:179], v[178:179], v[34:35]
    v_cvt_pk_bf16_f32 v96, v176, v177
    v_cvt_pk_bf16_f32 v97, v178, v179
    s_waitcnt lgkmcnt(12)
    v_pk_add_f32 v[180:181], v[180:181], v[36:37]
    v_pk_add_f32 v[182:183], v[182:183], v[38:39]
    v_pk_mul_f32 v[36:37], v[180:181], v[180:181]
    v_pk_mul_f32 v[38:39], v[182:183], v[182:183]
    v_pk_fma_f32 v[36:37], v[36:37], s[32:33], v[6:7] op_sel:[0,0,0] op_sel_hi:[1,0,0] neg_lo:[0,0,0] neg_hi:[0,0,0]
    v_pk_fma_f32 v[38:39], v[38:39], s[32:33], v[6:7] op_sel:[0,0,0] op_sel_hi:[1,0,0] neg_lo:[0,0,0] neg_hi:[0,0,0]
    v_pk_mul_f32 v[36:37], v[36:37], v[180:181]
    v_pk_mul_f32 v[38:39], v[38:39], v[182:183]
    v_exp_f32 v36, v36
    v_exp_f32 v37, v37
    v_exp_f32 v38, v38
    v_exp_f32 v39, v39
    s_add_u32 s34, s30, 0
    v_pk_add_f32 v[36:37], v[36:37], 1.0 op_sel_hi:[1,0]
    v_pk_add_f32 v[38:39], v[38:39], 1.0 op_sel_hi:[1,0]
    v_rcp_f32 v36, v36
    v_rcp_f32 v37, v37
    v_rcp_f32 v38, v38
    v_rcp_f32 v39, v39
    s_nop 0
    v_pk_mul_f32 v[180:181], v[180:181], v[36:37]
    v_pk_mul_f32 v[182:183], v[182:183], v[38:39]
    v_cvt_pk_bf16_f32 v98, v180, v181
    v_cvt_pk_bf16_f32 v99, v182, v183
    buffer_store_dwordx4 v[96:99], v3, s[16:19], s34 offen offset:512 sc1
    s_waitcnt lgkmcnt(11)
    v_pk_add_f32 v[184:185], v[184:185], v[40:41]
    v_pk_add_f32 v[186:187], v[186:187], v[42:43]
    v_pk_mul_f32 v[40:41], v[184:185], v[184:185]
    v_pk_mul_f32 v[42:43], v[186:187], v[186:187]
    v_pk_fma_f32 v[40:41], v[40:41], s[32:33], v[6:7] op_sel:[0,0,0] op_sel_hi:[1,0,0] neg_lo:[0,0,0] neg_hi:[0,0,0]
    v_pk_fma_f32 v[42:43], v[42:43], s[32:33], v[6:7] op_sel:[0,0,0] op_sel_hi:[1,0,0] neg_lo:[0,0,0] neg_hi:[0,0,0]
    v_pk_mul_f32 v[40:41], v[40:41], v[184:185]
    v_pk_mul_f32 v[42:43], v[42:43], v[186:187]
    v_exp_f32 v40, v40
    v_exp_f32 v41, v41
    v_exp_f32 v42, v42
    v_exp_f32 v43, v43
    s_nop 0
    v_pk_add_f32 v[40:41], v[40:41], 1.0 op_sel_hi:[1,0]
    v_pk_add_f32 v[42:43], v[42:43], 1.0 op_sel_hi:[1,0]
    v_rcp_f32 v40, v40
    v_rcp_f32 v41, v41
    v_rcp_f32 v42, v42
    v_rcp_f32 v43, v43
    s_nop 0
    v_pk_mul_f32 v[184:185], v[184:185], v[40:41]
    v_pk_mul_f32 v[186:187], v[186:187], v[42:43]
    v_cvt_pk_bf16_f32 v100, v184, v185
    v_cvt_pk_bf16_f32 v101, v186, v187
    s_waitcnt lgkmcnt(10)
    v_pk_add_f32 v[188:189], v[188:189], v[44:45]
    v_pk_add_f32 v[190:191], v[190:191], v[46:47]
    v_pk_mul_f32 v[44:45], v[188:189], v[188:189]
    v_pk_mul_f32 v[46:47], v[190:191], v[190:191]
    v_pk_fma_f32 v[44:45], v[44:45], s[32:33], v[6:7] op_sel:[0,0,0] op_sel_hi:[1,0,0] neg_lo:[0,0,0] neg_hi:[0,0,0]
    v_pk_fma_f32 v[46:47], v[46:47], s[32:33], v[6:7] op_sel:[0,0,0] op_sel_hi:[1,0,0] neg_lo:[0,0,0] neg_hi:[0,0,0]
    v_pk_mul_f32 v[44:45], v[44:45], v[188:189]
    v_pk_mul_f32 v[46:47], v[46:47], v[190:191]
    v_exp_f32 v44, v44
    v_exp_f32 v45, v45
    v_exp_f32 v46, v46
    v_exp_f32 v47, v47
    s_add_u32 s34, s30, 65536
    v_pk_add_f32 v[44:45], v[44:45], 1.0 op_sel_hi:[1,0]
    v_pk_add_f32 v[46:47], v[46:47], 1.0 op_sel_hi:[1,0]
    v_rcp_f32 v44, v44
    v_rcp_f32 v45, v45
    v_rcp_f32 v46, v46
    v_rcp_f32 v47, v47
    s_nop 0
    v_pk_mul_f32 v[188:189], v[188:189], v[44:45]
    v_pk_mul_f32 v[190:191], v[190:191], v[46:47]
    v_cvt_pk_bf16_f32 v102, v188, v189
    v_cvt_pk_bf16_f32 v103, v190, v191
    buffer_store_dwordx4 v[100:103], v3, s[16:19], s34 offen offset:512 sc1
    s_waitcnt lgkmcnt(9)
    v_pk_add_f32 v[192:193], v[192:193], v[48:49]
    v_pk_add_f32 v[194:195], v[194:195], v[50:51]
    v_pk_mul_f32 v[48:49], v[192:193], v[192:193]
    v_pk_mul_f32 v[50:51], v[194:195], v[194:195]
    v_pk_fma_f32 v[48:49], v[48:49], s[32:33], v[6:7] op_sel:[0,0,0] op_sel_hi:[1,0,0] neg_lo:[0,0,0] neg_hi:[0,0,0]
    v_pk_fma_f32 v[50:51], v[50:51], s[32:33], v[6:7] op_sel:[0,0,0] op_sel_hi:[1,0,0] neg_lo:[0,0,0] neg_hi:[0,0,0]
    v_pk_mul_f32 v[48:49], v[48:49], v[192:193]
    v_pk_mul_f32 v[50:51], v[50:51], v[194:195]
    v_exp_f32 v48, v48
    v_exp_f32 v49, v49
    v_exp_f32 v50, v50
    v_exp_f32 v51, v51
    s_nop 0
    v_pk_add_f32 v[48:49], v[48:49], 1.0 op_sel_hi:[1,0]
    v_pk_add_f32 v[50:51], v[50:51], 1.0 op_sel_hi:[1,0]
    v_rcp_f32 v48, v48
    v_rcp_f32 v49, v49
    v_rcp_f32 v50, v50
    v_rcp_f32 v51, v51
    s_nop 0
    v_pk_mul_f32 v[192:193], v[192:193], v[48:49]
    v_pk_mul_f32 v[194:195], v[194:195], v[50:51]
    v_cvt_pk_bf16_f32 v104, v192, v193
    v_cvt_pk_bf16_f32 v105, v194, v195
    s_waitcnt lgkmcnt(8)
    v_pk_add_f32 v[196:197], v[196:197], v[52:53]
    v_pk_add_f32 v[198:199], v[198:199], v[54:55]
    v_pk_mul_f32 v[52:53], v[196:197], v[196:197]
    v_pk_mul_f32 v[54:55], v[198:199], v[198:199]
    v_pk_fma_f32 v[52:53], v[52:53], s[32:33], v[6:7] op_sel:[0,0,0] op_sel_hi:[1,0,0] neg_lo:[0,0,0] neg_hi:[0,0,0]
    v_pk_fma_f32 v[54:55], v[54:55], s[32:33], v[6:7] op_sel:[0,0,0] op_sel_hi:[1,0,0] neg_lo:[0,0,0] neg_hi:[0,0,0]
    v_pk_mul_f32 v[52:53], v[52:53], v[196:197]
    v_pk_mul_f32 v[54:55], v[54:55], v[198:199]
    v_exp_f32 v52, v52
    v_exp_f32 v53, v53
    v_exp_f32 v54, v54
    v_exp_f32 v55, v55
    s_add_u32 s34, s30, 131072
    v_pk_add_f32 v[52:53], v[52:53], 1.0 op_sel_hi:[1,0]
    v_pk_add_f32 v[54:55], v[54:55], 1.0 op_sel_hi:[1,0]
    v_rcp_f32 v52, v52
    v_rcp_f32 v53, v53
    v_rcp_f32 v54, v54
    v_rcp_f32 v55, v55
    s_nop 0
    v_pk_mul_f32 v[196:197], v[196:197], v[52:53]
    v_pk_mul_f32 v[198:199], v[198:199], v[54:55]
    v_cvt_pk_bf16_f32 v106, v196, v197
    v_cvt_pk_bf16_f32 v107, v198, v199
    buffer_store_dwordx4 v[104:107], v3, s[16:19], s34 offen offset:512 sc1
    s_waitcnt lgkmcnt(7)
    v_pk_add_f32 v[200:201], v[200:201], v[56:57]
    v_pk_add_f32 v[202:203], v[202:203], v[58:59]
    v_pk_mul_f32 v[56:57], v[200:201], v[200:201]
    v_pk_mul_f32 v[58:59], v[202:203], v[202:203]
    v_pk_fma_f32 v[56:57], v[56:57], s[32:33], v[6:7] op_sel:[0,0,0] op_sel_hi:[1,0,0] neg_lo:[0,0,0] neg_hi:[0,0,0]
    v_pk_fma_f32 v[58:59], v[58:59], s[32:33], v[6:7] op_sel:[0,0,0] op_sel_hi:[1,0,0] neg_lo:[0,0,0] neg_hi:[0,0,0]
    v_pk_mul_f32 v[56:57], v[56:57], v[200:201]
    v_pk_mul_f32 v[58:59], v[58:59], v[202:203]
    v_exp_f32 v56, v56
    v_exp_f32 v57, v57
    v_exp_f32 v58, v58
    v_exp_f32 v59, v59
    s_nop 0
    v_pk_add_f32 v[56:57], v[56:57], 1.0 op_sel_hi:[1,0]
    v_pk_add_f32 v[58:59], v[58:59], 1.0 op_sel_hi:[1,0]
    v_rcp_f32 v56, v56
    v_rcp_f32 v57, v57
    v_rcp_f32 v58, v58
    v_rcp_f32 v59, v59
    s_nop 0
    v_pk_mul_f32 v[200:201], v[200:201], v[56:57]
    v_pk_mul_f32 v[202:203], v[202:203], v[58:59]
    v_cvt_pk_bf16_f32 v108, v200, v201
    v_cvt_pk_bf16_f32 v109, v202, v203
    buffer_store_dwordx2 v[108:109], v3, s[16:19], s33 offen offset:512 sc1
    s_waitcnt lgkmcnt(6)
    v_pk_add_f32 v[204:205], v[204:205], v[60:61]
    v_pk_add_f32 v[206:207], v[206:207], v[62:63]
    v_pk_mul_f32 v[60:61], v[204:205], v[204:205]
    v_pk_mul_f32 v[62:63], v[206:207], v[206:207]
    v_pk_fma_f32 v[60:61], v[60:61], s[32:33], v[6:7] op_sel:[0,0,0] op_sel_hi:[1,0,0] neg_lo:[0,0,0] neg_hi:[0,0,0]
    v_pk_fma_f32 v[62:63], v[62:63], s[32:33], v[6:7] op_sel:[0,0,0] op_sel_hi:[1,0,0] neg_lo:[0,0,0] neg_hi:[0,0,0]
    v_pk_mul_f32 v[60:61], v[60:61], v[204:205]
    v_pk_mul_f32 v[62:63], v[62:63], v[206:207]
    v_exp_f32 v60, v60
    v_exp_f32 v61, v61
    v_exp_f32 v62, v62
    v_exp_f32 v63, v63
    s_nop 0
    v_pk_add_f32 v[60:61], v[60:61], 1.0 op_sel_hi:[1,0]
    v_pk_add_f32 v[62:63], v[62:63], 1.0 op_sel_hi:[1,0]
    v_rcp_f32 v60, v60
    v_rcp_f32 v61, v61
    v_rcp_f32 v62, v62
    v_rcp_f32 v63, v63
    s_nop 0
    v_pk_mul_f32 v[204:205], v[204:205], v[60:61]
    v_pk_mul_f32 v[206:207], v[206:207], v[62:63]
    v_cvt_pk_bf16_f32 v96, v204, v205
    v_cvt_pk_bf16_f32 v97, v206, v207
    s_waitcnt lgkmcnt(5)
    v_pk_add_f32 v[208:209], v[208:209], v[64:65]
    v_pk_add_f32 v[210:211], v[210:211], v[66:67]
    v_pk_mul_f32 v[64:65], v[208:209], v[208:209]
    v_pk_mul_f32 v[66:67], v[210:211], v[210:211]
    v_pk_fma_f32 v[64:65], v[64:65], s[32:33], v[6:7] op_sel:[0,0,0] op_sel_hi:[1,0,0] neg_lo:[0,0,0] neg_hi:[0,0,0]
    v_pk_fma_f32 v[66:67], v[66:67], s[32:33], v[6:7] op_sel:[0,0,0] op_sel_hi:[1,0,0] neg_lo:[0,0,0] neg_hi:[0,0,0]
    v_pk_mul_f32 v[64:65], v[64:65], v[208:209]
    v_pk_mul_f32 v[66:67], v[66:67], v[210:211]
    v_exp_f32 v64, v64
    v_exp_f32 v65, v65
    v_exp_f32 v66, v66
    v_exp_f32 v67, v67
    s_add_u32 s34, s30, 0
    v_pk_add_f32 v[64:65], v[64:65], 1.0 op_sel_hi:[1,0]
    v_pk_add_f32 v[66:67], v[66:67], 1.0 op_sel_hi:[1,0]
    v_rcp_f32 v64, v64
    v_rcp_f32 v65, v65
    v_rcp_f32 v66, v66
    v_rcp_f32 v67, v67
    s_nop 0
    v_pk_mul_f32 v[208:209], v[208:209], v[64:65]
    v_pk_mul_f32 v[210:211], v[210:211], v[66:67]
    v_cvt_pk_bf16_f32 v98, v208, v209
    v_cvt_pk_bf16_f32 v99, v210, v211
    buffer_store_dwordx4 v[96:99], v3, s[16:19], s34 offen offset:768 sc1
    s_waitcnt lgkmcnt(4)
    v_pk_add_f32 v[212:213], v[212:213], v[68:69]
    v_pk_add_f32 v[214:215], v[214:215], v[70:71]
    v_pk_mul_f32 v[68:69], v[212:213], v[212:213]
    v_pk_mul_f32 v[70:71], v[214:215], v[214:215]
    v_pk_fma_f32 v[68:69], v[68:69], s[32:33], v[6:7] op_sel:[0,0,0] op_sel_hi:[1,0,0] neg_lo:[0,0,0] neg_hi:[0,0,0]
    v_pk_fma_f32 v[70:71], v[70:71], s[32:33], v[6:7] op_sel:[0,0,0] op_sel_hi:[1,0,0] neg_lo:[0,0,0] neg_hi:[0,0,0]
    v_pk_mul_f32 v[68:69], v[68:69], v[212:213]
    v_pk_mul_f32 v[70:71], v[70:71], v[214:215]
    v_exp_f32 v68, v68
    v_exp_f32 v69, v69
    v_exp_f32 v70, v70
    v_exp_f32 v71, v71
    s_nop 0
    v_pk_add_f32 v[68:69], v[68:69], 1.0 op_sel_hi:[1,0]
    v_pk_add_f32 v[70:71], v[70:71], 1.0 op_sel_hi:[1,0]
    v_rcp_f32 v68, v68
    v_rcp_f32 v69, v69
    v_rcp_f32 v70, v70
    v_rcp_f32 v71, v71
    s_nop 0
    v_pk_mul_f32 v[212:213], v[212:213], v[68:69]
    v_pk_mul_f32 v[214:215], v[214:215], v[70:71]
    v_cvt_pk_bf16_f32 v100, v212, v213
    v_cvt_pk_bf16_f32 v101, v214, v215
    s_waitcnt lgkmcnt(3)
    v_pk_add_f32 v[216:217], v[216:217], v[72:73]
    v_pk_add_f32 v[218:219], v[218:219], v[74:75]
    v_pk_mul_f32 v[72:73], v[216:217], v[216:217]
    v_pk_mul_f32 v[74:75], v[218:219], v[218:219]
    v_pk_fma_f32 v[72:73], v[72:73], s[32:33], v[6:7] op_sel:[0,0,0] op_sel_hi:[1,0,0] neg_lo:[0,0,0] neg_hi:[0,0,0]
    v_pk_fma_f32 v[74:75], v[74:75], s[32:33], v[6:7] op_sel:[0,0,0] op_sel_hi:[1,0,0] neg_lo:[0,0,0] neg_hi:[0,0,0]
    v_pk_mul_f32 v[72:73], v[72:73], v[216:217]
    v_pk_mul_f32 v[74:75], v[74:75], v[218:219]
    v_exp_f32 v72, v72
    v_exp_f32 v73, v73
    v_exp_f32 v74, v74
    v_exp_f32 v75, v75
    s_add_u32 s34, s30, 65536
    v_pk_add_f32 v[72:73], v[72:73], 1.0 op_sel_hi:[1,0]
    v_pk_add_f32 v[74:75], v[74:75], 1.0 op_sel_hi:[1,0]
    v_rcp_f32 v72, v72
    v_rcp_f32 v73, v73
    v_rcp_f32 v74, v74
    v_rcp_f32 v75, v75
    s_nop 0
    v_pk_mul_f32 v[216:217], v[216:217], v[72:73]
    v_pk_mul_f32 v[218:219], v[218:219], v[74:75]
    v_cvt_pk_bf16_f32 v102, v216, v217
    v_cvt_pk_bf16_f32 v103, v218, v219
    buffer_store_dwordx4 v[100:103], v3, s[16:19], s34 offen offset:768 sc1
    s_waitcnt lgkmcnt(2)
    v_pk_add_f32 v[220:221], v[220:221], v[76:77]
    v_pk_add_f32 v[222:223], v[222:223], v[78:79]
    v_pk_mul_f32 v[76:77], v[220:221], v[220:221]
    v_pk_mul_f32 v[78:79], v[222:223], v[222:223]
    v_pk_fma_f32 v[76:77], v[76:77], s[32:33], v[6:7] op_sel:[0,0,0] op_sel_hi:[1,0,0] neg_lo:[0,0,0] neg_hi:[0,0,0]
    v_pk_fma_f32 v[78:79], v[78:79], s[32:33], v[6:7] op_sel:[0,0,0] op_sel_hi:[1,0,0] neg_lo:[0,0,0] neg_hi:[0,0,0]
    v_pk_mul_f32 v[76:77], v[76:77], v[220:221]
    v_pk_mul_f32 v[78:79], v[78:79], v[222:223]
    v_exp_f32 v76, v76
    v_exp_f32 v77, v77
    v_exp_f32 v78, v78
    v_exp_f32 v79, v79
    s_nop 0
    v_pk_add_f32 v[76:77], v[76:77], 1.0 op_sel_hi:[1,0]
    v_pk_add_f32 v[78:79], v[78:79], 1.0 op_sel_hi:[1,0]
    v_rcp_f32 v76, v76
    v_rcp_f32 v77, v77
    v_rcp_f32 v78, v78
    v_rcp_f32 v79, v79
    s_nop 0
    v_pk_mul_f32 v[220:221], v[220:221], v[76:77]
    v_pk_mul_f32 v[222:223], v[222:223], v[78:79]
    v_cvt_pk_bf16_f32 v104, v220, v221
    v_cvt_pk_bf16_f32 v105, v222, v223
    s_waitcnt lgkmcnt(1)
    v_pk_add_f32 v[224:225], v[224:225], v[80:81]
    v_pk_add_f32 v[226:227], v[226:227], v[82:83]
    v_pk_mul_f32 v[80:81], v[224:225], v[224:225]
    v_pk_mul_f32 v[82:83], v[226:227], v[226:227]
    v_pk_fma_f32 v[80:81], v[80:81], s[32:33], v[6:7] op_sel:[0,0,0] op_sel_hi:[1,0,0] neg_lo:[0,0,0] neg_hi:[0,0,0]
    v_pk_fma_f32 v[82:83], v[82:83], s[32:33], v[6:7] op_sel:[0,0,0] op_sel_hi:[1,0,0] neg_lo:[0,0,0] neg_hi:[0,0,0]
    v_pk_mul_f32 v[80:81], v[80:81], v[224:225]
    v_pk_mul_f32 v[82:83], v[82:83], v[226:227]
    v_exp_f32 v80, v80
    v_exp_f32 v81, v81
    v_exp_f32 v82, v82
    v_exp_f32 v83, v83
    s_add_u32 s34, s30, 131072
    v_pk_add_f32 v[80:81], v[80:81], 1.0 op_sel_hi:[1,0]
    v_pk_add_f32 v[82:83], v[82:83], 1.0 op_sel_hi:[1,0]
    v_rcp_f32 v80, v80
    v_rcp_f32 v81, v81
    v_rcp_f32 v82, v82
    v_rcp_f32 v83, v83
    s_nop 0
    v_pk_mul_f32 v[224:225], v[224:225], v[80:81]
    v_pk_mul_f32 v[226:227], v[226:227], v[82:83]
    v_cvt_pk_bf16_f32 v106, v224, v225
    v_cvt_pk_bf16_f32 v107, v226, v227
    buffer_store_dwordx4 v[104:107], v3, s[16:19], s34 offen offset:768 sc1
    s_waitcnt lgkmcnt(0)
    v_pk_add_f32 v[228:229], v[228:229], v[84:85]
    v_pk_add_f32 v[230:231], v[230:231], v[86:87]
    v_pk_mul_f32 v[84:85], v[228:229], v[228:229]
    v_pk_mul_f32 v[86:87], v[230:231], v[230:231]
    v_pk_fma_f32 v[84:85], v[84:85], s[32:33], v[6:7] op_sel:[0,0,0] op_sel_hi:[1,0,0] neg_lo:[0,0,0] neg_hi:[0,0,0]
    v_pk_fma_f32 v[86:87], v[86:87], s[32:33], v[6:7] op_sel:[0,0,0] op_sel_hi:[1,0,0] neg_lo:[0,0,0] neg_hi:[0,0,0]
    v_pk_mul_f32 v[84:85], v[84:85], v[228:229]
    v_pk_mul_f32 v[86:87], v[86:87], v[230:231]
    v_exp_f32 v84, v84
    v_exp_f32 v85, v85
    v_exp_f32 v86, v86
    v_exp_f32 v87, v87
    s_nop 0
    v_pk_add_f32 v[84:85], v[84:85], 1.0 op_sel_hi:[1,0]
    v_pk_add_f32 v[86:87], v[86:87], 1.0 op_sel_hi:[1,0]
    v_rcp_f32 v84, v84
    v_rcp_f32 v85, v85
    v_rcp_f32 v86, v86
    v_rcp_f32 v87, v87
    s_nop 0
    v_pk_mul_f32 v[228:229], v[228:229], v[84:85]
    v_pk_mul_f32 v[230:231], v[230:231], v[86:87]
    v_cvt_pk_bf16_f32 v108, v228, v229
    v_cvt_pk_bf16_f32 v109, v230, v231
    buffer_store_dwordx2 v[108:109], v3, s[16:19], s33 offen offset:768 sc1
L1_fin:
    s_mov_b32 s12, s92
    s_mov_b32 s13, s93
    s_mov_b32 s14, 14680064
    s_mov_b32 s15, 0x20000
    s_mov_b32 s24, s96
    s_mov_b32 s25, s97
    s_mov_b32 s26, 2097152
    s_mov_b32 s27, 0x20000
    v_add_u32 v13, 128, v246
    v_add_u32 v14, 256, v246
    v_add_u32 v15, 384, v246
    v_add_u32 v21, 128, v247
    s_add_u32 s31, s40, s41
    s_and_b32 s59, s2, 1
    s_lshl_b32 s59, s59, 4
    s_bitcmp1_b32 s2, 7
    s_cselect_b32 s59, s43, s59
    s_mov_b32 s30, s59
    v_mov_b32 v2, 0
    v_mov_b32 v3, s51
    s_lshl_b32 s34, s42, 3
    s_lshr_b32 s34, 0xfcc99440, s34
    s_bfe_u32 s35, s34, 0x40004
    s_and_b32 s34, s34, 15
    v_add_u32 v20, s34, v1
    v_min_u32 v20, s35, v20
    v_lshl_add_u32 v20, v20, 2, s46
    s_lshl_b32 s32, s40, 3
    s_add_u32 s32, s32, s41
    s_lshl_b32 s32, s32, 7
    s_add_u32 s32, s32, 41959424
    v_and_b32 v22, 3, v1
    v_lshl_add_u32 v22, v22, 2, s32
    v_cmp_gt_u32 vcc, 32, v1
    s_lshl_b32 s33, s42, 2
    s_add_u32 s33, s33, s32
    v_and_b32 v16, 7, v1
    s_and_b32 s34, s2, 1
    s_lshl_b32 s34, s34, 5
    s_add_u32 s34, s34, s47
    v_lshl_add_u32 v16, v16, 2, s34
    s_waitcnt vmcnt(0)
    s_barrier
    s_cmp_lg_u32 s28, 0
    s_cbranch_scc1 P3_nosig
    s_mov_b64 exec, 1
    buffer_store_dword v3, v2, s[16:19], s48 offen sc1
    s_mov_b64 exec, -1
P3_nosig:
    s_mov_b32 s39, s59
    s_cmp_ge_u32 s28, 4
    s_cbranch_scc1 P3_nold0
    s_bitcmp1_b32 s2, 7
    s_cbranch_scc1 P3_wA0
    s_mov_b32 s30, s59
    s_add_u32 s34, s30, s31
    s_and_b32 s34, s34, 3
    s_andn2_b32 s35, s30, 3
    s_or_b32 s34, s34, s35
    s_mul_i32 s32, s34, 131072
    s_mul_i32 s33, s34, 65536
    s_add_u32 s30, s30, 1
    s_add_u32 m0, s29, 16384
    s_nop 0
    buffer_load_dwordx4 v247, s[24:27], s33 offen lds
    s_add_u32 m0, s29, 20480
    s_nop 0
    buffer_load_dwordx4 v21, s[24:27], s33 offen lds
    s_add_u32 s34, s30, s31
    s_and_b32 s34, s34, 3
    s_andn2_b32 s35, s30, 3
    s_or_b32 s34, s34, s35
    s_mul_i32 s32, s34, 131072
    s_mul_i32 s33, s34, 65536
    s_add_u32 s30, s30, 1
    s_add_u32 m0, s29, 40960
    s_nop 0
    buffer_load_dwordx4 v247, s[24:27], s33 offen lds
    s_add_u32 m0, s29, 45056
    s_nop 0
    buffer_load_dwordx4 v21, s[24:27], s33 offen lds
    s_add_u32 s34, s30, s31
    s_and_b32 s34, s34, 3
    s_andn2_b32 s35, s30, 3
    s_or_b32 s34, s34, s35
    s_mul_i32 s32, s34, 131072
    s_mul_i32 s33, s34, 65536
    s_add_u32 s30, s30, 1
    s_add_u32 m0, s29, 65536
    s_nop 0
    buffer_load_dwordx4 v247, s[24:27], s33 offen lds
    s_add_u32 m0, s29, 69632
    s_nop 0
    buffer_load_dwordx4 v21, s[24:27], s33 offen lds
    s_add_u32 s34, s30, s31
    s_and_b32 s34, s34, 3
    s_andn2_b32 s35, s30, 3
    s_or_b32 s34, s34, s35
    s_mul_i32 s32, s34, 131072
    s_mul_i32 s33, s34, 65536
    s_add_u32 s30, s30, 1
    s_add_u32 m0, s29, 90112
    s_nop 0
    buffer_load_dwordx4 v247, s[24:27], s33 offen lds
    s_add_u32 m0, s29, 94208
    s_nop 0
    buffer_load_dwordx4 v21, s[24:27], s33 offen lds
    s_branch P3_wd
P3_wA0:
    s_mov_b32 s30, s59
    s_add_u32 s34, s30, s31
    s_and_b32 s34, s34, 3
    s_andn2_b32 s35, s30, 3
    s_or_b32 s34, s34, s35
    s_mul_i32 s32, s34, 65536
    s_mul_i32 s33, s34, 131072
    s_add_u32 s30, s30, 1
    s_add_u32 m0, s29, 8192
    s_nop 0
    buffer_load_dwordx4 v246, s[12:15], s33 offen lds
    s_add_u32 m0, s29, 12288
    s_nop 0
    buffer_load_dwordx4 v13, s[12:15], s33 offen lds
    s_add_u32 m0, s29, 16384
    s_nop 0
    buffer_load_dwordx4 v14, s[12:15], s33 offen lds
    s_add_u32 m0, s29, 20480
    s_nop 0
    buffer_load_dwordx4 v15, s[12:15], s33 offen lds
    s_add_u32 s34, s30, s31
    s_and_b32 s34, s34, 3
    s_andn2_b32 s35, s30, 3
    s_or_b32 s34, s34, s35
    s_mul_i32 s32, s34, 65536
    s_mul_i32 s33, s34, 131072
    s_add_u32 s30, s30, 1
    s_add_u32 m0, s29, 32768
    s_nop 0
    buffer_load_dwordx4 v246, s[12:15], s33 offen lds
    s_add_u32 m0, s29, 36864
    s_nop 0
    buffer_load_dwordx4 v13, s[12:15], s33 offen lds
    s_add_u32 m0, s29, 40960
    s_nop 0
    buffer_load_dwordx4 v14, s[12:15], s33 offen lds
    s_add_u32 m0, s29, 45056
    s_nop 0
    buffer_load_dwordx4 v15, s[12:15], s33 offen lds
    s_add_u32 s34, s30, s31
    s_and_b32 s34, s34, 3
    s_andn2_b32 s35, s30, 3
    s_or_b32 s34, s34, s35
    s_mul_i32 s32, s34, 65536
    s_mul_i32 s33, s34, 131072
    s_add_u32 s30, s30, 1
    s_add_u32 m0, s29, 57344
    s_nop 0
    buffer_load_dwordx4 v246, s[12:15], s33 offen lds
    s_add_u32 m0, s29, 61440
    s_nop 0
    buffer_load_dwordx4 v13, s[12:15], s33 offen lds
    s_add_u32 m0, s29, 65536
    s_nop 0
    buffer_load_dwordx4 v14, s[12:15], s33 offen lds
    s_add_u32 m0, s29, 69632
    s_nop 0
    buffer_load_dwordx4 v15, s[12:15], s33 offen lds
    s_add_u32 s34, s30, s31
    s_and_b32 s34, s34, 3
    s_andn2_b32 s35, s30, 3
    s_or_b32 s34, s34, s35
    s_mul_i32 s32, s34, 65536
    s_mul_i32 s33, s34, 131072
    s_add_u32 s30, s30, 1
    s_add_u32 m0, s29, 81920
    s_nop 0
    buffer_load_dwordx4 v246, s[12:15], s33 offen lds
    s_add_u32 m0, s29, 86016
    s_nop 0
    buffer_load_dwordx4 v13, s[12:15], s33 offen lds
    s_add_u32 m0, s29, 90112
    s_nop 0
    buffer_load_dwordx4 v14, s[12:15], s33 offen lds
    s_add_u32 m0, s29, 94208
    s_nop 0
    buffer_load_dwordx4 v15, s[12:15], s33 offen lds
    s_branch P3_wd
P3_nold0:
    s_bitcmp1_b32 s2, 7
    s_cbranch_scc1 P3_wA1
    s_branch P3_wd
P3_wA1:
P3_wd:
    s_mov_b32 s3, s59
    s_mov_b32 s30, s59
    s_mov_b32 s56, s94
    s_mov_b32 s57, s95
    s_mov_b32 s58, 4096
    s_mov_b32 s59, 0x20000
    v_lshlrev_b32 v8, 3, v252
    v_lshlrev_b32 v12, 1, v252
    s_mov_b32 s34, 4194308
    buffer_load_dword v36, v8, s[16:19], s34 offen offset:0 sc1
    buffer_load_ushort v44, v12, s[56:59], 0 offen offset:0
    buffer_load_dword v38, v8, s[16:19], s34 offen offset:128 sc1
    buffer_load_ushort v46, v12, s[56:59], 0 offen offset:32
    buffer_load_dword v40, v8, s[16:19], s34 offen offset:256 sc1
    buffer_load_ushort v48, v12, s[56:59], 0 offen offset:64
    buffer_load_dword v42, v8, s[16:19], s34 offen offset:384 sc1
    buffer_load_ushort v50, v12, s[56:59], 0 offen offset:96
    s_add_u32 s8, s44, 8388608
    s_addc_u32 s9, s45, 0
    s_mov_b32 s10, 7340032
    s_mov_b32 s11, 0x20000
    s_add_u32 s20, s44, 29360128
    s_addc_u32 s21, s45, 0
    s_mov_b32 s22, 4194304
    s_mov_b32 s23, 0x20000
    v_add_u32 v9, 32768, v244
    v_add_u32 v17, 32768, v245
    v_add_u32 v18, 65536, v245
    v_add_u32 v19, 98304, v245
    v_add_u32 v25, 49152, v248
    v_add_u32 v31, 49152, v249
    v_add_u32 v27, 49152, v250
    v_add_u32 v33, 49152, v251
    v_xor_b32 v28, 32, v250
    v_xor_b32 v29, 32, v27
    v_xor_b32 v34, 32, v251
    v_xor_b32 v35, 32, v33
    v_lshrrev_b32 v4, 4, v1
    v_pk_mul_f32 v[116:117], v[2:3], v[2:3] op_sel_hi:[0,0]
    v_pk_mul_f32 v[118:119], v[2:3], v[2:3] op_sel_hi:[0,0]
    v_pk_mul_f32 v[120:121], v[2:3], v[2:3] op_sel_hi:[0,0]
    v_pk_mul_f32 v[122:123], v[2:3], v[2:3] op_sel_hi:[0,0]
    v_pk_mul_f32 v[124:125], v[2:3], v[2:3] op_sel_hi:[0,0]
    v_pk_mul_f32 v[126:127], v[2:3], v[2:3] op_sel_hi:[0,0]
    v_pk_mul_f32 v[128:129], v[2:3], v[2:3] op_sel_hi:[0,0]
    v_pk_mul_f32 v[130:131], v[2:3], v[2:3] op_sel_hi:[0,0]
    v_pk_mul_f32 v[132:133], v[2:3], v[2:3] op_sel_hi:[0,0]
    v_pk_mul_f32 v[134:135], v[2:3], v[2:3] op_sel_hi:[0,0]
    v_pk_mul_f32 v[136:137], v[2:3], v[2:3] op_sel_hi:[0,0]
    v_pk_mul_f32 v[138:139], v[2:3], v[2:3] op_sel_hi:[0,0]
    v_pk_mul_f32 v[140:141], v[2:3], v[2:3] op_sel_hi:[0,0]
    v_pk_mul_f32 v[142:143], v[2:3], v[2:3] op_sel_hi:[0,0]
    v_pk_mul_f32 v[144:145], v[2:3], v[2:3] op_sel_hi:[0,0]
    v_pk_mul_f32 v[146:147], v[2:3], v[2:3] op_sel_hi:[0,0]
    v_pk_mul_f32 v[148:149], v[2:3], v[2:3] op_sel_hi:[0,0]
    v_pk_mul_f32 v[150:151], v[2:3], v[2:3] op_sel_hi:[0,0]
    v_pk_mul_f32 v[152:153], v[2:3], v[2:3] op_sel_hi:[0,0]
    v_pk_mul_f32 v[154:155], v[2:3], v[2:3] op_sel_hi:[0,0]
    v_pk_mul_f32 v[156:157], v[2:3], v[2:3] op_sel_hi:[0,0]
    v_pk_mul_f32 v[158:159], v[2:3], v[2:3] op_sel_hi:[0,0]
    v_pk_mul_f32 v[160:161], v[2:3], v[2:3] op_sel_hi:[0,0]
    v_pk_mul_f32 v[162:163], v[2:3], v[2:3] op_sel_hi:[0,0]
    v_pk_mul_f32 v[164:165], v[2:3], v[2:3] op_sel_hi:[0,0]
    v_pk_mul_f32 v[166:167], v[2:3], v[2:3] op_sel_hi:[0,0]
    v_pk_mul_f32 v[168:169], v[2:3], v[2:3] op_sel_hi:[0,0]
    v_pk_mul_f32 v[170:171], v[2:3], v[2:3] op_sel_hi:[0,0]
    v_pk_mul_f32 v[172:173], v[2:3], v[2:3] op_sel_hi:[0,0]
    v_pk_mul_f32 v[174:175], v[2:3], v[2:3] op_sel_hi:[0,0]
    v_pk_mul_f32 v[176:177], v[2:3], v[2:3] op_sel_hi:[0,0]
    v_pk_mul_f32 v[178:179], v[2:3], v[2:3] op_sel_hi:[0,0]
    s_bitcmp1_b32 s2, 7
    s_cbranch_scc0 P3_B
    s_cmp_ge_u32 s28, 4
    s_cbranch_scc1 P3_A1
    s_barrier
    s_mov_b32 s30, s3
    s_add_u32 s34, s30, s31
    s_and_b32 s34, s34, 3
    s_andn2_b32 s35, s30, 3
    s_or_b32 s34, s34, s35
    s_mul_i32 s32, s34, 65536
    s_mul_i32 s33, s34, 131072
    s_add_u32 s30, s30, 1
    s_add_u32 m0, s29, 0
    s_nop 0
    buffer_load_dwordx4 v244, s[8:11], s32 offen sc1 lds
    s_add_u32 m0, s29, 4096
    s_nop 0
    buffer_load_dwordx4 v9, s[8:11], s32 offen sc1 lds
    s_add_u32 s34, s30, s31
    s_and_b32 s34, s34, 3
    s_andn2_b32 s35, s30, 3
    s_or_b32 s34, s34, s35
    s_mul_i32 s32, s34, 65536
    s_mul_i32 s33, s34, 131072
    s_add_u32 s30, s30, 1
    s_add_u32 m0, s29, 24576
    s_nop 0
    buffer_load_dwordx4 v244, s[8:11], s32 offen sc1 lds
    s_add_u32 m0, s29, 28672
    s_nop 0
    buffer_load_dwordx4 v9, s[8:11], s32 offen sc1 lds
    s_add_u32 s34, s30, s31
    s_and_b32 s34, s34, 3
    s_andn2_b32 s35, s30, 3
    s_or_b32 s34, s34, s35
    s_mul_i32 s32, s34, 65536
    s_mul_i32 s33, s34, 131072
    s_add_u32 s30, s30, 1
    s_add_u32 m0, s29, 49152
    s_nop 0
    buffer_load_dwordx4 v244, s[8:11], s32 offen sc1 lds
    s_add_u32 m0, s29, 53248
    s_nop 0
    buffer_load_dwordx4 v9, s[8:11], s32 offen sc1 lds
    s_add_u32 s34, s30, s31
    s_and_b32 s34, s34, 3
    s_andn2_b32 s35, s30, 3
    s_or_b32 s34, s34, s35
    s_mul_i32 s32, s34, 65536
    s_mul_i32 s33, s34, 131072
    s_add_u32 s30, s30, 1
    s_add_u32 m0, s29, 73728
    s_nop 0
    buffer_load_dwordx4 v244, s[8:11], s32 offen sc1 lds
    s_add_u32 m0, s29, 77824
    s_nop 0
    buffer_load_dwordx4 v9, s[8:11], s32 offen sc1 lds
    s_waitcnt vmcnt(0)
    s_barrier
    ds_read_b128 v[52:55], v248 offset:0
    ds_read_b64_tr_b16 v[68:69], v250 offset:0
    ds_read_b64_tr_b16 v[70:71], v250 offset:2048
    ds_read_b128 v[56:59], v248 offset:256
    ds_read_b64_tr_b16 v[72:73], v28 offset:0
    ds_read_b64_tr_b16 v[74:75], v28 offset:2048
    ds_read_b128 v[60:63], v248 offset:512
    ds_read_b64_tr_b16 v[76:77], v250 offset:512
    ds_read_b64_tr_b16 v[78:79], v250 offset:2560
    ds_read_b128 v[64:67], v248 offset:768
    ds_read_b64_tr_b16 v[80:81], v28 offset:512
    ds_read_b64_tr_b16 v[82:83], v28 offset:2560
    s_mov_b32 s36, 7
L_p3_6120:
    s_waitcnt vmcnt(12) lgkmcnt(0)
    s_barrier
    v_mfma_f32_16x16x32_bf16 v[116:119], v[52:55], v[68:71], v[116:119]
    ds_read_b128 v[84:87], v248 offset:24576
    s_add_u32 s34, s30, s31
    s_and_b32 s34, s34, 3
    s_andn2_b32 s35, s30, 3
    s_or_b32 s34, s34, s35
    s_mul_i32 s32, s34, 65536
    s_mul_i32 s33, s34, 131072
    s_add_u32 s30, s30, 1
    s_add_u32 m0, s29, 0
    s_nop 0
    buffer_load_dwordx4 v244, s[8:11], s32 offen sc1 lds
    v_mfma_f32_16x16x32_bf16 v[120:123], v[52:55], v[72:75], v[120:123]
    ds_read_b64_tr_b16 v[100:101], v250 offset:24576
    v_mfma_f32_16x16x32_bf16 v[124:127], v[52:55], v[76:79], v[124:127]
    ds_read_b64_tr_b16 v[102:103], v250 offset:26624
    s_add_u32 m0, s29, 4096
    s_nop 0
    buffer_load_dwordx4 v9, s[8:11], s32 offen sc1 lds
    v_mfma_f32_16x16x32_bf16 v[128:131], v[52:55], v[80:83], v[128:131]
    ds_read_b128 v[88:91], v248 offset:24832
    v_mfma_f32_16x16x32_bf16 v[132:135], v[56:59], v[68:71], v[132:135]
    ds_read_b64_tr_b16 v[104:105], v28 offset:24576
    v_mfma_f32_16x16x32_bf16 v[136:139], v[56:59], v[72:75], v[136:139]
    ds_read_b64_tr_b16 v[106:107], v28 offset:26624
    s_add_u32 m0, s29, 8192
    s_nop 0
    buffer_load_dwordx4 v246, s[12:15], s33 offen lds
    v_mfma_f32_16x16x32_bf16 v[140:143], v[56:59], v[76:79], v[140:143]
    ds_read_b128 v[92:95], v248 offset:25088
    v_mfma_f32_16x16x32_bf16 v[144:147], v[56:59], v[80:83], v[144:147]
    ds_read_b64_tr_b16 v[108:109], v250 offset:25088
    v_mfma_f32_16x16x32_bf16 v[148:151], v[60:63], v[68:71], v[148:151]
    ds_read_b64_tr_b16 v[110:111], v250 offset:27136
    s_add_u32 m0, s29, 12288
    s_nop 0
    buffer_load_dwordx4 v13, s[12:15], s33 offen lds
    v_mfma_f32_16x16x32_bf16 v[152:155], v[60:63], v[72:75], v[152:155]
    ds_read_b128 v[96:99], v248 offset:25344
    v_mfma_f32_16x16x32_bf16 v[156:159], v[60:63], v[76:79], v[156:159]
    ds_read_b64_tr_b16 v[112:113], v28 offset:25088
    s_add_u32 m0, s29, 16384
    s_nop 0
    buffer_load_dwordx4 v14, s[12:15], s33 offen lds
    v_mfma_f32_16x16x32_bf16 v[160:163], v[60:63], v[80:83], v[160:163]
    ds_read_b64_tr_b16 v[114:115], v28 offset:27136
    v_mfma_f32_16x16x32_bf16 v[164:167], v[64:67], v[68:71], v[164:167]
    v_mfma_f32_16x16x32_bf16 v[168:171], v[64:67], v[72:75], v[168:171]
    s_add_u32 m0, s29, 20480
    s_nop 0
    buffer_load_dwordx4 v15, s[12:15], s33 offen lds
    v_mfma_f32_16x16x32_bf16 v[172:175], v[64:67], v[76:79], v[172:175]
    v_mfma_f32_16x16x32_bf16 v[176:179], v[64:67], v[80:83], v[176:179]
    s_waitcnt vmcnt(12) lgkmcnt(0)
    s_barrier
    v_mfma_f32_16x16x32_bf16 v[116:119], v[84:87], v[100:103], v[116:119]
    ds_read_b128 v[52:55], v25 offset:0
    s_add_u32 s34, s30, s31
    s_and_b32 s34, s34, 3
    s_andn2_b32 s35, s30, 3
    s_or_b32 s34, s34, s35
    s_mul_i32 s32, s34, 65536
    s_mul_i32 s33, s34, 131072
    s_add_u32 s30, s30, 1
    s_add_u32 m0, s29, 24576
    s_nop 0
    buffer_load_dwordx4 v244, s[8:11], s32 offen sc1 lds
    v_mfma_f32_16x16x32_bf16 v[120:123], v[84:87], v[104:107], v[120:123]
    ds_read_b64_tr_b16 v[68:69], v27 offset:0
    v_mfma_f32_16x16x32_bf16 v[124:127], v[84:87], v[108:111], v[124:127]
    ds_read_b64_tr_b16 v[70:71], v27 offset:2048
    s_add_u32 m0, s29, 28672
    s_nop 0
    buffer_load_dwordx4 v9, s[8:11], s32 offen sc1 lds
    v_mfma_f32_16x16x32_bf16 v[128:131], v[84:87], v[112:115], v[128:131]
    ds_read_b128 v[56:59], v25 offset:256
    v_mfma_f32_16x16x32_bf16 v[132:135], v[88:91], v[100:103], v[132:135]
    ds_read_b64_tr_b16 v[72:73], v29 offset:0
    v_mfma_f32_16x16x32_bf16 v[136:139], v[88:91], v[104:107], v[136:139]
    ds_read_b64_tr_b16 v[74:75], v29 offset:2048
    s_add_u32 m0, s29, 32768
    s_nop 0
    buffer_load_dwordx4 v246, s[12:15], s33 offen lds
    v_mfma_f32_16x16x32_bf16 v[140:143], v[88:91], v[108:111], v[140:143]
    ds_read_b128 v[60:63], v25 offset:512
    v_mfma_f32_16x16x32_bf16 v[144:147], v[88:91], v[112:115], v[144:147]
    ds_read_b64_tr_b16 v[76:77], v27 offset:512
    v_mfma_f32_16x16x32_bf16 v[148:151], v[92:95], v[100:103], v[148:151]
    ds_read_b64_tr_b16 v[78:79], v27 offset:2560
    s_add_u32 m0, s29, 36864
    s_nop 0
    buffer_load_dwordx4 v13, s[12:15], s33 offen lds
    v_mfma_f32_16x16x32_bf16 v[152:155], v[92:95], v[104:107], v[152:155]
    ds_read_b128 v[64:67], v25 offset:768
    v_mfma_f32_16x16x32_bf16 v[156:159], v[92:95], v[108:111], v[156:159]
    ds_read_b64_tr_b16 v[80:81], v29 offset:512
    s_add_u32 m0, s29, 40960
    s_nop 0
    buffer_load_dwordx4 v14, s[12:15], s33 offen lds
    v_mfma_f32_16x16x32_bf16 v[160:163], v[92:95], v[112:115], v[160:163]
    ds_read_b64_tr_b16 v[82:83], v29 offset:2560
    v_mfma_f32_16x16x32_bf16 v[164:167], v[96:99], v[100:103], v[164:167]
    v_mfma_f32_16x16x32_bf16 v[168:171], v[96:99], v[104:107], v[168:171]
    s_add_u32 m0, s29, 45056
    s_nop 0
    buffer_load_dwordx4 v15, s[12:15], s33 offen lds
    v_mfma_f32_16x16x32_bf16 v[172:175], v[96:99], v[108:111], v[172:175]
    v_mfma_f32_16x16x32_bf16 v[176:179], v[96:99], v[112:115], v[176:179]
    s_waitcnt vmcnt(12) lgkmcnt(0)
    s_barrier
    v_mfma_f32_16x16x32_bf16 v[116:119], v[52:55], v[68:71], v[116:119]
    ds_read_b128 v[84:87], v25 offset:24576
    s_add_u32 s34, s30, s31
    s_and_b32 s34, s34, 3
    s_andn2_b32 s35, s30, 3
    s_or_b32 s34, s34, s35
    s_mul_i32 s32, s34, 65536
    s_mul_i32 s33, s34, 131072
    s_add_u32 s30, s30, 1
    s_add_u32 m0, s29, 49152
    s_nop 0
    buffer_load_dwordx4 v244, s[8:11], s32 offen sc1 lds
    v_mfma_f32_16x16x32_bf16 v[120:123], v[52:55], v[72:75], v[120:123]
    ds_read_b64_tr_b16 v[100:101], v27 offset:24576
    v_mfma_f32_16x16x32_bf16 v[124:127], v[52:55], v[76:79], v[124:127]
    ds_read_b64_tr_b16 v[102:103], v27 offset:26624
    s_add_u32 m0, s29, 53248
    s_nop 0
    buffer_load_dwordx4 v9, s[8:11], s32 offen sc1 lds
    v_mfma_f32_16x16x32_bf16 v[128:131], v[52:55], v[80:83], v[128:131]
    ds_read_b128 v[88:91], v25 offset:24832
    v_mfma_f32_16x16x32_bf16 v[132:135], v[56:59], v[68:71], v[132:135]
    ds_read_b64_tr_b16 v[104:105], v29 offset:24576
    v_mfma_f32_16x16x32_bf16 v[136:139], v[56:59], v[72:75], v[136:139]
    ds_read_b64_tr_b16 v[106:107], v29 offset:26624
    s_add_u32 m0, s29, 57344
    s_nop 0
    buffer_load_dwordx4 v246, s[12:15], s33 offen lds
    v_mfma_f32_16x16x32_bf16 v[140:143], v[56:59], v[76:79], v[140:143]
    ds_read_b128 v[92:95], v25 offset:25088
    v_mfma_f32_16x16x32_bf16 v[144:147], v[56:59], v[80:83], v[144:147]
    ds_read_b64_tr_b16 v[108:109], v27 offset:25088
    v_mfma_f32_16x16x32_bf16 v[148:151], v[60:63], v[68:71], v[148:151]
    ds_read_b64_tr_b16 v[110:111], v27 offset:27136
    s_add_u32 m0, s29, 61440
    s_nop 0
    buffer_load_dwordx4 v13, s[12:15], s33 offen lds
    v_mfma_f32_16x16x32_bf16 v[152:155], v[60:63], v[72:75], v[152:155]
    ds_read_b128 v[96:99], v25 offset:25344
    v_mfma_f32_16x16x32_bf16 v[156:159], v[60:63], v[76:79], v[156:159]
    ds_read_b64_tr_b16 v[112:113], v29 offset:25088
    s_add_u32 m0, s29, 65536
    s_nop 0
    buffer_load_dwordx4 v14, s[12:15], s33 offen lds
    v_mfma_f32_16x16x32_bf16 v[160:163], v[60:63], v[80:83], v[160:163]
    ds_read_b64_tr_b16 v[114:115], v29 offset:27136
    v_mfma_f32_16x16x32_bf16 v[164:167], v[64:67], v[68:71], v[164:167]
    v_mfma_f32_16x16x32_bf16 v[168:171], v[64:67], v[72:75], v[168:171]
    s_add_u32 m0, s29, 69632
    s_nop 0
    buffer_load_dwordx4 v15, s[12:15], s33 offen lds
    v_mfma_f32_16x16x32_bf16 v[172:175], v[64:67], v[76:79], v[172:175]
    v_mfma_f32_16x16x32_bf16 v[176:179], v[64:67], v[80:83], v[176:179]
    s_waitcnt vmcnt(12) lgkmcnt(0)
    s_barrier
    v_mfma_f32_16x16x32_bf16 v[116:119], v[84:87], v[100:103], v[116:119]
    ds_read_b128 v[52:55], v248 offset:0
    s_add_u32 s34, s30, s31
    s_and_b32 s34, s34, 3
    s_andn2_b32 s35, s30, 3
    s_or_b32 s34, s34, s35
    s_mul_i32 s32, s34, 65536
    s_mul_i32 s33, s34, 131072
    s_add_u32 s30, s30, 1
    s_add_u32 m0, s29, 73728
    s_nop 0
    buffer_load_dwordx4 v244, s[8:11], s32 offen sc1 lds
    v_mfma_f32_16x16x32_bf16 v[120:123], v[84:87], v[104:107], v[120:123]
    ds_read_b64_tr_b16 v[68:69], v250 offset:0
    v_mfma_f32_16x16x32_bf16 v[124:127], v[84:87], v[108:111], v[124:127]
    ds_read_b64_tr_b16 v[70:71], v250 offset:2048
    s_add_u32 m0, s29, 77824
    s_nop 0
    buffer_load_dwordx4 v9, s[8:11], s32 offen sc1 lds
    v_mfma_f32_16x16x32_bf16 v[128:131], v[84:87], v[112:115], v[128:131]
    ds_read_b128 v[56:59], v248 offset:256
    v_mfma_f32_16x16x32_bf16 v[132:135], v[88:91], v[100:103], v[132:135]
    ds_read_b64_tr_b16 v[72:73], v28 offset:0
    v_mfma_f32_16x16x32_bf16 v[136:139], v[88:91], v[104:107], v[136:139]
    ds_read_b64_tr_b16 v[74:75], v28 offset:2048
    s_add_u32 m0, s29, 81920
    s_nop 0
    buffer_load_dwordx4 v246, s[12:15], s33 offen lds
    v_mfma_f32_16x16x32_bf16 v[140:143], v[88:91], v[108:111], v[140:143]
    ds_read_b128 v[60:63], v248 offset:512
    v_mfma_f32_16x16x32_bf16 v[144:147], v[88:91], v[112:115], v[144:147]
    ds_read_b64_tr_b16 v[76:77], v250 offset:512
    v_mfma_f32_16x16x32_bf16 v[148:151], v[92:95], v[100:103], v[148:151]
    ds_read_b64_tr_b16 v[78:79], v250 offset:2560
    s_add_u32 m0, s29, 86016
    s_nop 0
    buffer_load_dwordx4 v13, s[12:15], s33 offen lds
    v_mfma_f32_16x16x32_bf16 v[152:155], v[92:95], v[104:107], v[152:155]
    ds_read_b128 v[64:67], v248 offset:768
    v_mfma_f32_16x16x32_bf16 v[156:159], v[92:95], v[108:111], v[156:159]
    ds_read_b64_tr_b16 v[80:81], v28 offset:512
    s_add_u32 m0, s29, 90112
    s_nop 0
    buffer_load_dwordx4 v14, s[12:15], s33 offen lds
    v_mfma_f32_16x16x32_bf16 v[160:163], v[92:95], v[112:115], v[160:163]
    ds_read_b64_tr_b16 v[82:83], v28 offset:2560
    v_mfma_f32_16x16x32_bf16 v[164:167], v[96:99], v[100:103], v[164:167]
    v_mfma_f32_16x16x32_bf16 v[168:171], v[96:99], v[104:107], v[168:171]
    s_add_u32 m0, s29, 94208
    s_nop 0
    buffer_load_dwordx4 v15, s[12:15], s33 offen lds
    v_mfma_f32_16x16x32_bf16 v[172:175], v[96:99], v[108:111], v[172:175]
    v_mfma_f32_16x16x32_bf16 v[176:179], v[96:99], v[112:115], v[176:179]
    s_sub_u32 s36, s36, 1
    s_cmp_lg_u32 s36, 0
    s_cbranch_scc1 L_p3_6120
    s_waitcnt vmcnt(12) lgkmcnt(0)
    s_barrier
    v_mfma_f32_16x16x32_bf16 v[116:119], v[52:55], v[68:71], v[116:119]
    ds_read_b128 v[84:87], v248 offset:24576
    v_mfma_f32_16x16x32_bf16 v[120:123], v[52:55], v[72:75], v[120:123]
    ds_read_b64_tr_b16 v[100:101], v250 offset:24576
    v_mfma_f32_16x16x32_bf16 v[124:127], v[52:55], v[76:79], v[124:127]
    ds_read_b64_tr_b16 v[102:103], v250 offset:26624
    v_mfma_f32_16x16x32_bf16 v[128:131], v[52:55], v[80:83], v[128:131]
    ds_read_b128 v[88:91], v248 offset:24832
    v_mfma_f32_16x16x32_bf16 v[132:135], v[56:59], v[68:71], v[132:135]
    ds_read_b64_tr_b16 v[104:105], v28 offset:24576
    v_mfma_f32_16x16x32_bf16 v[136:139], v[56:59], v[72:75], v[136:139]
    ds_read_b64_tr_b16 v[106:107], v28 offset:26624
    v_mfma_f32_16x16x32_bf16 v[140:143], v[56:59], v[76:79], v[140:143]
    ds_read_b128 v[92:95], v248 offset:25088
    v_mfma_f32_16x16x32_bf16 v[144:147], v[56:59], v[80:83], v[144:147]
    ds_read_b64_tr_b16 v[108:109], v250 offset:25088
    v_mfma_f32_16x16x32_bf16 v[148:151], v[60:63], v[68:71], v[148:151]
    ds_read_b64_tr_b16 v[110:111], v250 offset:27136
    v_mfma_f32_16x16x32_bf16 v[152:155], v[60:63], v[72:75], v[152:155]
    ds_read_b128 v[96:99], v248 offset:25344
    v_mfma_f32_16x16x32_bf16 v[156:159], v[60:63], v[76:79], v[156:159]
    ds_read_b64_tr_b16 v[112:113], v28 offset:25088
    v_mfma_f32_16x16x32_bf16 v[160:163], v[60:63], v[80:83], v[160:163]
    ds_read_b64_tr_b16 v[114:115], v28 offset:27136
    v_mfma_f32_16x16x32_bf16 v[164:167], v[64:67], v[68:71], v[164:167]
    v_mfma_f32_16x16x32_bf16 v[168:171], v[64:67], v[72:75], v[168:171]
    v_mfma_f32_16x16x32_bf16 v[172:175], v[64:67], v[76:79], v[172:175]
    v_mfma_f32_16x16x32_bf16 v[176:179], v[64:67], v[80:83], v[176:179]
    s_waitcnt vmcnt(6) lgkmcnt(0)
    s_barrier
    v_mfma_f32_16x16x32_bf16 v[116:119], v[84:87], v[100:103], v[116:119]
    ds_read_b128 v[52:55], v25 offset:0
    v_mfma_f32_16x16x32_bf16 v[120:123], v[84:87], v[104:107], v[120:123]
    ds_read_b64_tr_b16 v[68:69], v27 offset:0
    v_mfma_f32_16x16x32_bf16 v[124:127], v[84:87], v[108:111], v[124:127]
    ds_read_b64_tr_b16 v[70:71], v27 offset:2048
    v_mfma_f32_16x16x32_bf16 v[128:131], v[84:87], v[112:115], v[128:131]
    ds_read_b128 v[56:59], v25 offset:256
    v_mfma_f32_16x16x32_bf16 v[132:135], v[88:91], v[100:103], v[132:135]
    ds_read_b64_tr_b16 v[72:73], v29 offset:0
    v_mfma_f32_16x16x32_bf16 v[136:139], v[88:91], v[104:107], v[136:139]
    ds_read_b64_tr_b16 v[74:75], v29 offset:2048
    v_mfma_f32_16x16x32_bf16 v[140:143], v[88:91], v[108:111], v[140:143]
    ds_read_b128 v[60:63], v25 offset:512
    v_mfma_f32_16x16x32_bf16 v[144:147], v[88:91], v[112:115], v[144:147]
    ds_read_b64_tr_b16 v[76:77], v27 offset:512
    v_mfma_f32_16x16x32_bf16 v[148:151], v[92:95], v[100:103], v[148:151]
    ds_read_b64_tr_b16 v[78:79], v27 offset:2560
    v_mfma_f32_16x16x32_bf16 v[152:155], v[92:95], v[104:107], v[152:155]
    ds_read_b128 v[64:67], v25 offset:768
    v_mfma_f32_16x16x32_bf16 v[156:159], v[92:95], v[108:111], v[156:159]
    ds_read_b64_tr_b16 v[80:81], v29 offset:512
    v_mfma_f32_16x16x32_bf16 v[160:163], v[92:95], v[112:115], v[160:163]
    ds_read_b64_tr_b16 v[82:83], v29 offset:2560
    v_mfma_f32_16x16x32_bf16 v[164:167], v[96:99], v[100:103], v[164:167]
    v_mfma_f32_16x16x32_bf16 v[168:171], v[96:99], v[104:107], v[168:171]
    v_mfma_f32_16x16x32_bf16 v[172:175], v[96:99], v[108:111], v[172:175]
    v_mfma_f32_16x16x32_bf16 v[176:179], v[96:99], v[112:115], v[176:179]
    s_waitcnt vmcnt(0) lgkmcnt(0)
    s_barrier
    v_mfma_f32_16x16x32_bf16 v[116:119], v[52:55], v[68:71], v[116:119]
    ds_read_b128 v[84:87], v25 offset:24576
    v_mfma_f32_16x16x32_bf16 v[120:123], v[52:55], v[72:75], v[120:123]
    ds_read_b64_tr_b16 v[100:101], v27 offset:24576
    v_mfma_f32_16x16x32_bf16 v[124:127], v[52:55], v[76:79], v[124:127]
    ds_read_b64_tr_b16 v[102:103], v27 offset:26624
    v_mfma_f32_16x16x32_bf16 v[128:131], v[52:55], v[80:83], v[128:131]
    ds_read_b128 v[88:91], v25 offset:24832
    v_mfma_f32_16x16x32_bf16 v[132:135], v[56:59], v[68:71], v[132:135]
    ds_read_b64_tr_b16 v[104:105], v29 offset:24576
    v_mfma_f32_16x16x32_bf16 v[136:139], v[56:59], v[72:75], v[136:139]
    ds_read_b64_tr_b16 v[106:107], v29 offset:26624
    v_mfma_f32_16x16x32_bf16 v[140:143], v[56:59], v[76:79], v[140:143]
    ds_read_b128 v[92:95], v25 offset:25088
    v_mfma_f32_16x16x32_bf16 v[144:147], v[56:59], v[80:83], v[144:147]
    ds_read_b64_tr_b16 v[108:109], v27 offset:25088
    v_mfma_f32_16x16x32_bf16 v[148:151], v[60:63], v[68:71], v[148:151]
    ds_read_b64_tr_b16 v[110:111], v27 offset:27136
    v_mfma_f32_16x16x32_bf16 v[152:155], v[60:63], v[72:75], v[152:155]
    ds_read_b128 v[96:99], v25 offset:25344
    v_mfma_f32_16x16x32_bf16 v[156:159], v[60:63], v[76:79], v[156:159]
    ds_read_b64_tr_b16 v[112:113], v29 offset:25088
    v_mfma_f32_16x16x32_bf16 v[160:163], v[60:63], v[80:83], v[160:163]
    ds_read_b64_tr_b16 v[114:115], v29 offset:27136
    v_mfma_f32_16x16x32_bf16 v[164:167], v[64:67], v[68:71], v[164:167]
    v_mfma_f32_16x16x32_bf16 v[168:171], v[64:67], v[72:75], v[168:171]
    v_mfma_f32_16x16x32_bf16 v[172:175], v[64:67], v[76:79], v[172:175]
    v_mfma_f32_16x16x32_bf16 v[176:179], v[64:67], v[80:83], v[176:179]
    s_waitcnt lgkmcnt(0)
    v_mfma_f32_16x16x32_bf16 v[116:119], v[84:87], v[100:103], v[116:119]
    v_mfma_f32_16x16x32_bf16 v[120:123], v[84:87], v[104:107], v[120:123]
    v_mfma_f32_16x16x32_bf16 v[124:127], v[84:87], v[108:111], v[124:127]
    v_mfma_f32_16x16x32_bf16 v[128:131], v[84:87], v[112:115], v[128:131]
    v_mfma_f32_16x16x32_bf16 v[132:135], v[88:91], v[100:103], v[132:135]
    v_mfma_f32_16x16x32_bf16 v[136:139], v[88:91], v[104:107], v[136:139]
    v_mfma_f32_16x16x32_bf16 v[140:143], v[88:91], v[108:111], v[140:143]
    v_mfma_f32_16x16x32_bf16 v[144:147], v[88:91], v[112:115], v[144:147]
    v_mfma_f32_16x16x32_bf16 v[148:151], v[92:95], v[100:103], v[148:151]
    v_mfma_f32_16x16x32_bf16 v[152:155], v[92:95], v[104:107], v[152:155]
    v_mfma_f32_16x16x32_bf16 v[156:159], v[92:95], v[108:111], v[156:159]
    v_mfma_f32_16x16x32_bf16 v[160:163], v[92:95], v[112:115], v[160:163]
    v_mfma_f32_16x16x32_bf16 v[164:167], v[96:99], v[100:103], v[164:167]
    v_mfma_f32_16x16x32_bf16 v[168:171], v[96:99], v[104:107], v[168:171]
    v_mfma_f32_16x16x32_bf16 v[172:175], v[96:99], v[108:111], v[172:175]
    v_mfma_f32_16x16x32_bf16 v[176:179], v[96:99], v[112:115], v[176:179]
    s_branch P3_Aend
P3_A1:
    s_cmp_lg_u32 s28, 4
    s_cbranch_scc1 Lq_depA
    s_mov_b32 s39, 0
Lp_depA:
    buffer_load_dword v3, v20, s[16:19], 0 offen sc1
    s_add_u32 s39, s39, 1
    s_waitcnt vmcnt(0)
    v_cmp_ne_u32 vcc, s51, v3
    s_cbranch_vccz Lq_depA
    s_cmp_ge_u32 s39, 0x40000
    s_cbranch_scc1 Lq_depA
    s_sleep 1
    s_branch Lp_depA
Lq_depA:
    s_waitcnt vmcnt(0)
    s_barrier
    s_barrier
    ds_read_b128 v[52:55], v248 offset:0
    ds_read_b64_tr_b16 v[68:69], v250 offset:0
    ds_read_b64_tr_b16 v[70:71], v250 offset:2048
    ds_read_b128 v[56:59], v248 offset:256
    ds_read_b64_tr_b16 v[72:73], v28 offset:0
    ds_read_b64_tr_b16 v[74:75], v28 offset:2048
    ds_read_b128 v[60:63], v248 offset:512
    ds_read_b64_tr_b16 v[76:77], v250 offset:512
    ds_read_b64_tr_b16 v[78:79], v250 offset:2560
    ds_read_b128 v[64:67], v248 offset:768
    ds_read_b64_tr_b16 v[80:81], v28 offset:512
    ds_read_b64_tr_b16 v[82:83], v28 offset:2560
    s_mov_b32 s36, 7
L_p3_6483:
    s_waitcnt lgkmcnt(0)
    s_barrier
    v_mfma_f32_16x16x32_bf16 v[116:119], v[52:55], v[68:71], v[116:119]
    ds_read_b128 v[84:87], v248 offset:24576
    v_mfma_f32_16x16x32_bf16 v[120:123], v[52:55], v[72:75], v[120:123]
    ds_read_b64_tr_b16 v[100:101], v250 offset:24576
    v_mfma_f32_16x16x32_bf16 v[124:127], v[52:55], v[76:79], v[124:127]
    ds_read_b64_tr_b16 v[102:103], v250 offset:26624
    v_mfma_f32_16x16x32_bf16 v[128:131], v[52:55], v[80:83], v[128:131]
    ds_read_b128 v[88:91], v248 offset:24832
    v_mfma_f32_16x16x32_bf16 v[132:135], v[56:59], v[68:71], v[132:135]
    ds_read_b64_tr_b16 v[104:105], v28 offset:24576
    v_mfma_f32_16x16x32_bf16 v[136:139], v[56:59], v[72:75], v[136:139]
    ds_read_b64_tr_b16 v[106:107], v28 offset:26624
    v_mfma_f32_16x16x32_bf16 v[140:143], v[56:59], v[76:79], v[140:143]
    ds_read_b128 v[92:95], v248 offset:25088
    v_mfma_f32_16x16x32_bf16 v[144:147], v[56:59], v[80:83], v[144:147]
    ds_read_b64_tr_b16 v[108:109], v250 offset:25088
    v_mfma_f32_16x16x32_bf16 v[148:151], v[60:63], v[68:71], v[148:151]
    ds_read_b64_tr_b16 v[110:111], v250 offset:27136
    v_mfma_f32_16x16x32_bf16 v[152:155], v[60:63], v[72:75], v[152:155]
    ds_read_b128 v[96:99], v248 offset:25344
    v_mfma_f32_16x16x32_bf16 v[156:159], v[60:63], v[76:79], v[156:159]
    ds_read_b64_tr_b16 v[112:113], v28 offset:25088
    v_mfma_f32_16x16x32_bf16 v[160:163], v[60:63], v[80:83], v[160:163]
    ds_read_b64_tr_b16 v[114:115], v28 offset:27136
    v_mfma_f32_16x16x32_bf16 v[164:167], v[64:67], v[68:71], v[164:167]
    v_mfma_f32_16x16x32_bf16 v[168:171], v[64:67], v[72:75], v[168:171]
    v_mfma_f32_16x16x32_bf16 v[172:175], v[64:67], v[76:79], v[172:175]
    v_mfma_f32_16x16x32_bf16 v[176:179], v[64:67], v[80:83], v[176:179]
    s_waitcnt lgkmcnt(0)
    s_barrier
    v_mfma_f32_16x16x32_bf16 v[116:119], v[84:87], v[100:103], v[116:119]
    ds_read_b128 v[52:55], v25 offset:0
    v_mfma_f32_16x16x32_bf16 v[120:123], v[84:87], v[104:107], v[120:123]
    ds_read_b64_tr_b16 v[68:69], v27 offset:0
    v_mfma_f32_16x16x32_bf16 v[124:127], v[84:87], v[108:111], v[124:127]
    ds_read_b64_tr_b16 v[70:71], v27 offset:2048
    v_mfma_f32_16x16x32_bf16 v[128:131], v[84:87], v[112:115], v[128:131]
    ds_read_b128 v[56:59], v25 offset:256
    v_mfma_f32_16x16x32_bf16 v[132:135], v[88:91], v[100:103], v[132:135]
    ds_read_b64_tr_b16 v[72:73], v29 offset:0
    v_mfma_f32_16x16x32_bf16 v[136:139], v[88:91], v[104:107], v[136:139]
    ds_read_b64_tr_b16 v[74:75], v29 offset:2048
    v_mfma_f32_16x16x32_bf16 v[140:143], v[88:91], v[108:111], v[140:143]
    ds_read_b128 v[60:63], v25 offset:512
    v_mfma_f32_16x16x32_bf16 v[144:147], v[88:91], v[112:115], v[144:147]
    ds_read_b64_tr_b16 v[76:77], v27 offset:512
    v_mfma_f32_16x16x32_bf16 v[148:151], v[92:95], v[100:103], v[148:151]
    ds_read_b64_tr_b16 v[78:79], v27 offset:2560
    v_mfma_f32_16x16x32_bf16 v[152:155], v[92:95], v[104:107], v[152:155]
    ds_read_b128 v[64:67], v25 offset:768
    v_mfma_f32_16x16x32_bf16 v[156:159], v[92:95], v[108:111], v[156:159]
    ds_read_b64_tr_b16 v[80:81], v29 offset:512
    v_mfma_f32_16x16x32_bf16 v[160:163], v[92:95], v[112:115], v[160:163]
    ds_read_b64_tr_b16 v[82:83], v29 offset:2560
    v_mfma_f32_16x16x32_bf16 v[164:167], v[96:99], v[100:103], v[164:167]
    v_mfma_f32_16x16x32_bf16 v[168:171], v[96:99], v[104:107], v[168:171]
    v_mfma_f32_16x16x32_bf16 v[172:175], v[96:99], v[108:111], v[172:175]
    v_mfma_f32_16x16x32_bf16 v[176:179], v[96:99], v[112:115], v[176:179]
    s_waitcnt lgkmcnt(0)
    s_barrier
    v_mfma_f32_16x16x32_bf16 v[116:119], v[52:55], v[68:71], v[116:119]
    ds_read_b128 v[84:87], v25 offset:24576
    v_mfma_f32_16x16x32_bf16 v[120:123], v[52:55], v[72:75], v[120:123]
    ds_read_b64_tr_b16 v[100:101], v27 offset:24576
    v_mfma_f32_16x16x32_bf16 v[124:127], v[52:55], v[76:79], v[124:127]
    ds_read_b64_tr_b16 v[102:103], v27 offset:26624
    v_mfma_f32_16x16x32_bf16 v[128:131], v[52:55], v[80:83], v[128:131]
    ds_read_b128 v[88:91], v25 offset:24832
    v_mfma_f32_16x16x32_bf16 v[132:135], v[56:59], v[68:71], v[132:135]
    ds_read_b64_tr_b16 v[104:105], v29 offset:24576
    v_mfma_f32_16x16x32_bf16 v[136:139], v[56:59], v[72:75], v[136:139]
    ds_read_b64_tr_b16 v[106:107], v29 offset:26624
    v_mfma_f32_16x16x32_bf16 v[140:143], v[56:59], v[76:79], v[140:143]
    ds_read_b128 v[92:95], v25 offset:25088
    v_mfma_f32_16x16x32_bf16 v[144:147], v[56:59], v[80:83], v[144:147]
    ds_read_b64_tr_b16 v[108:109], v27 offset:25088
    v_mfma_f32_16x16x32_bf16 v[148:151], v[60:63], v[68:71], v[148:151]
    ds_read_b64_tr_b16 v[110:111], v27 offset:27136
    v_mfma_f32_16x16x32_bf16 v[152:155], v[60:63], v[72:75], v[152:155]
    ds_read_b128 v[96:99], v25 offset:25344
    v_mfma_f32_16x16x32_bf16 v[156:159], v[60:63], v[76:79], v[156:159]
    ds_read_b64_tr_b16 v[112:113], v29 offset:25088
    v_mfma_f32_16x16x32_bf16 v[160:163], v[60:63], v[80:83], v[160:163]
    ds_read_b64_tr_b16 v[114:115], v29 offset:27136
    v_mfma_f32_16x16x32_bf16 v[164:167], v[64:67], v[68:71], v[164:167]
    v_mfma_f32_16x16x32_bf16 v[168:171], v[64:67], v[72:75], v[168:171]
    v_mfma_f32_16x16x32_bf16 v[172:175], v[64:67], v[76:79], v[172:175]
    v_mfma_f32_16x16x32_bf16 v[176:179], v[64:67], v[80:83], v[176:179]
    s_waitcnt lgkmcnt(0)
    s_barrier
    v_mfma_f32_16x16x32_bf16 v[116:119], v[84:87], v[100:103], v[116:119]
    ds_read_b128 v[52:55], v248 offset:0
    v_mfma_f32_16x16x32_bf16 v[120:123], v[84:87], v[104:107], v[120:123]
    ds_read_b64_tr_b16 v[68:69], v250 offset:0
    v_mfma_f32_16x16x32_bf16 v[124:127], v[84:87], v[108:111], v[124:127]
    ds_read_b64_tr_b16 v[70:71], v250 offset:2048
    v_mfma_f32_16x16x32_bf16 v[128:131], v[84:87], v[112:115], v[128:131]
    ds_read_b128 v[56:59], v248 offset:256
    v_mfma_f32_16x16x32_bf16 v[132:135], v[88:91], v[100:103], v[132:135]
    ds_read_b64_tr_b16 v[72:73], v28 offset:0
    v_mfma_f32_16x16x32_bf16 v[136:139], v[88:91], v[104:107], v[136:139]
    ds_read_b64_tr_b16 v[74:75], v28 offset:2048
    v_mfma_f32_16x16x32_bf16 v[140:143], v[88:91], v[108:111], v[140:143]
    ds_read_b128 v[60:63], v248 offset:512
    v_mfma_f32_16x16x32_bf16 v[144:147], v[88:91], v[112:115], v[144:147]
    ds_read_b64_tr_b16 v[76:77], v250 offset:512
    v_mfma_f32_16x16x32_bf16 v[148:151], v[92:95], v[100:103], v[148:151]
    ds_read_b64_tr_b16 v[78:79], v250 offset:2560
    v_mfma_f32_16x16x32_bf16 v[152:155], v[92:95], v[104:107], v[152:155]
    ds_read_b128 v[64:67], v248 offset:768
    v_mfma_f32_16x16x32_bf16 v[156:159], v[92:95], v[108:111], v[156:159]
    ds_read_b64_tr_b16 v[80:81], v28 offset:512
    v_mfma_f32_16x16x32_bf16 v[160:163], v[92:95], v[112:115], v[160:163]
    ds_read_b64_tr_b16 v[82:83], v28 offset:2560
    v_mfma_f32_16x16x32_bf16 v[164:167], v[96:99], v[100:103], v[164:167]
    v_mfma_f32_16x16x32_bf16 v[168:171], v[96:99], v[104:107], v[168:171]
    v_mfma_f32_16x16x32_bf16 v[172:175], v[96:99], v[108:111], v[172:175]
    v_mfma_f32_16x16x32_bf16 v[176:179], v[96:99], v[112:115], v[176:179]
    s_sub_u32 s36, s36, 1
    s_cmp_lg_u32 s36, 0
    s_cbranch_scc1 L_p3_6483
    s_waitcnt lgkmcnt(0)
    s_barrier
    v_mfma_f32_16x16x32_bf16 v[116:119], v[52:55], v[68:71], v[116:119]
    ds_read_b128 v[84:87], v248 offset:24576
    v_mfma_f32_16x16x32_bf16 v[120:123], v[52:55], v[72:75], v[120:123]
    ds_read_b64_tr_b16 v[100:101], v250 offset:24576
    v_mfma_f32_16x16x32_bf16 v[124:127], v[52:55], v[76:79], v[124:127]
    ds_read_b64_tr_b16 v[102:103], v250 offset:26624
    v_mfma_f32_16x16x32_bf16 v[128:131], v[52:55], v[80:83], v[128:131]
    ds_read_b128 v[88:91], v248 offset:24832
    v_mfma_f32_16x16x32_bf16 v[132:135], v[56:59], v[68:71], v[132:135]
    ds_read_b64_tr_b16 v[104:105], v28 offset:24576
    v_mfma_f32_16x16x32_bf16 v[136:139], v[56:59], v[72:75], v[136:139]
    ds_read_b64_tr_b16 v[106:107], v28 offset:26624
    v_mfma_f32_16x16x32_bf16 v[140:143], v[56:59], v[76:79], v[140:143]
    ds_read_b128 v[92:95], v248 offset:25088
    v_mfma_f32_16x16x32_bf16 v[144:147], v[56:59], v[80:83], v[144:147]
    ds_read_b64_tr_b16 v[108:109], v250 offset:25088
    v_mfma_f32_16x16x32_bf16 v[148:151], v[60:63], v[68:71], v[148:151]
    ds_read_b64_tr_b16 v[110:111], v250 offset:27136
    v_mfma_f32_16x16x32_bf16 v[152:155], v[60:63], v[72:75], v[152:155]
    ds_read_b128 v[96:99], v248 offset:25344
    v_mfma_f32_16x16x32_bf16 v[156:159], v[60:63], v[76:79], v[156:159]
    ds_read_b64_tr_b16 v[112:113], v28 offset:25088
    v_mfma_f32_16x16x32_bf16 v[160:163], v[60:63], v[80:83], v[160:163]
    ds_read_b64_tr_b16 v[114:115], v28 offset:27136
    v_mfma_f32_16x16x32_bf16 v[164:167], v[64:67], v[68:71], v[164:167]
    v_mfma_f32_16x16x32_bf16 v[168:171], v[64:67], v[72:75], v[168:171]
    v_mfma_f32_16x16x32_bf16 v[172:175], v[64:67], v[76:79], v[172:175]
    v_mfma_f32_16x16x32_bf16 v[176:179], v[64:67], v[80:83], v[176:179]
    s_waitcnt lgkmcnt(0)
    s_barrier
    v_mfma_f32_16x16x32_bf16 v[116:119], v[84:87], v[100:103], v[116:119]
    ds_read_b128 v[52:55], v25 offset:0
    v_mfma_f32_16x16x32_bf16 v[120:123], v[84:87], v[104:107], v[120:123]
    ds_read_b64_tr_b16 v[68:69], v27 offset:0
    v_mfma_f32_16x16x32_bf16 v[124:127], v[84:87], v[108:111], v[124:127]
    ds_read_b64_tr_b16 v[70:71], v27 offset:2048
    v_mfma_f32_16x16x32_bf16 v[128:131], v[84:87], v[112:115], v[128:131]
    ds_read_b128 v[56:59], v25 offset:256
    v_mfma_f32_16x16x32_bf16 v[132:135], v[88:91], v[100:103], v[132:135]
    ds_read_b64_tr_b16 v[72:73], v29 offset:0
    v_mfma_f32_16x16x32_bf16 v[136:139], v[88:91], v[104:107], v[136:139]
    ds_read_b64_tr_b16 v[74:75], v29 offset:2048
    v_mfma_f32_16x16x32_bf16 v[140:143], v[88:91], v[108:111], v[140:143]
    ds_read_b128 v[60:63], v25 offset:512
    v_mfma_f32_16x16x32_bf16 v[144:147], v[88:91], v[112:115], v[144:147]
    ds_read_b64_tr_b16 v[76:77], v27 offset:512
    v_mfma_f32_16x16x32_bf16 v[148:151], v[92:95], v[100:103], v[148:151]
    ds_read_b64_tr_b16 v[78:79], v27 offset:2560
    v_mfma_f32_16x16x32_bf16 v[152:155], v[92:95], v[104:107], v[152:155]
    ds_read_b128 v[64:67], v25 offset:768
    v_mfma_f32_16x16x32_bf16 v[156:159], v[92:95], v[108:111], v[156:159]
    ds_read_b64_tr_b16 v[80:81], v29 offset:512
    v_mfma_f32_16x16x32_bf16 v[160:163], v[92:95], v[112:115], v[160:163]
    ds_read_b64_tr_b16 v[82:83], v29 offset:2560
    v_mfma_f32_16x16x32_bf16 v[164:167], v[96:99], v[100:103], v[164:167]
    v_mfma_f32_16x16x32_bf16 v[168:171], v[96:99], v[104:107], v[168:171]
    v_mfma_f32_16x16x32_bf16 v[172:175], v[96:99], v[108:111], v[172:175]
    v_mfma_f32_16x16x32_bf16 v[176:179], v[96:99], v[112:115], v[176:179]
    s_waitcnt lgkmcnt(0)
    s_barrier
    v_mfma_f32_16x16x32_bf16 v[116:119], v[52:55], v[68:71], v[116:119]
    ds_read_b128 v[84:87], v25 offset:24576
    v_mfma_f32_16x16x32_bf16 v[120:123], v[52:55], v[72:75], v[120:123]
    ds_read_b64_tr_b16 v[100:101], v27 offset:24576
    v_mfma_f32_16x16x32_bf16 v[124:127], v[52:55], v[76:79], v[124:127]
    ds_read_b64_tr_b16 v[102:103], v27 offset:26624
    v_mfma_f32_16x16x32_bf16 v[128:131], v[52:55], v[80:83], v[128:131]
    ds_read_b128 v[88:91], v25 offset:24832
    v_mfma_f32_16x16x32_bf16 v[132:135], v[56:59], v[68:71], v[132:135]
    ds_read_b64_tr_b16 v[104:105], v29 offset:24576
    v_mfma_f32_16x16x32_bf16 v[136:139], v[56:59], v[72:75], v[136:139]
    ds_read_b64_tr_b16 v[106:107], v29 offset:26624
    v_mfma_f32_16x16x32_bf16 v[140:143], v[56:59], v[76:79], v[140:143]
    ds_read_b128 v[92:95], v25 offset:25088
    v_mfma_f32_16x16x32_bf16 v[144:147], v[56:59], v[80:83], v[144:147]
    ds_read_b64_tr_b16 v[108:109], v27 offset:25088
    v_mfma_f32_16x16x32_bf16 v[148:151], v[60:63], v[68:71], v[148:151]
    ds_read_b64_tr_b16 v[110:111], v27 offset:27136
    v_mfma_f32_16x16x32_bf16 v[152:155], v[60:63], v[72:75], v[152:155]
    ds_read_b128 v[96:99], v25 offset:25344
    v_mfma_f32_16x16x32_bf16 v[156:159], v[60:63], v[76:79], v[156:159]
    ds_read_b64_tr_b16 v[112:113], v29 offset:25088
    v_mfma_f32_16x16x32_bf16 v[160:163], v[60:63], v[80:83], v[160:163]
    ds_read_b64_tr_b16 v[114:115], v29 offset:27136
    v_mfma_f32_16x16x32_bf16 v[164:167], v[64:67], v[68:71], v[164:167]
    v_mfma_f32_16x16x32_bf16 v[168:171], v[64:67], v[72:75], v[168:171]
    v_mfma_f32_16x16x32_bf16 v[172:175], v[64:67], v[76:79], v[172:175]
    v_mfma_f32_16x16x32_bf16 v[176:179], v[64:67], v[80:83], v[176:179]
    s_waitcnt lgkmcnt(0)
    v_mfma_f32_16x16x32_bf16 v[116:119], v[84:87], v[100:103], v[116:119]
    v_mfma_f32_16x16x32_bf16 v[120:123], v[84:87], v[104:107], v[120:123]
    v_mfma_f32_16x16x32_bf16 v[124:127], v[84:87], v[108:111], v[124:127]
    v_mfma_f32_16x16x32_bf16 v[128:131], v[84:87], v[112:115], v[128:131]
    v_mfma_f32_16x16x32_bf16 v[132:135], v[88:91], v[100:103], v[132:135]
    v_mfma_f32_16x16x32_bf16 v[136:139], v[88:91], v[104:107], v[136:139]
    v_mfma_f32_16x16x32_bf16 v[140:143], v[88:91], v[108:111], v[140:143]
    v_mfma_f32_16x16x32_bf16 v[144:147], v[88:91], v[112:115], v[144:147]
    v_mfma_f32_16x16x32_bf16 v[148:151], v[92:95], v[100:103], v[148:151]
    v_mfma_f32_16x16x32_bf16 v[152:155], v[92:95], v[104:107], v[152:155]
    v_mfma_f32_16x16x32_bf16 v[156:159], v[92:95], v[108:111], v[156:159]
    v_mfma_f32_16x16x32_bf16 v[160:163], v[92:95], v[112:115], v[160:163]
    v_mfma_f32_16x16x32_bf16 v[164:167], v[96:99], v[100:103], v[164:167]
    v_mfma_f32_16x16x32_bf16 v[168:171], v[96:99], v[104:107], v[168:171]
    v_mfma_f32_16x16x32_bf16 v[172:175], v[96:99], v[108:111], v[172:175]
    v_mfma_f32_16x16x32_bf16 v[176:179], v[96:99], v[112:115], v[176:179]
P3_Aend:
    s_nop 6
    v_pk_mul_f32 v[116:117], v[116:117], v[36:37] op_sel:[0,0] op_sel_hi:[1,0]
    v_pk_mul_f32 v[118:119], v[118:119], v[36:37] op_sel:[0,0] op_sel_hi:[1,0]
    v_pk_mul_f32 v[132:133], v[132:133], v[36:37] op_sel:[0,0] op_sel_hi:[1,0]
    v_pk_mul_f32 v[134:135], v[134:135], v[36:37] op_sel:[0,0] op_sel_hi:[1,0]
    v_pk_mul_f32 v[148:149], v[148:149], v[36:37] op_sel:[0,0] op_sel_hi:[1,0]
    v_pk_mul_f32 v[150:151], v[150:151], v[36:37] op_sel:[0,0] op_sel_hi:[1,0]
    v_pk_mul_f32 v[164:165], v[164:165], v[36:37] op_sel:[0,0] op_sel_hi:[1,0]
    v_pk_mul_f32 v[166:167], v[166:167], v[36:37] op_sel:[0,0] op_sel_hi:[1,0]
    v_pk_mul_f32 v[120:121], v[120:121], v[38:39] op_sel:[0,0] op_sel_hi:[1,0]
    v_pk_mul_f32 v[122:123], v[122:123], v[38:39] op_sel:[0,0] op_sel_hi:[1,0]
    v_pk_mul_f32 v[136:137], v[136:137], v[38:39] op_sel:[0,0] op_sel_hi:[1,0]
    v_pk_mul_f32 v[138:139], v[138:139], v[38:39] op_sel:[0,0] op_sel_hi:[1,0]
    v_pk_mul_f32 v[152:153], v[152:153], v[38:39] op_sel:[0,0] op_sel_hi:[1,0]
    v_pk_mul_f32 v[154:155], v[154:155], v[38:39] op_sel:[0,0] op_sel_hi:[1,0]
    v_pk_mul_f32 v[168:169], v[168:169], v[38:39] op_sel:[0,0] op_sel_hi:[1,0]
    v_pk_mul_f32 v[170:171], v[170:171], v[38:39] op_sel:[0,0] op_sel_hi:[1,0]
    v_pk_mul_f32 v[124:125], v[124:125], v[40:41] op_sel:[0,0] op_sel_hi:[1,0]
    v_pk_mul_f32 v[126:127], v[126:127], v[40:41] op_sel:[0,0] op_sel_hi:[1,0]
    v_pk_mul_f32 v[140:141], v[140:141], v[40:41] op_sel:[0,0] op_sel_hi:[1,0]
    v_pk_mul_f32 v[142:143], v[142:143], v[40:41] op_sel:[0,0] op_sel_hi:[1,0]
    v_pk_mul_f32 v[156:157], v[156:157], v[40:41] op_sel:[0,0] op_sel_hi:[1,0]
    v_pk_mul_f32 v[158:159], v[158:159], v[40:41] op_sel:[0,0] op_sel_hi:[1,0]
    v_pk_mul_f32 v[172:173], v[172:173], v[40:41] op_sel:[0,0] op_sel_hi:[1,0]
    v_pk_mul_f32 v[174:175], v[174:175], v[40:41] op_sel:[0,0] op_sel_hi:[1,0]
    v_pk_mul_f32 v[128:129], v[128:129], v[42:43] op_sel:[0,0] op_sel_hi:[1,0]
    v_pk_mul_f32 v[130:131], v[130:131], v[42:43] op_sel:[0,0] op_sel_hi:[1,0]
    v_pk_mul_f32 v[144:145], v[144:145], v[42:43] op_sel:[0,0] op_sel_hi:[1,0]
    v_pk_mul_f32 v[146:147], v[146:147], v[42:43] op_sel:[0,0] op_sel_hi:[1,0]
    v_pk_mul_f32 v[160:161], v[160:161], v[42:43] op_sel:[0,0] op_sel_hi:[1,0]
    v_pk_mul_f32 v[162:163], v[162:163], v[42:43] op_sel:[0,0] op_sel_hi:[1,0]
    v_pk_mul_f32 v[176:177], v[176:177], v[42:43] op_sel:[0,0] op_sel_hi:[1,0]
    v_pk_mul_f32 v[178:179], v[178:179], v[42:43] op_sel:[0,0] op_sel_hi:[1,0]
    s_branch P3_epi
P3_B:
    s_waitcnt vmcnt(0)
    s_bitcmp0_b32 s2, 0
    s_cselect_b32 s34, 1.0, 0
    v_lshlrev_b32 v44, 16, v44
    v_mul_f32 v44, v44, v36
    v_mul_f32 v44, s34, v44
    v_lshlrev_b32 v46, 16, v46
    v_mul_f32 v46, v46, v38
    v_mul_f32 v46, s34, v46
    v_lshlrev_b32 v48, 16, v48
    v_mul_f32 v48, v48, v40
    v_mul_f32 v48, s34, v48
    v_lshlrev_b32 v50, 16, v50
    v_mul_f32 v50, v50, v42
    v_mul_f32 v50, s34, v50
    v_pk_add_f32 v[180:181], v[44:45], v[2:3] op_sel_hi:[0,0]
    v_pk_add_f32 v[182:183], v[44:45], v[2:3] op_sel_hi:[0,0]
    v_pk_add_f32 v[184:185], v[46:47], v[2:3] op_sel_hi:[0,0]
    v_pk_add_f32 v[186:187], v[46:47], v[2:3] op_sel_hi:[0,0]
    v_pk_add_f32 v[188:189], v[48:49], v[2:3] op_sel_hi:[0,0]
    v_pk_add_f32 v[190:191], v[48:49], v[2:3] op_sel_hi:[0,0]
    v_pk_add_f32 v[192:193], v[50:51], v[2:3] op_sel_hi:[0,0]
    v_pk_add_f32 v[194:195], v[50:51], v[2:3] op_sel_hi:[0,0]
    v_pk_add_f32 v[196:197], v[44:45], v[2:3] op_sel_hi:[0,0]
    v_pk_add_f32 v[198:199], v[44:45], v[2:3] op_sel_hi:[0,0]
    v_pk_add_f32 v[200:201], v[46:47], v[2:3] op_sel_hi:[0,0]
    v_pk_add_f32 v[202:203], v[46:47], v[2:3] op_sel_hi:[0,0]
    v_pk_add_f32 v[204:205], v[48:49], v[2:3] op_sel_hi:[0,0]
    v_pk_add_f32 v[206:207], v[48:49], v[2:3] op_sel_hi:[0,0]
    v_pk_add_f32 v[208:209], v[50:51], v[2:3] op_sel_hi:[0,0]
    v_pk_add_f32 v[210:211], v[50:51], v[2:3] op_sel_hi:[0,0]
    v_pk_add_f32 v[212:213], v[44:45], v[2:3] op_sel_hi:[0,0]
    v_pk_add_f32 v[214:215], v[44:45], v[2:3] op_sel_hi:[0,0]
    v_pk_add_f32 v[216:217], v[46:47], v[2:3] op_sel_hi:[0,0]
    v_pk_add_f32 v[218:219], v[46:47], v[2:3] op_sel_hi:[0,0]
    v_pk_add_f32 v[220:221], v[48:49], v[2:3] op_sel_hi:[0,0]
    v_pk_add_f32 v[222:223], v[48:49], v[2:3] op_sel_hi:[0,0]
    v_pk_add_f32 v[224:225], v[50:51], v[2:3] op_sel_hi:[0,0]
    v_pk_add_f32 v[226:227], v[50:51], v[2:3] op_sel_hi:[0,0]
    v_pk_add_f32 v[228:229], v[44:45], v[2:3] op_sel_hi:[0,0]
    v_pk_add_f32 v[230:231], v[44:45], v[2:3] op_sel_hi:[0,0]
    v_pk_add_f32 v[232:233], v[46:47], v[2:3] op_sel_hi:[0,0]
    v_pk_add_f32 v[234:235], v[46:47], v[2:3] op_sel_hi:[0,0]
    v_pk_add_f32 v[236:237], v[48:49], v[2:3] op_sel_hi:[0,0]
    v_pk_add_f32 v[238:239], v[48:49], v[2:3] op_sel_hi:[0,0]
    v_pk_add_f32 v[240:241], v[50:51], v[2:3] op_sel_hi:[0,0]
    v_pk_add_f32 v[242:243], v[50:51], v[2:3] op_sel_hi:[0,0]
    s_cmp_ge_u32 s28, 4
    s_cbranch_scc1 P3_B1
    s_barrier
    s_mov_b32 s30, s3
    s_add_u32 s34, s30, s31
    s_and_b32 s34, s34, 3
    s_andn2_b32 s35, s30, 3
    s_or_b32 s34, s34, s35
    s_mul_i32 s32, s34, 131072
    s_mul_i32 s33, s34, 65536
    s_add_u32 s30, s30, 1
    s_add_u32 m0, s29, 0
    s_nop 0
    buffer_load_dwordx4 v245, s[20:23], s32 offen sc1 lds
    s_add_u32 m0, s29, 4096
    s_nop 0
    buffer_load_dwordx4 v17, s[20:23], s32 offen sc1 lds
    s_add_u32 m0, s29, 8192
    s_nop 0
    buffer_load_dwordx4 v18, s[20:23], s32 offen sc1 lds
    s_add_u32 m0, s29, 12288
    s_nop 0
    buffer_load_dwordx4 v19, s[20:23], s32 offen sc1 lds
    s_add_u32 s34, s30, s31
    s_and_b32 s34, s34, 3
    s_andn2_b32 s35, s30, 3
    s_or_b32 s34, s34, s35
    s_mul_i32 s32, s34, 131072
    s_mul_i32 s33, s34, 65536
    s_add_u32 s30, s30, 1
    s_add_u32 m0, s29, 24576
    s_nop 0
    buffer_load_dwordx4 v245, s[20:23], s32 offen sc1 lds
    s_add_u32 m0, s29, 28672
    s_nop 0
    buffer_load_dwordx4 v17, s[20:23], s32 offen sc1 lds
    s_add_u32 m0, s29, 32768
    s_nop 0
    buffer_load_dwordx4 v18, s[20:23], s32 offen sc1 lds
    s_add_u32 m0, s29, 36864
    s_nop 0
    buffer_load_dwordx4 v19, s[20:23], s32 offen sc1 lds
    s_add_u32 s34, s30, s31
    s_and_b32 s34, s34, 3
    s_andn2_b32 s35, s30, 3
    s_or_b32 s34, s34, s35
    s_mul_i32 s32, s34, 131072
    s_mul_i32 s33, s34, 65536
    s_add_u32 s30, s30, 1
    s_add_u32 m0, s29, 49152
    s_nop 0
    buffer_load_dwordx4 v245, s[20:23], s32 offen sc1 lds
    s_add_u32 m0, s29, 53248
    s_nop 0
    buffer_load_dwordx4 v17, s[20:23], s32 offen sc1 lds
    s_add_u32 m0, s29, 57344
    s_nop 0
    buffer_load_dwordx4 v18, s[20:23], s32 offen sc1 lds
    s_add_u32 m0, s29, 61440
    s_nop 0
    buffer_load_dwordx4 v19, s[20:23], s32 offen sc1 lds
    s_add_u32 s34, s30, s31
    s_and_b32 s34, s34, 3
    s_andn2_b32 s35, s30, 3
    s_or_b32 s34, s34, s35
    s_mul_i32 s32, s34, 131072
    s_mul_i32 s33, s34, 65536
    s_add_u32 s30, s30, 1
    s_add_u32 m0, s29, 73728
    s_nop 0
    buffer_load_dwordx4 v245, s[20:23], s32 offen sc1 lds
    s_add_u32 m0, s29, 77824
    s_nop 0
    buffer_load_dwordx4 v17, s[20:23], s32 offen sc1 lds
    s_add_u32 m0, s29, 81920
    s_nop 0
    buffer_load_dwordx4 v18, s[20:23], s32 offen sc1 lds
    s_add_u32 m0, s29, 86016
    s_nop 0
    buffer_load_dwordx4 v19, s[20:23], s32 offen sc1 lds
    s_waitcnt vmcnt(0)
    s_barrier
    ds_read_b128 v[52:55], v249 offset:0
    ds_read_b64_tr_b16 v[68:69], v251 offset:0
    ds_read_b64_tr_b16 v[70:71], v251 offset:2048
    ds_read_b128 v[56:59], v249 offset:256
    ds_read_b64_tr_b16 v[72:73], v34 offset:0
    ds_read_b64_tr_b16 v[74:75], v34 offset:2048
    ds_read_b128 v[60:63], v249 offset:512
    ds_read_b64_tr_b16 v[76:77], v251 offset:512
    ds_read_b64_tr_b16 v[78:79], v251 offset:2560
    ds_read_b128 v[64:67], v249 offset:768
    ds_read_b64_tr_b16 v[80:81], v34 offset:512
    ds_read_b64_tr_b16 v[82:83], v34 offset:2560
    s_mov_b32 s36, 3
L_p3_6892:
    s_waitcnt vmcnt(12) lgkmcnt(0)
    s_barrier
    v_mfma_f32_16x16x32_bf16 v[180:183], v[68:71], v[52:55], v[180:183]
    ds_read_b128 v[84:87], v249 offset:24576
    s_add_u32 s34, s30, s31
    s_and_b32 s34, s34, 3
    s_andn2_b32 s35, s30, 3
    s_or_b32 s34, s34, s35
    s_mul_i32 s32, s34, 131072
    s_mul_i32 s33, s34, 65536
    s_add_u32 s30, s30, 1
    s_add_u32 m0, s29, 0
    s_nop 0
    buffer_load_dwordx4 v245, s[20:23], s32 offen sc1 lds
    v_mfma_f32_16x16x32_bf16 v[196:199], v[72:75], v[52:55], v[196:199]
    ds_read_b64_tr_b16 v[100:101], v251 offset:24576
    v_mfma_f32_16x16x32_bf16 v[212:215], v[76:79], v[52:55], v[212:215]
    ds_read_b64_tr_b16 v[102:103], v251 offset:26624
    s_add_u32 m0, s29, 4096
    s_nop 0
    buffer_load_dwordx4 v17, s[20:23], s32 offen sc1 lds
    v_mfma_f32_16x16x32_bf16 v[228:231], v[80:83], v[52:55], v[228:231]
    ds_read_b128 v[88:91], v249 offset:24832
    v_mfma_f32_16x16x32_bf16 v[184:187], v[68:71], v[56:59], v[184:187]
    ds_read_b64_tr_b16 v[104:105], v34 offset:24576
    v_mfma_f32_16x16x32_bf16 v[200:203], v[72:75], v[56:59], v[200:203]
    ds_read_b64_tr_b16 v[106:107], v34 offset:26624
    s_add_u32 m0, s29, 8192
    s_nop 0
    buffer_load_dwordx4 v18, s[20:23], s32 offen sc1 lds
    v_mfma_f32_16x16x32_bf16 v[216:219], v[76:79], v[56:59], v[216:219]
    ds_read_b128 v[92:95], v249 offset:25088
    v_mfma_f32_16x16x32_bf16 v[232:235], v[80:83], v[56:59], v[232:235]
    ds_read_b64_tr_b16 v[108:109], v251 offset:25088
    v_mfma_f32_16x16x32_bf16 v[188:191], v[68:71], v[60:63], v[188:191]
    ds_read_b64_tr_b16 v[110:111], v251 offset:27136
    s_add_u32 m0, s29, 12288
    s_nop 0
    buffer_load_dwordx4 v19, s[20:23], s32 offen sc1 lds
    v_mfma_f32_16x16x32_bf16 v[204:207], v[72:75], v[60:63], v[204:207]
    ds_read_b128 v[96:99], v249 offset:25344
    v_mfma_f32_16x16x32_bf16 v[220:223], v[76:79], v[60:63], v[220:223]
    ds_read_b64_tr_b16 v[112:113], v34 offset:25088
    s_add_u32 m0, s29, 16384
    s_nop 0
    buffer_load_dwordx4 v247, s[24:27], s33 offen lds
    v_mfma_f32_16x16x32_bf16 v[236:239], v[80:83], v[60:63], v[236:239]
    ds_read_b64_tr_b16 v[114:115], v34 offset:27136
    v_mfma_f32_16x16x32_bf16 v[192:195], v[68:71], v[64:67], v[192:195]
    v_mfma_f32_16x16x32_bf16 v[208:211], v[72:75], v[64:67], v[208:211]
    s_add_u32 m0, s29, 20480
    s_nop 0
    buffer_load_dwordx4 v21, s[24:27], s33 offen lds
    v_mfma_f32_16x16x32_bf16 v[224:227], v[76:79], v[64:67], v[224:227]
    v_mfma_f32_16x16x32_bf16 v[240:243], v[80:83], v[64:67], v[240:243]
    s_waitcnt vmcnt(12) lgkmcnt(0)
    s_barrier
    v_mfma_f32_16x16x32_bf16 v[180:183], v[100:103], v[84:87], v[180:183]
    ds_read_b128 v[52:55], v31 offset:0
    s_add_u32 s34, s30, s31
    s_and_b32 s34, s34, 3
    s_andn2_b32 s35, s30, 3
    s_or_b32 s34, s34, s35
    s_mul_i32 s32, s34, 131072
    s_mul_i32 s33, s34, 65536
    s_add_u32 s30, s30, 1
    s_add_u32 m0, s29, 24576
    s_nop 0
    buffer_load_dwordx4 v245, s[20:23], s32 offen sc1 lds
    v_mfma_f32_16x16x32_bf16 v[196:199], v[104:107], v[84:87], v[196:199]
    ds_read_b64_tr_b16 v[68:69], v33 offset:0
    v_mfma_f32_16x16x32_bf16 v[212:215], v[108:111], v[84:87], v[212:215]
    ds_read_b64_tr_b16 v[70:71], v33 offset:2048
    s_add_u32 m0, s29, 28672
    s_nop 0
    buffer_load_dwordx4 v17, s[20:23], s32 offen sc1 lds
    v_mfma_f32_16x16x32_bf16 v[228:231], v[112:115], v[84:87], v[228:231]
    ds_read_b128 v[56:59], v31 offset:256
    v_mfma_f32_16x16x32_bf16 v[184:187], v[100:103], v[88:91], v[184:187]
    ds_read_b64_tr_b16 v[72:73], v35 offset:0
    v_mfma_f32_16x16x32_bf16 v[200:203], v[104:107], v[88:91], v[200:203]
    ds_read_b64_tr_b16 v[74:75], v35 offset:2048
    s_add_u32 m0, s29, 32768
    s_nop 0
    buffer_load_dwordx4 v18, s[20:23], s32 offen sc1 lds
    v_mfma_f32_16x16x32_bf16 v[216:219], v[108:111], v[88:91], v[216:219]
    ds_read_b128 v[60:63], v31 offset:512
    v_mfma_f32_16x16x32_bf16 v[232:235], v[112:115], v[88:91], v[232:235]
    ds_read_b64_tr_b16 v[76:77], v33 offset:512
    v_mfma_f32_16x16x32_bf16 v[188:191], v[100:103], v[92:95], v[188:191]
    ds_read_b64_tr_b16 v[78:79], v33 offset:2560
    s_add_u32 m0, s29, 36864
    s_nop 0
    buffer_load_dwordx4 v19, s[20:23], s32 offen sc1 lds
    v_mfma_f32_16x16x32_bf16 v[204:207], v[104:107], v[92:95], v[204:207]
    ds_read_b128 v[64:67], v31 offset:768
    v_mfma_f32_16x16x32_bf16 v[220:223], v[108:111], v[92:95], v[220:223]
    ds_read_b64_tr_b16 v[80:81], v35 offset:512
    s_add_u32 m0, s29, 40960
    s_nop 0
    buffer_load_dwordx4 v247, s[24:27], s33 offen lds
    v_mfma_f32_16x16x32_bf16 v[236:239], v[112:115], v[92:95], v[236:239]
    ds_read_b64_tr_b16 v[82:83], v35 offset:2560
    v_mfma_f32_16x16x32_bf16 v[192:195], v[100:103], v[96:99], v[192:195]
    v_mfma_f32_16x16x32_bf16 v[208:211], v[104:107], v[96:99], v[208:211]
    s_add_u32 m0, s29, 45056
    s_nop 0
    buffer_load_dwordx4 v21, s[24:27], s33 offen lds
    v_mfma_f32_16x16x32_bf16 v[224:227], v[108:111], v[96:99], v[224:227]
    v_mfma_f32_16x16x32_bf16 v[240:243], v[112:115], v[96:99], v[240:243]
    s_waitcnt vmcnt(12) lgkmcnt(0)
    s_barrier
    v_mfma_f32_16x16x32_bf16 v[180:183], v[68:71], v[52:55], v[180:183]
    ds_read_b128 v[84:87], v31 offset:24576
    s_add_u32 s34, s30, s31
    s_and_b32 s34, s34, 3
    s_andn2_b32 s35, s30, 3
    s_or_b32 s34, s34, s35
    s_mul_i32 s32, s34, 131072
    s_mul_i32 s33, s34, 65536
    s_add_u32 s30, s30, 1
    s_add_u32 m0, s29, 49152
    s_nop 0
    buffer_load_dwordx4 v245, s[20:23], s32 offen sc1 lds
    v_mfma_f32_16x16x32_bf16 v[196:199], v[72:75], v[52:55], v[196:199]
    ds_read_b64_tr_b16 v[100:101], v33 offset:24576
    v_mfma_f32_16x16x32_bf16 v[212:215], v[76:79], v[52:55], v[212:215]
    ds_read_b64_tr_b16 v[102:103], v33 offset:26624
    s_add_u32 m0, s29, 53248
    s_nop 0
    buffer_load_dwordx4 v17, s[20:23], s32 offen sc1 lds
    v_mfma_f32_16x16x32_bf16 v[228:231], v[80:83], v[52:55], v[228:231]
    ds_read_b128 v[88:91], v31 offset:24832
    v_mfma_f32_16x16x32_bf16 v[184:187], v[68:71], v[56:59], v[184:187]
    ds_read_b64_tr_b16 v[104:105], v35 offset:24576
    v_mfma_f32_16x16x32_bf16 v[200:203], v[72:75], v[56:59], v[200:203]
    ds_read_b64_tr_b16 v[106:107], v35 offset:26624
    s_add_u32 m0, s29, 57344
    s_nop 0
    buffer_load_dwordx4 v18, s[20:23], s32 offen sc1 lds
    v_mfma_f32_16x16x32_bf16 v[216:219], v[76:79], v[56:59], v[216:219]
    ds_read_b128 v[92:95], v31 offset:25088
    v_mfma_f32_16x16x32_bf16 v[232:235], v[80:83], v[56:59], v[232:235]
    ds_read_b64_tr_b16 v[108:109], v33 offset:25088
    v_mfma_f32_16x16x32_bf16 v[188:191], v[68:71], v[60:63], v[188:191]
    ds_read_b64_tr_b16 v[110:111], v33 offset:27136
    s_add_u32 m0, s29, 61440
    s_nop 0
    buffer_load_dwordx4 v19, s[20:23], s32 offen sc1 lds
    v_mfma_f32_16x16x32_bf16 v[204:207], v[72:75], v[60:63], v[204:207]
    ds_read_b128 v[96:99], v31 offset:25344
    v_mfma_f32_16x16x32_bf16 v[220:223], v[76:79], v[60:63], v[220:223]
    ds_read_b64_tr_b16 v[112:113], v35 offset:25088
    s_add_u32 m0, s29, 65536
    s_nop 0
    buffer_load_dwordx4 v247, s[24:27], s33 offen lds
    v_mfma_f32_16x16x32_bf16 v[236:239], v[80:83], v[60:63], v[236:239]
    ds_read_b64_tr_b16 v[114:115], v35 offset:27136
    v_mfma_f32_16x16x32_bf16 v[192:195], v[68:71], v[64:67], v[192:195]
    v_mfma_f32_16x16x32_bf16 v[208:211], v[72:75], v[64:67], v[208:211]
    s_add_u32 m0, s29, 69632
    s_nop 0
    buffer_load_dwordx4 v21, s[24:27], s33 offen lds
    v_mfma_f32_16x16x32_bf16 v[224:227], v[76:79], v[64:67], v[224:227]
    v_mfma_f32_16x16x32_bf16 v[240:243], v[80:83], v[64:67], v[240:243]
    s_waitcnt vmcnt(12) lgkmcnt(0)
    s_barrier
    v_mfma_f32_16x16x32_bf16 v[180:183], v[100:103], v[84:87], v[180:183]
    ds_read_b128 v[52:55], v249 offset:0
    s_add_u32 s34, s30, s31
    s_and_b32 s34, s34, 3
    s_andn2_b32 s35, s30, 3
    s_or_b32 s34, s34, s35
    s_mul_i32 s32, s34, 131072
    s_mul_i32 s33, s34, 65536
    s_add_u32 s30, s30, 1
    s_add_u32 m0, s29, 73728
    s_nop 0
    buffer_load_dwordx4 v245, s[20:23], s32 offen sc1 lds
    v_mfma_f32_16x16x32_bf16 v[196:199], v[104:107], v[84:87], v[196:199]
    ds_read_b64_tr_b16 v[68:69], v251 offset:0
    v_mfma_f32_16x16x32_bf16 v[212:215], v[108:111], v[84:87], v[212:215]
    ds_read_b64_tr_b16 v[70:71], v251 offset:2048
    s_add_u32 m0, s29, 77824
    s_nop 0
    buffer_load_dwordx4 v17, s[20:23], s32 offen sc1 lds
    v_mfma_f32_16x16x32_bf16 v[228:231], v[112:115], v[84:87], v[228:231]
    ds_read_b128 v[56:59], v249 offset:256
    v_mfma_f32_16x16x32_bf16 v[184:187], v[100:103], v[88:91], v[184:187]
    ds_read_b64_tr_b16 v[72:73], v34 offset:0
    v_mfma_f32_16x16x32_bf16 v[200:203], v[104:107], v[88:91], v[200:203]
    ds_read_b64_tr_b16 v[74:75], v34 offset:2048
    s_add_u32 m0, s29, 81920
    s_nop 0
    buffer_load_dwordx4 v18, s[20:23], s32 offen sc1 lds
    v_mfma_f32_16x16x32_bf16 v[216:219], v[108:111], v[88:91], v[216:219]
    ds_read_b128 v[60:63], v249 offset:512
    v_mfma_f32_16x16x32_bf16 v[232:235], v[112:115], v[88:91], v[232:235]
    ds_read_b64_tr_b16 v[76:77], v251 offset:512
    v_mfma_f32_16x16x32_bf16 v[188:191], v[100:103], v[92:95], v[188:191]
    ds_read_b64_tr_b16 v[78:79], v251 offset:2560
    s_add_u32 m0, s29, 86016
    s_nop 0
    buffer_load_dwordx4 v19, s[20:23], s32 offen sc1 lds
    v_mfma_f32_16x16x32_bf16 v[204:207], v[104:107], v[92:95], v[204:207]
    ds_read_b128 v[64:67], v249 offset:768
    v_mfma_f32_16x16x32_bf16 v[220:223], v[108:111], v[92:95], v[220:223]
    ds_read_b64_tr_b16 v[80:81], v34 offset:512
    s_add_u32 m0, s29, 90112
    s_nop 0
    buffer_load_dwordx4 v247, s[24:27], s33 offen lds
    v_mfma_f32_16x16x32_bf16 v[236:239], v[112:115], v[92:95], v[236:239]
    ds_read_b64_tr_b16 v[82:83], v34 offset:2560
    v_mfma_f32_16x16x32_bf16 v[192:195], v[100:103], v[96:99], v[192:195]
    v_mfma_f32_16x16x32_bf16 v[208:211], v[104:107], v[96:99], v[208:211]
    s_add_u32 m0, s29, 94208
    s_nop 0
    buffer_load_dwordx4 v21, s[24:27], s33 offen lds
    v_mfma_f32_16x16x32_bf16 v[224:227], v[108:111], v[96:99], v[224:227]
    v_mfma_f32_16x16x32_bf16 v[240:243], v[112:115], v[96:99], v[240:243]
    s_sub_u32 s36, s36, 1
    s_cmp_lg_u32 s36, 0
    s_cbranch_scc1 L_p3_6892
    s_mov_b32 s30, s43
    s_waitcnt vmcnt(12) lgkmcnt(0)
    s_barrier
    v_mfma_f32_16x16x32_bf16 v[180:183], v[68:71], v[52:55], v[180:183]
    ds_read_b128 v[84:87], v249 offset:24576
    s_add_u32 s34, s30, s31
    s_and_b32 s34, s34, 3
    s_andn2_b32 s35, s30, 3
    s_or_b32 s34, s34, s35
    s_mul_i32 s32, s34, 65536
    s_mul_i32 s33, s34, 131072
    s_add_u32 s30, s30, 1
    s_add_u32 m0, s29, 0
    s_nop 0
    buffer_load_dwordx4 v244, s[8:11], s32 offen sc1 lds
    v_mfma_f32_16x16x32_bf16 v[196:199], v[72:75], v[52:55], v[196:199]
    ds_read_b64_tr_b16 v[100:101], v251 offset:24576
    v_mfma_f32_16x16x32_bf16 v[212:215], v[76:79], v[52:55], v[212:215]
    ds_read_b64_tr_b16 v[102:103], v251 offset:26624
    s_add_u32 m0, s29, 4096
    s_nop 0
    buffer_load_dwordx4 v9, s[8:11], s32 offen sc1 lds
    v_mfma_f32_16x16x32_bf16 v[228:231], v[80:83], v[52:55], v[228:231]
    ds_read_b128 v[88:91], v249 offset:24832
    v_mfma_f32_16x16x32_bf16 v[184:187], v[68:71], v[56:59], v[184:187]
    ds_read_b64_tr_b16 v[104:105], v34 offset:24576
    v_mfma_f32_16x16x32_bf16 v[200:203], v[72:75], v[56:59], v[200:203]
    ds_read_b64_tr_b16 v[106:107], v34 offset:26624
    s_add_u32 m0, s29, 8192
    s_nop 0
    buffer_load_dwordx4 v246, s[12:15], s33 offen lds
    v_mfma_f32_16x16x32_bf16 v[216:219], v[76:79], v[56:59], v[216:219]
    ds_read_b128 v[92:95], v249 offset:25088
    v_mfma_f32_16x16x32_bf16 v[232:235], v[80:83], v[56:59], v[232:235]
    ds_read_b64_tr_b16 v[108:109], v251 offset:25088
    v_mfma_f32_16x16x32_bf16 v[188:191], v[68:71], v[60:63], v[188:191]
    ds_read_b64_tr_b16 v[110:111], v251 offset:27136
    s_add_u32 m0, s29, 12288
    s_nop 0
    buffer_load_dwordx4 v13, s[12:15], s33 offen lds
    v_mfma_f32_16x16x32_bf16 v[204:207], v[72:75], v[60:63], v[204:207]
    ds_read_b128 v[96:99], v249 offset:25344
    v_mfma_f32_16x16x32_bf16 v[220:223], v[76:79], v[60:63], v[220:223]
    ds_read_b64_tr_b16 v[112:113], v34 offset:25088
    s_add_u32 m0, s29, 16384
    s_nop 0
    buffer_load_dwordx4 v14, s[12:15], s33 offen lds
    v_mfma_f32_16x16x32_bf16 v[236:239], v[80:83], v[60:63], v[236:239]
    ds_read_b64_tr_b16 v[114:115], v34 offset:27136
    v_mfma_f32_16x16x32_bf16 v[192:195], v[68:71], v[64:67], v[192:195]
    v_mfma_f32_16x16x32_bf16 v[208:211], v[72:75], v[64:67], v[208:211]
    s_add_u32 m0, s29, 20480
    s_nop 0
    buffer_load_dwordx4 v15, s[12:15], s33 offen lds
    v_mfma_f32_16x16x32_bf16 v[224:227], v[76:79], v[64:67], v[224:227]
    v_mfma_f32_16x16x32_bf16 v[240:243], v[80:83], v[64:67], v[240:243]
    s_waitcnt vmcnt(12) lgkmcnt(0)
    s_barrier
    v_mfma_f32_16x16x32_bf16 v[180:183], v[100:103], v[84:87], v[180:183]
    ds_read_b128 v[52:55], v31 offset:0
    s_add_u32 s34, s30, s31
    s_and_b32 s34, s34, 3
    s_andn2_b32 s35, s30, 3
    s_or_b32 s34, s34, s35
    s_mul_i32 s32, s34, 65536
    s_mul_i32 s33, s34, 131072
    s_add_u32 s30, s30, 1
    s_add_u32 m0, s29, 24576
    s_nop 0
    buffer_load_dwordx4 v244, s[8:11], s32 offen sc1 lds
    v_mfma_f32_16x16x32_bf16 v[196:199], v[104:107], v[84:87], v[196:199]
    ds_read_b64_tr_b16 v[68:69], v33 offset:0
    v_mfma_f32_16x16x32_bf16 v[212:215], v[108:111], v[84:87], v[212:215]
    ds_read_b64_tr_b16 v[70:71], v33 offset:2048
    s_add_u32 m0, s29, 28672
    s_nop 0
    buffer_load_dwordx4 v9, s[8:11], s32 offen sc1 lds
    v_mfma_f32_16x16x32_bf16 v[228:231], v[112:115], v[84:87], v[228:231]
    ds_read_b128 v[56:59], v31 offset:256
    v_mfma_f32_16x16x32_bf16 v[184:187], v[100:103], v[88:91], v[184:187]
    ds_read_b64_tr_b16 v[72:73], v35 offset:0
    v_mfma_f32_16x16x32_bf16 v[200:203], v[104:107], v[88:91], v[200:203]
    ds_read_b64_tr_b16 v[74:75], v35 offset:2048
    s_add_u32 m0, s29, 32768
    s_nop 0
    buffer_load_dwordx4 v246, s[12:15], s33 offen lds
    v_mfma_f32_16x16x32_bf16 v[216:219], v[108:111], v[88:91], v[216:219]
    ds_read_b128 v[60:63], v31 offset:512
    v_mfma_f32_16x16x32_bf16 v[232:235], v[112:115], v[88:91], v[232:235]
    ds_read_b64_tr_b16 v[76:77], v33 offset:512
    v_mfma_f32_16x16x32_bf16 v[188:191], v[100:103], v[92:95], v[188:191]
    ds_read_b64_tr_b16 v[78:79], v33 offset:2560
    s_add_u32 m0, s29, 36864
    s_nop 0
    buffer_load_dwordx4 v13, s[12:15], s33 offen lds
    v_mfma_f32_16x16x32_bf16 v[204:207], v[104:107], v[92:95], v[204:207]
    ds_read_b128 v[64:67], v31 offset:768
    v_mfma_f32_16x16x32_bf16 v[220:223], v[108:111], v[92:95], v[220:223]
    ds_read_b64_tr_b16 v[80:81], v35 offset:512
    s_add_u32 m0, s29, 40960
    s_nop 0
    buffer_load_dwordx4 v14, s[12:15], s33 offen lds
    v_mfma_f32_16x16x32_bf16 v[236:239], v[112:115], v[92:95], v[236:239]
    ds_read_b64_tr_b16 v[82:83], v35 offset:2560
    v_mfma_f32_16x16x32_bf16 v[192:195], v[100:103], v[96:99], v[192:195]
    v_mfma_f32_16x16x32_bf16 v[208:211], v[104:107], v[96:99], v[208:211]
    s_add_u32 m0, s29, 45056
    s_nop 0
    buffer_load_dwordx4 v15, s[12:15], s33 offen lds
    v_mfma_f32_16x16x32_bf16 v[224:227], v[108:111], v[96:99], v[224:227]
    v_mfma_f32_16x16x32_bf16 v[240:243], v[112:115], v[96:99], v[240:243]
    s_waitcnt vmcnt(12) lgkmcnt(0)
    s_barrier
    v_mfma_f32_16x16x32_bf16 v[180:183], v[68:71], v[52:55], v[180:183]
    ds_read_b128 v[84:87], v31 offset:24576
    s_add_u32 s34, s30, s31
    s_and_b32 s34, s34, 3
    s_andn2_b32 s35, s30, 3
    s_or_b32 s34, s34, s35
    s_mul_i32 s32, s34, 65536
    s_mul_i32 s33, s34, 131072
    s_add_u32 s30, s30, 1
    s_add_u32 m0, s29, 49152
    s_nop 0
    buffer_load_dwordx4 v244, s[8:11], s32 offen sc1 lds
    v_mfma_f32_16x16x32_bf16 v[196:199], v[72:75], v[52:55], v[196:199]
    ds_read_b64_tr_b16 v[100:101], v33 offset:24576
    v_mfma_f32_16x16x32_bf16 v[212:215], v[76:79], v[52:55], v[212:215]
    ds_read_b64_tr_b16 v[102:103], v33 offset:26624
    s_add_u32 m0, s29, 53248
    s_nop 0
    buffer_load_dwordx4 v9, s[8:11], s32 offen sc1 lds
    v_mfma_f32_16x16x32_bf16 v[228:231], v[80:83], v[52:55], v[228:231]
    ds_read_b128 v[88:91], v31 offset:24832
    v_mfma_f32_16x16x32_bf16 v[184:187], v[68:71], v[56:59], v[184:187]
    ds_read_b64_tr_b16 v[104:105], v35 offset:24576
    v_mfma_f32_16x16x32_bf16 v[200:203], v[72:75], v[56:59], v[200:203]
    ds_read_b64_tr_b16 v[106:107], v35 offset:26624
    s_add_u32 m0, s29, 57344
    s_nop 0
    buffer_load_dwordx4 v246, s[12:15], s33 offen lds
    v_mfma_f32_16x16x32_bf16 v[216:219], v[76:79], v[56:59], v[216:219]
    ds_read_b128 v[92:95], v31 offset:25088
    v_mfma_f32_16x16x32_bf16 v[232:235], v[80:83], v[56:59], v[232:235]
    ds_read_b64_tr_b16 v[108:109], v33 offset:25088
    v_mfma_f32_16x16x32_bf16 v[188:191], v[68:71], v[60:63], v[188:191]
    ds_read_b64_tr_b16 v[110:111], v33 offset:27136
    s_add_u32 m0, s29, 61440
    s_nop 0
    buffer_load_dwordx4 v13, s[12:15], s33 offen lds
    v_mfma_f32_16x16x32_bf16 v[204:207], v[72:75], v[60:63], v[204:207]
    ds_read_b128 v[96:99], v31 offset:25344
    v_mfma_f32_16x16x32_bf16 v[220:223], v[76:79], v[60:63], v[220:223]
    ds_read_b64_tr_b16 v[112:113], v35 offset:25088
    s_add_u32 m0, s29, 65536
    s_nop 0
    buffer_load_dwordx4 v14, s[12:15], s33 offen lds
    v_mfma_f32_16x16x32_bf16 v[236:239], v[80:83], v[60:63], v[236:239]
    ds_read_b64_tr_b16 v[114:115], v35 offset:27136
    v_mfma_f32_16x16x32_bf16 v[192:195], v[68:71], v[64:67], v[192:195]
    v_mfma_f32_16x16x32_bf16 v[208:211], v[72:75], v[64:67], v[208:211]
    s_add_u32 m0, s29, 69632
    s_nop 0
    buffer_load_dwordx4 v15, s[12:15], s33 offen lds
    v_mfma_f32_16x16x32_bf16 v[224:227], v[76:79], v[64:67], v[224:227]
    v_mfma_f32_16x16x32_bf16 v[240:243], v[80:83], v[64:67], v[240:243]
    s_waitcnt vmcnt(12) lgkmcnt(0)
    s_barrier
    v_mfma_f32_16x16x32_bf16 v[180:183], v[100:103], v[84:87], v[180:183]
    ds_read_b128 v[52:55], v248 offset:0
    s_add_u32 s34, s30, s31
    s_and_b32 s34, s34, 3
    s_andn2_b32 s35, s30, 3
    s_or_b32 s34, s34, s35
    s_mul_i32 s32, s34, 65536
    s_mul_i32 s33, s34, 131072
    s_add_u32 s30, s30, 1
    s_add_u32 m0, s29, 73728
    s_nop 0
    buffer_load_dwordx4 v244, s[8:11], s32 offen sc1 lds
    v_mfma_f32_16x16x32_bf16 v[196:199], v[104:107], v[84:87], v[196:199]
    ds_read_b64_tr_b16 v[68:69], v250 offset:0
    v_mfma_f32_16x16x32_bf16 v[212:215], v[108:111], v[84:87], v[212:215]
    ds_read_b64_tr_b16 v[70:71], v250 offset:2048
    s_add_u32 m0, s29, 77824
    s_nop 0
    buffer_load_dwordx4 v9, s[8:11], s32 offen sc1 lds
    v_mfma_f32_16x16x32_bf16 v[228:231], v[112:115], v[84:87], v[228:231]
    ds_read_b128 v[56:59], v248 offset:256
    v_mfma_f32_16x16x32_bf16 v[184:187], v[100:103], v[88:91], v[184:187]
    ds_read_b64_tr_b16 v[72:73], v28 offset:0
    v_mfma_f32_16x16x32_bf16 v[200:203], v[104:107], v[88:91], v[200:203]
    ds_read_b64_tr_b16 v[74:75], v28 offset:2048
    s_add_u32 m0, s29, 81920
    s_nop 0
    buffer_load_dwordx4 v246, s[12:15], s33 offen lds
    v_mfma_f32_16x16x32_bf16 v[216:219], v[108:111], v[88:91], v[216:219]
    ds_read_b128 v[60:63], v248 offset:512
    v_mfma_f32_16x16x32_bf16 v[232:235], v[112:115], v[88:91], v[232:235]
    ds_read_b64_tr_b16 v[76:77], v250 offset:512
    v_mfma_f32_16x16x32_bf16 v[188:191], v[100:103], v[92:95], v[188:191]
    ds_read_b64_tr_b16 v[78:79], v250 offset:2560
    s_add_u32 m0, s29, 86016
    s_nop 0
    buffer_load_dwordx4 v13, s[12:15], s33 offen lds
    v_mfma_f32_16x16x32_bf16 v[204:207], v[104:107], v[92:95], v[204:207]
    ds_read_b128 v[64:67], v248 offset:768
    v_mfma_f32_16x16x32_bf16 v[220:223], v[108:111], v[92:95], v[220:223]
    ds_read_b64_tr_b16 v[80:81], v28 offset:512
    s_add_u32 m0, s29, 90112
    s_nop 0
    buffer_load_dwordx4 v14, s[12:15], s33 offen lds
    v_mfma_f32_16x16x32_bf16 v[236:239], v[112:115], v[92:95], v[236:239]
    ds_read_b64_tr_b16 v[82:83], v28 offset:2560
    v_mfma_f32_16x16x32_bf16 v[192:195], v[100:103], v[96:99], v[192:195]
    v_mfma_f32_16x16x32_bf16 v[208:211], v[104:107], v[96:99], v[208:211]
    s_add_u32 m0, s29, 94208
    s_nop 0
    buffer_load_dwordx4 v15, s[12:15], s33 offen lds
    v_mfma_f32_16x16x32_bf16 v[224:227], v[108:111], v[96:99], v[224:227]
    v_mfma_f32_16x16x32_bf16 v[240:243], v[112:115], v[96:99], v[240:243]
    s_mov_b32 s36, 5
L_p3_7338:
    s_waitcnt vmcnt(12) lgkmcnt(0)
    s_barrier
    v_mfma_f32_16x16x32_bf16 v[116:119], v[52:55], v[68:71], v[116:119]
    ds_read_b128 v[84:87], v248 offset:24576
    s_add_u32 s34, s30, s31
    s_and_b32 s34, s34, 3
    s_andn2_b32 s35, s30, 3
    s_or_b32 s34, s34, s35
    s_mul_i32 s32, s34, 65536
    s_mul_i32 s33, s34, 131072
    s_add_u32 s30, s30, 1
    s_add_u32 m0, s29, 0
    s_nop 0
    buffer_load_dwordx4 v244, s[8:11], s32 offen sc1 lds
    v_mfma_f32_16x16x32_bf16 v[120:123], v[52:55], v[72:75], v[120:123]
    ds_read_b64_tr_b16 v[100:101], v250 offset:24576
    v_mfma_f32_16x16x32_bf16 v[124:127], v[52:55], v[76:79], v[124:127]
    ds_read_b64_tr_b16 v[102:103], v250 offset:26624
    s_add_u32 m0, s29, 4096
    s_nop 0
    buffer_load_dwordx4 v9, s[8:11], s32 offen sc1 lds
    v_mfma_f32_16x16x32_bf16 v[128:131], v[52:55], v[80:83], v[128:131]
    ds_read_b128 v[88:91], v248 offset:24832
    v_mfma_f32_16x16x32_bf16 v[132:135], v[56:59], v[68:71], v[132:135]
    ds_read_b64_tr_b16 v[104:105], v28 offset:24576
    v_mfma_f32_16x16x32_bf16 v[136:139], v[56:59], v[72:75], v[136:139]
    ds_read_b64_tr_b16 v[106:107], v28 offset:26624
    s_add_u32 m0, s29, 8192
    s_nop 0
    buffer_load_dwordx4 v246, s[12:15], s33 offen lds
    v_mfma_f32_16x16x32_bf16 v[140:143], v[56:59], v[76:79], v[140:143]
    ds_read_b128 v[92:95], v248 offset:25088
    v_mfma_f32_16x16x32_bf16 v[144:147], v[56:59], v[80:83], v[144:147]
    ds_read_b64_tr_b16 v[108:109], v250 offset:25088
    v_mfma_f32_16x16x32_bf16 v[148:151], v[60:63], v[68:71], v[148:151]
    ds_read_b64_tr_b16 v[110:111], v250 offset:27136
    s_add_u32 m0, s29, 12288
    s_nop 0
    buffer_load_dwordx4 v13, s[12:15], s33 offen lds
    v_mfma_f32_16x16x32_bf16 v[152:155], v[60:63], v[72:75], v[152:155]
    ds_read_b128 v[96:99], v248 offset:25344
    v_mfma_f32_16x16x32_bf16 v[156:159], v[60:63], v[76:79], v[156:159]
    ds_read_b64_tr_b16 v[112:113], v28 offset:25088
    s_add_u32 m0, s29, 16384
    s_nop 0
    buffer_load_dwordx4 v14, s[12:15], s33 offen lds
    v_mfma_f32_16x16x32_bf16 v[160:163], v[60:63], v[80:83], v[160:163]
    ds_read_b64_tr_b16 v[114:115], v28 offset:27136
    v_mfma_f32_16x16x32_bf16 v[164:167], v[64:67], v[68:71], v[164:167]
    v_mfma_f32_16x16x32_bf16 v[168:171], v[64:67], v[72:75], v[168:171]
    s_add_u32 m0, s29, 20480
    s_nop 0
    buffer_load_dwordx4 v15, s[12:15], s33 offen lds
    v_mfma_f32_16x16x32_bf16 v[172:175], v[64:67], v[76:79], v[172:175]
    v_mfma_f32_16x16x32_bf16 v[176:179], v[64:67], v[80:83], v[176:179]
    s_waitcnt vmcnt(12) lgkmcnt(0)
    s_barrier
    v_mfma_f32_16x16x32_bf16 v[116:119], v[84:87], v[100:103], v[116:119]
    ds_read_b128 v[52:55], v25 offset:0
    s_add_u32 s34, s30, s31
    s_and_b32 s34, s34, 3
    s_andn2_b32 s35, s30, 3
    s_or_b32 s34, s34, s35
    s_mul_i32 s32, s34, 65536
    s_mul_i32 s33, s34, 131072
    s_add_u32 s30, s30, 1
    s_add_u32 m0, s29, 24576
    s_nop 0
    buffer_load_dwordx4 v244, s[8:11], s32 offen sc1 lds
    v_mfma_f32_16x16x32_bf16 v[120:123], v[84:87], v[104:107], v[120:123]
    ds_read_b64_tr_b16 v[68:69], v27 offset:0
    v_mfma_f32_16x16x32_bf16 v[124:127], v[84:87], v[108:111], v[124:127]
    ds_read_b64_tr_b16 v[70:71], v27 offset:2048
    s_add_u32 m0, s29, 28672
    s_nop 0
    buffer_load_dwordx4 v9, s[8:11], s32 offen sc1 lds
    v_mfma_f32_16x16x32_bf16 v[128:131], v[84:87], v[112:115], v[128:131]
    ds_read_b128 v[56:59], v25 offset:256
    v_mfma_f32_16x16x32_bf16 v[132:135], v[88:91], v[100:103], v[132:135]
    ds_read_b64_tr_b16 v[72:73], v29 offset:0
    v_mfma_f32_16x16x32_bf16 v[136:139], v[88:91], v[104:107], v[136:139]
    ds_read_b64_tr_b16 v[74:75], v29 offset:2048
    s_add_u32 m0, s29, 32768
    s_nop 0
    buffer_load_dwordx4 v246, s[12:15], s33 offen lds
    v_mfma_f32_16x16x32_bf16 v[140:143], v[88:91], v[108:111], v[140:143]
    ds_read_b128 v[60:63], v25 offset:512
    v_mfma_f32_16x16x32_bf16 v[144:147], v[88:91], v[112:115], v[144:147]
    ds_read_b64_tr_b16 v[76:77], v27 offset:512
    v_mfma_f32_16x16x32_bf16 v[148:151], v[92:95], v[100:103], v[148:151]
    ds_read_b64_tr_b16 v[78:79], v27 offset:2560
    s_add_u32 m0, s29, 36864
    s_nop 0
    buffer_load_dwordx4 v13, s[12:15], s33 offen lds
    v_mfma_f32_16x16x32_bf16 v[152:155], v[92:95], v[104:107], v[152:155]
    ds_read_b128 v[64:67], v25 offset:768
    v_mfma_f32_16x16x32_bf16 v[156:159], v[92:95], v[108:111], v[156:159]
    ds_read_b64_tr_b16 v[80:81], v29 offset:512
    s_add_u32 m0, s29, 40960
    s_nop 0
    buffer_load_dwordx4 v14, s[12:15], s33 offen lds
    v_mfma_f32_16x16x32_bf16 v[160:163], v[92:95], v[112:115], v[160:163]
    ds_read_b64_tr_b16 v[82:83], v29 offset:2560
    v_mfma_f32_16x16x32_bf16 v[164:167], v[96:99], v[100:103], v[164:167]
    v_mfma_f32_16x16x32_bf16 v[168:171], v[96:99], v[104:107], v[168:171]
    s_add_u32 m0, s29, 45056
    s_nop 0
    buffer_load_dwordx4 v15, s[12:15], s33 offen lds
    v_mfma_f32_16x16x32_bf16 v[172:175], v[96:99], v[108:111], v[172:175]
    v_mfma_f32_16x16x32_bf16 v[176:179], v[96:99], v[112:115], v[176:179]
    s_waitcnt vmcnt(12) lgkmcnt(0)
    s_barrier
    v_mfma_f32_16x16x32_bf16 v[116:119], v[52:55], v[68:71], v[116:119]
    ds_read_b128 v[84:87], v25 offset:24576
    s_add_u32 s34, s30, s31
    s_and_b32 s34, s34, 3
    s_andn2_b32 s35, s30, 3
    s_or_b32 s34, s34, s35
    s_mul_i32 s32, s34, 65536
    s_mul_i32 s33, s34, 131072
    s_add_u32 s30, s30, 1
    s_add_u32 m0, s29, 49152
    s_nop 0
    buffer_load_dwordx4 v244, s[8:11], s32 offen sc1 lds
    v_mfma_f32_16x16x32_bf16 v[120:123], v[52:55], v[72:75], v[120:123]
    ds_read_b64_tr_b16 v[100:101], v27 offset:24576
    v_mfma_f32_16x16x32_bf16 v[124:127], v[52:55], v[76:79], v[124:127]
    ds_read_b64_tr_b16 v[102:103], v27 offset:26624
    s_add_u32 m0, s29, 53248
    s_nop 0
    buffer_load_dwordx4 v9, s[8:11], s32 offen sc1 lds
    v_mfma_f32_16x16x32_bf16 v[128:131], v[52:55], v[80:83], v[128:131]
    ds_read_b128 v[88:91], v25 offset:24832
    v_mfma_f32_16x16x32_bf16 v[132:135], v[56:59], v[68:71], v[132:135]
    ds_read_b64_tr_b16 v[104:105], v29 offset:24576
    v_mfma_f32_16x16x32_bf16 v[136:139], v[56:59], v[72:75], v[136:139]
    ds_read_b64_tr_b16 v[106:107], v29 offset:26624
    s_add_u32 m0, s29, 57344
    s_nop 0
    buffer_load_dwordx4 v246, s[12:15], s33 offen lds
    v_mfma_f32_16x16x32_bf16 v[140:143], v[56:59], v[76:79], v[140:143]
    ds_read_b128 v[92:95], v25 offset:25088
    v_mfma_f32_16x16x32_bf16 v[144:147], v[56:59], v[80:83], v[144:147]
    ds_read_b64_tr_b16 v[108:109], v27 offset:25088
    v_mfma_f32_16x16x32_bf16 v[148:151], v[60:63], v[68:71], v[148:151]
    ds_read_b64_tr_b16 v[110:111], v27 offset:27136
    s_add_u32 m0, s29, 61440
    s_nop 0
    buffer_load_dwordx4 v13, s[12:15], s33 offen lds
    v_mfma_f32_16x16x32_bf16 v[152:155], v[60:63], v[72:75], v[152:155]
    ds_read_b128 v[96:99], v25 offset:25344
    v_mfma_f32_16x16x32_bf16 v[156:159], v[60:63], v[76:79], v[156:159]
    ds_read_b64_tr_b16 v[112:113], v29 offset:25088
    s_add_u32 m0, s29, 65536
    s_nop 0
    buffer_load_dwordx4 v14, s[12:15], s33 offen lds
    v_mfma_f32_16x16x32_bf16 v[160:163], v[60:63], v[80:83], v[160:163]
    ds_read_b64_tr_b16 v[114:115], v29 offset:27136
    v_mfma_f32_16x16x32_bf16 v[164:167], v[64:67], v[68:71], v[164:167]
    v_mfma_f32_16x16x32_bf16 v[168:171], v[64:67], v[72:75], v[168:171]
    s_add_u32 m0, s29, 69632
    s_nop 0
    buffer_load_dwordx4 v15, s[12:15], s33 offen lds
    v_mfma_f32_16x16x32_bf16 v[172:175], v[64:67], v[76:79], v[172:175]
    v_mfma_f32_16x16x32_bf16 v[176:179], v[64:67], v[80:83], v[176:179]
    s_waitcnt vmcnt(12) lgkmcnt(0)
    s_barrier
    v_mfma_f32_16x16x32_bf16 v[116:119], v[84:87], v[100:103], v[116:119]
    ds_read_b128 v[52:55], v248 offset:0
    s_add_u32 s34, s30, s31
    s_and_b32 s34, s34, 3
    s_andn2_b32 s35, s30, 3
    s_or_b32 s34, s34, s35
    s_mul_i32 s32, s34, 65536
    s_mul_i32 s33, s34, 131072
    s_add_u32 s30, s30, 1
    s_add_u32 m0, s29, 73728
    s_nop 0
    buffer_load_dwordx4 v244, s[8:11], s32 offen sc1 lds
    v_mfma_f32_16x16x32_bf16 v[120:123], v[84:87], v[104:107], v[120:123]
    ds_read_b64_tr_b16 v[68:69], v250 offset:0
    v_mfma_f32_16x16x32_bf16 v[124:127], v[84:87], v[108:111], v[124:127]
    ds_read_b64_tr_b16 v[70:71], v250 offset:2048
    s_add_u32 m0, s29, 77824
    s_nop 0
    buffer_load_dwordx4 v9, s[8:11], s32 offen sc1 lds
    v_mfma_f32_16x16x32_bf16 v[128:131], v[84:87], v[112:115], v[128:131]
    ds_read_b128 v[56:59], v248 offset:256
    v_mfma_f32_16x16x32_bf16 v[132:135], v[88:91], v[100:103], v[132:135]
    ds_read_b64_tr_b16 v[72:73], v28 offset:0
    v_mfma_f32_16x16x32_bf16 v[136:139], v[88:91], v[104:107], v[136:139]
    ds_read_b64_tr_b16 v[74:75], v28 offset:2048
    s_add_u32 m0, s29, 81920
    s_nop 0
    buffer_load_dwordx4 v246, s[12:15], s33 offen lds
    v_mfma_f32_16x16x32_bf16 v[140:143], v[88:91], v[108:111], v[140:143]
    ds_read_b128 v[60:63], v248 offset:512
    v_mfma_f32_16x16x32_bf16 v[144:147], v[88:91], v[112:115], v[144:147]
    ds_read_b64_tr_b16 v[76:77], v250 offset:512
    v_mfma_f32_16x16x32_bf16 v[148:151], v[92:95], v[100:103], v[148:151]
    ds_read_b64_tr_b16 v[78:79], v250 offset:2560
    s_add_u32 m0, s29, 86016
    s_nop 0
    buffer_load_dwordx4 v13, s[12:15], s33 offen lds
    v_mfma_f32_16x16x32_bf16 v[152:155], v[92:95], v[104:107], v[152:155]
    ds_read_b128 v[64:67], v248 offset:768
    v_mfma_f32_16x16x32_bf16 v[156:159], v[92:95], v[108:111], v[156:159]
    ds_read_b64_tr_b16 v[80:81], v28 offset:512
    s_add_u32 m0, s29, 90112
    s_nop 0
    buffer_load_dwordx4 v14, s[12:15], s33 offen lds
    v_mfma_f32_16x16x32_bf16 v[160:163], v[92:95], v[112:115], v[160:163]
    ds_read_b64_tr_b16 v[82:83], v28 offset:2560
    v_mfma_f32_16x16x32_bf16 v[164:167], v[96:99], v[100:103], v[164:167]
    v_mfma_f32_16x16x32_bf16 v[168:171], v[96:99], v[104:107], v[168:171]
    s_add_u32 m0, s29, 94208
    s_nop 0
    buffer_load_dwordx4 v15, s[12:15], s33 offen lds
    v_mfma_f32_16x16x32_bf16 v[172:175], v[96:99], v[108:111], v[172:175]
    v_mfma_f32_16x16x32_bf16 v[176:179], v[96:99], v[112:115], v[176:179]
    s_sub_u32 s36, s36, 1
    s_cmp_lg_u32 s36, 0
    s_cbranch_scc1 L_p3_7338
    s_waitcnt vmcnt(12) lgkmcnt(0)
    s_barrier
    v_mfma_f32_16x16x32_bf16 v[116:119], v[52:55], v[68:71], v[116:119]
    ds_read_b128 v[84:87], v248 offset:24576
    v_mfma_f32_16x16x32_bf16 v[120:123], v[52:55], v[72:75], v[120:123]
    ds_read_b64_tr_b16 v[100:101], v250 offset:24576
    v_mfma_f32_16x16x32_bf16 v[124:127], v[52:55], v[76:79], v[124:127]
    ds_read_b64_tr_b16 v[102:103], v250 offset:26624
    v_mfma_f32_16x16x32_bf16 v[128:131], v[52:55], v[80:83], v[128:131]
    ds_read_b128 v[88:91], v248 offset:24832
    v_mfma_f32_16x16x32_bf16 v[132:135], v[56:59], v[68:71], v[132:135]
    ds_read_b64_tr_b16 v[104:105], v28 offset:24576
    v_mfma_f32_16x16x32_bf16 v[136:139], v[56:59], v[72:75], v[136:139]
    ds_read_b64_tr_b16 v[106:107], v28 offset:26624
    v_mfma_f32_16x16x32_bf16 v[140:143], v[56:59], v[76:79], v[140:143]
    ds_read_b128 v[92:95], v248 offset:25088
    v_mfma_f32_16x16x32_bf16 v[144:147], v[56:59], v[80:83], v[144:147]
    ds_read_b64_tr_b16 v[108:109], v250 offset:25088
    v_mfma_f32_16x16x32_bf16 v[148:151], v[60:63], v[68:71], v[148:151]
    ds_read_b64_tr_b16 v[110:111], v250 offset:27136
    v_mfma_f32_16x16x32_bf16 v[152:155], v[60:63], v[72:75], v[152:155]
    ds_read_b128 v[96:99], v248 offset:25344
    v_mfma_f32_16x16x32_bf16 v[156:159], v[60:63], v[76:79], v[156:159]
    ds_read_b64_tr_b16 v[112:113], v28 offset:25088
    v_mfma_f32_16x16x32_bf16 v[160:163], v[60:63], v[80:83], v[160:163]
    ds_read_b64_tr_b16 v[114:115], v28 offset:27136
    v_mfma_f32_16x16x32_bf16 v[164:167], v[64:67], v[68:71], v[164:167]
    v_mfma_f32_16x16x32_bf16 v[168:171], v[64:67], v[72:75], v[168:171]
    v_mfma_f32_16x16x32_bf16 v[172:175], v[64:67], v[76:79], v[172:175]
    v_mfma_f32_16x16x32_bf16 v[176:179], v[64:67], v[80:83], v[176:179]
    s_waitcnt vmcnt(6) lgkmcnt(0)
    s_barrier
    v_mfma_f32_16x16x32_bf16 v[116:119], v[84:87], v[100:103], v[116:119]
    ds_read_b128 v[52:55], v25 offset:0
    v_mfma_f32_16x16x32_bf16 v[120:123], v[84:87], v[104:107], v[120:123]
    ds_read_b64_tr_b16 v[68:69], v27 offset:0
    v_mfma_f32_16x16x32_bf16 v[124:127], v[84:87], v[108:111], v[124:127]
    ds_read_b64_tr_b16 v[70:71], v27 offset:2048
    v_mfma_f32_16x16x32_bf16 v[128:131], v[84:87], v[112:115], v[128:131]
    ds_read_b128 v[56:59], v25 offset:256
    v_mfma_f32_16x16x32_bf16 v[132:135], v[88:91], v[100:103], v[132:135]
    ds_read_b64_tr_b16 v[72:73], v29 offset:0
    v_mfma_f32_16x16x32_bf16 v[136:139], v[88:91], v[104:107], v[136:139]
    ds_read_b64_tr_b16 v[74:75], v29 offset:2048
    v_mfma_f32_16x16x32_bf16 v[140:143], v[88:91], v[108:111], v[140:143]
    ds_read_b128 v[60:63], v25 offset:512
    v_mfma_f32_16x16x32_bf16 v[144:147], v[88:91], v[112:115], v[144:147]
    ds_read_b64_tr_b16 v[76:77], v27 offset:512
    v_mfma_f32_16x16x32_bf16 v[148:151], v[92:95], v[100:103], v[148:151]
    ds_read_b64_tr_b16 v[78:79], v27 offset:2560
    v_mfma_f32_16x16x32_bf16 v[152:155], v[92:95], v[104:107], v[152:155]
    ds_read_b128 v[64:67], v25 offset:768
    v_mfma_f32_16x16x32_bf16 v[156:159], v[92:95], v[108:111], v[156:159]
    ds_read_b64_tr_b16 v[80:81], v29 offset:512
    v_mfma_f32_16x16x32_bf16 v[160:163], v[92:95], v[112:115], v[160:163]
    ds_read_b64_tr_b16 v[82:83], v29 offset:2560
    v_mfma_f32_16x16x32_bf16 v[164:167], v[96:99], v[100:103], v[164:167]
    v_mfma_f32_16x16x32_bf16 v[168:171], v[96:99], v[104:107], v[168:171]
    v_mfma_f32_16x16x32_bf16 v[172:175], v[96:99], v[108:111], v[172:175]
    v_mfma_f32_16x16x32_bf16 v[176:179], v[96:99], v[112:115], v[176:179]
    s_waitcnt vmcnt(0) lgkmcnt(0)
    s_barrier
    v_mfma_f32_16x16x32_bf16 v[116:119], v[52:55], v[68:71], v[116:119]
    ds_read_b128 v[84:87], v25 offset:24576
    v_mfma_f32_16x16x32_bf16 v[120:123], v[52:55], v[72:75], v[120:123]
    ds_read_b64_tr_b16 v[100:101], v27 offset:24576
    v_mfma_f32_16x16x32_bf16 v[124:127], v[52:55], v[76:79], v[124:127]
    ds_read_b64_tr_b16 v[102:103], v27 offset:26624
    v_mfma_f32_16x16x32_bf16 v[128:131], v[52:55], v[80:83], v[128:131]
    ds_read_b128 v[88:91], v25 offset:24832
    v_mfma_f32_16x16x32_bf16 v[132:135], v[56:59], v[68:71], v[132:135]
    ds_read_b64_tr_b16 v[104:105], v29 offset:24576
    v_mfma_f32_16x16x32_bf16 v[136:139], v[56:59], v[72:75], v[136:139]
    ds_read_b64_tr_b16 v[106:107], v29 offset:26624
    v_mfma_f32_16x16x32_bf16 v[140:143], v[56:59], v[76:79], v[140:143]
    ds_read_b128 v[92:95], v25 offset:25088
    v_mfma_f32_16x16x32_bf16 v[144:147], v[56:59], v[80:83], v[144:147]
    ds_read_b64_tr_b16 v[108:109], v27 offset:25088
    v_mfma_f32_16x16x32_bf16 v[148:151], v[60:63], v[68:71], v[148:151]
    ds_read_b64_tr_b16 v[110:111], v27 offset:27136
    v_mfma_f32_16x16x32_bf16 v[152:155], v[60:63], v[72:75], v[152:155]
    ds_read_b128 v[96:99], v25 offset:25344
    v_mfma_f32_16x16x32_bf16 v[156:159], v[60:63], v[76:79], v[156:159]
    ds_read_b64_tr_b16 v[112:113], v29 offset:25088
    v_mfma_f32_16x16x32_bf16 v[160:163], v[60:63], v[80:83], v[160:163]
    ds_read_b64_tr_b16 v[114:115], v29 offset:27136
    v_mfma_f32_16x16x32_bf16 v[164:167], v[64:67], v[68:71], v[164:167]
    v_mfma_f32_16x16x32_bf16 v[168:171], v[64:67], v[72:75], v[168:171]
    v_mfma_f32_16x16x32_bf16 v[172:175], v[64:67], v[76:79], v[172:175]
    v_mfma_f32_16x16x32_bf16 v[176:179], v[64:67], v[80:83], v[176:179]
    s_waitcnt lgkmcnt(0)
    v_mfma_f32_16x16x32_bf16 v[116:119], v[84:87], v[100:103], v[116:119]
    v_mfma_f32_16x16x32_bf16 v[120:123], v[84:87], v[104:107], v[120:123]
    v_mfma_f32_16x16x32_bf16 v[124:127], v[84:87], v[108:111], v[124:127]
    v_mfma_f32_16x16x32_bf16 v[128:131], v[84:87], v[112:115], v[128:131]
    v_mfma_f32_16x16x32_bf16 v[132:135], v[88:91], v[100:103], v[132:135]
    v_mfma_f32_16x16x32_bf16 v[136:139], v[88:91], v[104:107], v[136:139]
    v_mfma_f32_16x16x32_bf16 v[140:143], v[88:91], v[108:111], v[140:143]
    v_mfma_f32_16x16x32_bf16 v[144:147], v[88:91], v[112:115], v[144:147]
    v_mfma_f32_16x16x32_bf16 v[148:151], v[92:95], v[100:103], v[148:151]
    v_mfma_f32_16x16x32_bf16 v[152:155], v[92:95], v[104:107], v[152:155]
    v_mfma_f32_16x16x32_bf16 v[156:159], v[92:95], v[108:111], v[156:159]
    v_mfma_f32_16x16x32_bf16 v[160:163], v[92:95], v[112:115], v[160:163]
    v_mfma_f32_16x16x32_bf16 v[164:167], v[96:99], v[100:103], v[164:167]
    v_mfma_f32_16x16x32_bf16 v[168:171], v[96:99], v[104:107], v[168:171]
    v_mfma_f32_16x16x32_bf16 v[172:175], v[96:99], v[108:111], v[172:175]
    v_mfma_f32_16x16x32_bf16 v[176:179], v[96:99], v[112:115], v[176:179]
    s_branch P3_Bend
P3_B1:
    s_cmp_lg_u32 s28, 4
    s_cbranch_scc1 Lq_depB
    s_mov_b32 s39, 0
Lp_depB:
    buffer_load_dword v3, v16, s[16:19], 0 offen sc1
    s_add_u32 s39, s39, 1
    s_waitcnt vmcnt(0)
    v_cmp_ne_u32 vcc, s51, v3
    s_cbranch_vccz Lq_depB
    s_cmp_ge_u32 s39, 0x40000
    s_cbranch_scc1 Lq_depB
    s_sleep 1
    s_branch Lp_depB
Lq_depB:
    s_barrier
    s_barrier
    ds_read_b128 v[52:55], v249 offset:0
    ds_read_b64_tr_b16 v[68:69], v251 offset:0
    ds_read_b64_tr_b16 v[70:71], v251 offset:2048
    ds_read_b128 v[56:59], v249 offset:256
    ds_read_b64_tr_b16 v[72:73], v34 offset:0
    ds_read_b64_tr_b16 v[74:75], v34 offset:2048
    ds_read_b128 v[60:63], v249 offset:512
    ds_read_b64_tr_b16 v[76:77], v251 offset:512
    ds_read_b64_tr_b16 v[78:79], v251 offset:2560
    ds_read_b128 v[64:67], v249 offset:768
    ds_read_b64_tr_b16 v[80:81], v34 offset:512
    ds_read_b64_tr_b16 v[82:83], v34 offset:2560
    s_mov_b32 s36, 3
L_p3_7700:
    s_waitcnt lgkmcnt(0)
    s_barrier
    v_mfma_f32_16x16x32_bf16 v[180:183], v[68:71], v[52:55], v[180:183]
    ds_read_b128 v[84:87], v249 offset:24576
    v_mfma_f32_16x16x32_bf16 v[196:199], v[72:75], v[52:55], v[196:199]
    ds_read_b64_tr_b16 v[100:101], v251 offset:24576
    v_mfma_f32_16x16x32_bf16 v[212:215], v[76:79], v[52:55], v[212:215]
    ds_read_b64_tr_b16 v[102:103], v251 offset:26624
    v_mfma_f32_16x16x32_bf16 v[228:231], v[80:83], v[52:55], v[228:231]
    ds_read_b128 v[88:91], v249 offset:24832
    v_mfma_f32_16x16x32_bf16 v[184:187], v[68:71], v[56:59], v[184:187]
    ds_read_b64_tr_b16 v[104:105], v34 offset:24576
    v_mfma_f32_16x16x32_bf16 v[200:203], v[72:75], v[56:59], v[200:203]
    ds_read_b64_tr_b16 v[106:107], v34 offset:26624
    v_mfma_f32_16x16x32_bf16 v[216:219], v[76:79], v[56:59], v[216:219]
    ds_read_b128 v[92:95], v249 offset:25088
    v_mfma_f32_16x16x32_bf16 v[232:235], v[80:83], v[56:59], v[232:235]
    ds_read_b64_tr_b16 v[108:109], v251 offset:25088
    v_mfma_f32_16x16x32_bf16 v[188:191], v[68:71], v[60:63], v[188:191]
    ds_read_b64_tr_b16 v[110:111], v251 offset:27136
    v_mfma_f32_16x16x32_bf16 v[204:207], v[72:75], v[60:63], v[204:207]
    ds_read_b128 v[96:99], v249 offset:25344
    v_mfma_f32_16x16x32_bf16 v[220:223], v[76:79], v[60:63], v[220:223]
    ds_read_b64_tr_b16 v[112:113], v34 offset:25088
    v_mfma_f32_16x16x32_bf16 v[236:239], v[80:83], v[60:63], v[236:239]
    ds_read_b64_tr_b16 v[114:115], v34 offset:27136
    v_mfma_f32_16x16x32_bf16 v[192:195], v[68:71], v[64:67], v[192:195]
    v_mfma_f32_16x16x32_bf16 v[208:211], v[72:75], v[64:67], v[208:211]
    v_mfma_f32_16x16x32_bf16 v[224:227], v[76:79], v[64:67], v[224:227]
    v_mfma_f32_16x16x32_bf16 v[240:243], v[80:83], v[64:67], v[240:243]
    s_waitcnt lgkmcnt(0)
    s_barrier
    v_mfma_f32_16x16x32_bf16 v[180:183], v[100:103], v[84:87], v[180:183]
    ds_read_b128 v[52:55], v31 offset:0
    v_mfma_f32_16x16x32_bf16 v[196:199], v[104:107], v[84:87], v[196:199]
    ds_read_b64_tr_b16 v[68:69], v33 offset:0
    v_mfma_f32_16x16x32_bf16 v[212:215], v[108:111], v[84:87], v[212:215]
    ds_read_b64_tr_b16 v[70:71], v33 offset:2048
    v_mfma_f32_16x16x32_bf16 v[228:231], v[112:115], v[84:87], v[228:231]
    ds_read_b128 v[56:59], v31 offset:256
    v_mfma_f32_16x16x32_bf16 v[184:187], v[100:103], v[88:91], v[184:187]
    ds_read_b64_tr_b16 v[72:73], v35 offset:0
    v_mfma_f32_16x16x32_bf16 v[200:203], v[104:107], v[88:91], v[200:203]
    ds_read_b64_tr_b16 v[74:75], v35 offset:2048
    v_mfma_f32_16x16x32_bf16 v[216:219], v[108:111], v[88:91], v[216:219]
    ds_read_b128 v[60:63], v31 offset:512
    v_mfma_f32_16x16x32_bf16 v[232:235], v[112:115], v[88:91], v[232:235]
    ds_read_b64_tr_b16 v[76:77], v33 offset:512
    v_mfma_f32_16x16x32_bf16 v[188:191], v[100:103], v[92:95], v[188:191]
    ds_read_b64_tr_b16 v[78:79], v33 offset:2560
    v_mfma_f32_16x16x32_bf16 v[204:207], v[104:107], v[92:95], v[204:207]
    ds_read_b128 v[64:67], v31 offset:768
    v_mfma_f32_16x16x32_bf16 v[220:223], v[108:111], v[92:95], v[220:223]
    ds_read_b64_tr_b16 v[80:81], v35 offset:512
    v_mfma_f32_16x16x32_bf16 v[236:239], v[112:115], v[92:95], v[236:239]
    ds_read_b64_tr_b16 v[82:83], v35 offset:2560
    v_mfma_f32_16x16x32_bf16 v[192:195], v[100:103], v[96:99], v[192:195]
    v_mfma_f32_16x16x32_bf16 v[208:211], v[104:107], v[96:99], v[208:211]
    v_mfma_f32_16x16x32_bf16 v[224:227], v[108:111], v[96:99], v[224:227]
    v_mfma_f32_16x16x32_bf16 v[240:243], v[112:115], v[96:99], v[240:243]
    s_waitcnt lgkmcnt(0)
    s_barrier
    v_mfma_f32_16x16x32_bf16 v[180:183], v[68:71], v[52:55], v[180:183]
    ds_read_b128 v[84:87], v31 offset:24576
    v_mfma_f32_16x16x32_bf16 v[196:199], v[72:75], v[52:55], v[196:199]
    ds_read_b64_tr_b16 v[100:101], v33 offset:24576
    v_mfma_f32_16x16x32_bf16 v[212:215], v[76:79], v[52:55], v[212:215]
    ds_read_b64_tr_b16 v[102:103], v33 offset:26624
    v_mfma_f32_16x16x32_bf16 v[228:231], v[80:83], v[52:55], v[228:231]
    ds_read_b128 v[88:91], v31 offset:24832
    v_mfma_f32_16x16x32_bf16 v[184:187], v[68:71], v[56:59], v[184:187]
    ds_read_b64_tr_b16 v[104:105], v35 offset:24576
    v_mfma_f32_16x16x32_bf16 v[200:203], v[72:75], v[56:59], v[200:203]
    ds_read_b64_tr_b16 v[106:107], v35 offset:26624
    v_mfma_f32_16x16x32_bf16 v[216:219], v[76:79], v[56:59], v[216:219]
    ds_read_b128 v[92:95], v31 offset:25088
    v_mfma_f32_16x16x32_bf16 v[232:235], v[80:83], v[56:59], v[232:235]
    ds_read_b64_tr_b16 v[108:109], v33 offset:25088
    v_mfma_f32_16x16x32_bf16 v[188:191], v[68:71], v[60:63], v[188:191]
    ds_read_b64_tr_b16 v[110:111], v33 offset:27136
    v_mfma_f32_16x16x32_bf16 v[204:207], v[72:75], v[60:63], v[204:207]
    ds_read_b128 v[96:99], v31 offset:25344
    v_mfma_f32_16x16x32_bf16 v[220:223], v[76:79], v[60:63], v[220:223]
    ds_read_b64_tr_b16 v[112:113], v35 offset:25088
    v_mfma_f32_16x16x32_bf16 v[236:239], v[80:83], v[60:63], v[236:239]
    ds_read_b64_tr_b16 v[114:115], v35 offset:27136
    v_mfma_f32_16x16x32_bf16 v[192:195], v[68:71], v[64:67], v[192:195]
    v_mfma_f32_16x16x32_bf16 v[208:211], v[72:75], v[64:67], v[208:211]
    v_mfma_f32_16x16x32_bf16 v[224:227], v[76:79], v[64:67], v[224:227]
    v_mfma_f32_16x16x32_bf16 v[240:243], v[80:83], v[64:67], v[240:243]
    s_waitcnt lgkmcnt(0)
    s_barrier
    v_mfma_f32_16x16x32_bf16 v[180:183], v[100:103], v[84:87], v[180:183]
    ds_read_b128 v[52:55], v249 offset:0
    v_mfma_f32_16x16x32_bf16 v[196:199], v[104:107], v[84:87], v[196:199]
    ds_read_b64_tr_b16 v[68:69], v251 offset:0
    v_mfma_f32_16x16x32_bf16 v[212:215], v[108:111], v[84:87], v[212:215]
    ds_read_b64_tr_b16 v[70:71], v251 offset:2048
    v_mfma_f32_16x16x32_bf16 v[228:231], v[112:115], v[84:87], v[228:231]
    ds_read_b128 v[56:59], v249 offset:256
    v_mfma_f32_16x16x32_bf16 v[184:187], v[100:103], v[88:91], v[184:187]
    ds_read_b64_tr_b16 v[72:73], v34 offset:0
    v_mfma_f32_16x16x32_bf16 v[200:203], v[104:107], v[88:91], v[200:203]
    ds_read_b64_tr_b16 v[74:75], v34 offset:2048
    v_mfma_f32_16x16x32_bf16 v[216:219], v[108:111], v[88:91], v[216:219]
    ds_read_b128 v[60:63], v249 offset:512
    v_mfma_f32_16x16x32_bf16 v[232:235], v[112:115], v[88:91], v[232:235]
    ds_read_b64_tr_b16 v[76:77], v251 offset:512
    v_mfma_f32_16x16x32_bf16 v[188:191], v[100:103], v[92:95], v[188:191]
    ds_read_b64_tr_b16 v[78:79], v251 offset:2560
    v_mfma_f32_16x16x32_bf16 v[204:207], v[104:107], v[92:95], v[204:207]
    ds_read_b128 v[64:67], v249 offset:768
    v_mfma_f32_16x16x32_bf16 v[220:223], v[108:111], v[92:95], v[220:223]
    ds_read_b64_tr_b16 v[80:81], v34 offset:512
    v_mfma_f32_16x16x32_bf16 v[236:239], v[112:115], v[92:95], v[236:239]
    ds_read_b64_tr_b16 v[82:83], v34 offset:2560
    v_mfma_f32_16x16x32_bf16 v[192:195], v[100:103], v[96:99], v[192:195]
    v_mfma_f32_16x16x32_bf16 v[208:211], v[104:107], v[96:99], v[208:211]
    v_mfma_f32_16x16x32_bf16 v[224:227], v[108:111], v[96:99], v[224:227]
    v_mfma_f32_16x16x32_bf16 v[240:243], v[112:115], v[96:99], v[240:243]
    s_sub_u32 s36, s36, 1
    s_cmp_lg_u32 s36, 0
    s_cbranch_scc1 L_p3_7700
    s_cmp_lg_u32 s28, 4
    s_cbranch_scc1 Lq_dep2
    s_mov_b32 s39, 0
Lp_dep2:
    buffer_load_dword v3, v20, s[16:19], 0 offen sc1
    s_add_u32 s39, s39, 1
    s_waitcnt vmcnt(0)
    v_cmp_ne_u32 vcc, s51, v3
    s_cbranch_vccz Lq_dep2
    s_cmp_ge_u32 s39, 0x40000
    s_cbranch_scc1 Lq_dep2
    s_sleep 1
    s_branch Lp_dep2
Lq_dep2:
    s_waitcnt lgkmcnt(0)
    s_barrier
    v_mfma_f32_16x16x32_bf16 v[180:183], v[68:71], v[52:55], v[180:183]
    ds_read_b128 v[84:87], v249 offset:24576
    v_mfma_f32_16x16x32_bf16 v[196:199], v[72:75], v[52:55], v[196:199]
    ds_read_b64_tr_b16 v[100:101], v251 offset:24576
    v_mfma_f32_16x16x32_bf16 v[212:215], v[76:79], v[52:55], v[212:215]
    ds_read_b64_tr_b16 v[102:103], v251 offset:26624
    v_mfma_f32_16x16x32_bf16 v[228:231], v[80:83], v[52:55], v[228:231]
    ds_read_b128 v[88:91], v249 offset:24832
    v_mfma_f32_16x16x32_bf16 v[184:187], v[68:71], v[56:59], v[184:187]
    ds_read_b64_tr_b16 v[104:105], v34 offset:24576
    v_mfma_f32_16x16x32_bf16 v[200:203], v[72:75], v[56:59], v[200:203]
    ds_read_b64_tr_b16 v[106:107], v34 offset:26624
    v_mfma_f32_16x16x32_bf16 v[216:219], v[76:79], v[56:59], v[216:219]
    ds_read_b128 v[92:95], v249 offset:25088
    v_mfma_f32_16x16x32_bf16 v[232:235], v[80:83], v[56:59], v[232:235]
    ds_read_b64_tr_b16 v[108:109], v251 offset:25088
    v_mfma_f32_16x16x32_bf16 v[188:191], v[68:71], v[60:63], v[188:191]
    ds_read_b64_tr_b16 v[110:111], v251 offset:27136
    v_mfma_f32_16x16x32_bf16 v[204:207], v[72:75], v[60:63], v[204:207]
    ds_read_b128 v[96:99], v249 offset:25344
    v_mfma_f32_16x16x32_bf16 v[220:223], v[76:79], v[60:63], v[220:223]
    ds_read_b64_tr_b16 v[112:113], v34 offset:25088
    v_mfma_f32_16x16x32_bf16 v[236:239], v[80:83], v[60:63], v[236:239]
    ds_read_b64_tr_b16 v[114:115], v34 offset:27136
    v_mfma_f32_16x16x32_bf16 v[192:195], v[68:71], v[64:67], v[192:195]
    v_mfma_f32_16x16x32_bf16 v[208:211], v[72:75], v[64:67], v[208:211]
    v_mfma_f32_16x16x32_bf16 v[224:227], v[76:79], v[64:67], v[224:227]
    v_mfma_f32_16x16x32_bf16 v[240:243], v[80:83], v[64:67], v[240:243]
    s_waitcnt lgkmcnt(0)
    s_barrier
    v_mfma_f32_16x16x32_bf16 v[180:183], v[100:103], v[84:87], v[180:183]
    ds_read_b128 v[52:55], v31 offset:0
    v_mfma_f32_16x16x32_bf16 v[196:199], v[104:107], v[84:87], v[196:199]
    ds_read_b64_tr_b16 v[68:69], v33 offset:0
    v_mfma_f32_16x16x32_bf16 v[212:215], v[108:111], v[84:87], v[212:215]
    ds_read_b64_tr_b16 v[70:71], v33 offset:2048
    v_mfma_f32_16x16x32_bf16 v[228:231], v[112:115], v[84:87], v[228:231]
    ds_read_b128 v[56:59], v31 offset:256
    v_mfma_f32_16x16x32_bf16 v[184:187], v[100:103], v[88:91], v[184:187]
    ds_read_b64_tr_b16 v[72:73], v35 offset:0
    v_mfma_f32_16x16x32_bf16 v[200:203], v[104:107], v[88:91], v[200:203]
    ds_read_b64_tr_b16 v[74:75], v35 offset:2048
    v_mfma_f32_16x16x32_bf16 v[216:219], v[108:111], v[88:91], v[216:219]
    ds_read_b128 v[60:63], v31 offset:512
    v_mfma_f32_16x16x32_bf16 v[232:235], v[112:115], v[88:91], v[232:235]
    ds_read_b64_tr_b16 v[76:77], v33 offset:512
    v_mfma_f32_16x16x32_bf16 v[188:191], v[100:103], v[92:95], v[188:191]
    ds_read_b64_tr_b16 v[78:79], v33 offset:2560
    v_mfma_f32_16x16x32_bf16 v[204:207], v[104:107], v[92:95], v[204:207]
    ds_read_b128 v[64:67], v31 offset:768
    v_mfma_f32_16x16x32_bf16 v[220:223], v[108:111], v[92:95], v[220:223]
    ds_read_b64_tr_b16 v[80:81], v35 offset:512
    v_mfma_f32_16x16x32_bf16 v[236:239], v[112:115], v[92:95], v[236:239]
    ds_read_b64_tr_b16 v[82:83], v35 offset:2560
    v_mfma_f32_16x16x32_bf16 v[192:195], v[100:103], v[96:99], v[192:195]
    v_mfma_f32_16x16x32_bf16 v[208:211], v[104:107], v[96:99], v[208:211]
    v_mfma_f32_16x16x32_bf16 v[224:227], v[108:111], v[96:99], v[224:227]
    v_mfma_f32_16x16x32_bf16 v[240:243], v[112:115], v[96:99], v[240:243]
    s_waitcnt lgkmcnt(0)
    s_barrier
    v_mfma_f32_16x16x32_bf16 v[180:183], v[68:71], v[52:55], v[180:183]
    ds_read_b128 v[84:87], v31 offset:24576
    v_mfma_f32_16x16x32_bf16 v[196:199], v[72:75], v[52:55], v[196:199]
    ds_read_b64_tr_b16 v[100:101], v33 offset:24576
    v_mfma_f32_16x16x32_bf16 v[212:215], v[76:79], v[52:55], v[212:215]
    ds_read_b64_tr_b16 v[102:103], v33 offset:26624
    v_mfma_f32_16x16x32_bf16 v[228:231], v[80:83], v[52:55], v[228:231]
    ds_read_b128 v[88:91], v31 offset:24832
    v_mfma_f32_16x16x32_bf16 v[184:187], v[68:71], v[56:59], v[184:187]
    ds_read_b64_tr_b16 v[104:105], v35 offset:24576
    v_mfma_f32_16x16x32_bf16 v[200:203], v[72:75], v[56:59], v[200:203]
    ds_read_b64_tr_b16 v[106:107], v35 offset:26624
    v_mfma_f32_16x16x32_bf16 v[216:219], v[76:79], v[56:59], v[216:219]
    ds_read_b128 v[92:95], v31 offset:25088
    v_mfma_f32_16x16x32_bf16 v[232:235], v[80:83], v[56:59], v[232:235]
    ds_read_b64_tr_b16 v[108:109], v33 offset:25088
    v_mfma_f32_16x16x32_bf16 v[188:191], v[68:71], v[60:63], v[188:191]
    ds_read_b64_tr_b16 v[110:111], v33 offset:27136
    v_mfma_f32_16x16x32_bf16 v[204:207], v[72:75], v[60:63], v[204:207]
    ds_read_b128 v[96:99], v31 offset:25344
    v_mfma_f32_16x16x32_bf16 v[220:223], v[76:79], v[60:63], v[220:223]
    ds_read_b64_tr_b16 v[112:113], v35 offset:25088
    v_mfma_f32_16x16x32_bf16 v[236:239], v[80:83], v[60:63], v[236:239]
    ds_read_b64_tr_b16 v[114:115], v35 offset:27136
    v_mfma_f32_16x16x32_bf16 v[192:195], v[68:71], v[64:67], v[192:195]
    v_mfma_f32_16x16x32_bf16 v[208:211], v[72:75], v[64:67], v[208:211]
    v_mfma_f32_16x16x32_bf16 v[224:227], v[76:79], v[64:67], v[224:227]
    v_mfma_f32_16x16x32_bf16 v[240:243], v[80:83], v[64:67], v[240:243]
    s_waitcnt lgkmcnt(0)
    s_barrier
    v_mfma_f32_16x16x32_bf16 v[180:183], v[100:103], v[84:87], v[180:183]
    ds_read_b128 v[52:55], v248 offset:0
    v_mfma_f32_16x16x32_bf16 v[196:199], v[104:107], v[84:87], v[196:199]
    ds_read_b64_tr_b16 v[68:69], v250 offset:0
    v_mfma_f32_16x16x32_bf16 v[212:215], v[108:111], v[84:87], v[212:215]
    ds_read_b64_tr_b16 v[70:71], v250 offset:2048
    v_mfma_f32_16x16x32_bf16 v[228:231], v[112:115], v[84:87], v[228:231]
    ds_read_b128 v[56:59], v248 offset:256
    v_mfma_f32_16x16x32_bf16 v[184:187], v[100:103], v[88:91], v[184:187]
    ds_read_b64_tr_b16 v[72:73], v28 offset:0
    v_mfma_f32_16x16x32_bf16 v[200:203], v[104:107], v[88:91], v[200:203]
    ds_read_b64_tr_b16 v[74:75], v28 offset:2048
    v_mfma_f32_16x16x32_bf16 v[216:219], v[108:111], v[88:91], v[216:219]
    ds_read_b128 v[60:63], v248 offset:512
    v_mfma_f32_16x16x32_bf16 v[232:235], v[112:115], v[88:91], v[232:235]
    ds_read_b64_tr_b16 v[76:77], v250 offset:512
    v_mfma_f32_16x16x32_bf16 v[188:191], v[100:103], v[92:95], v[188:191]
    ds_read_b64_tr_b16 v[78:79], v250 offset:2560
    v_mfma_f32_16x16x32_bf16 v[204:207], v[104:107], v[92:95], v[204:207]
    ds_read_b128 v[64:67], v248 offset:768
    v_mfma_f32_16x16x32_bf16 v[220:223], v[108:111], v[92:95], v[220:223]
    ds_read_b64_tr_b16 v[80:81], v28 offset:512
    v_mfma_f32_16x16x32_bf16 v[236:239], v[112:115], v[92:95], v[236:239]
    ds_read_b64_tr_b16 v[82:83], v28 offset:2560
    v_mfma_f32_16x16x32_bf16 v[192:195], v[100:103], v[96:99], v[192:195]
    v_mfma_f32_16x16x32_bf16 v[208:211], v[104:107], v[96:99], v[208:211]
    v_mfma_f32_16x16x32_bf16 v[224:227], v[108:111], v[96:99], v[224:227]
    v_mfma_f32_16x16x32_bf16 v[240:243], v[112:115], v[96:99], v[240:243]
    s_mov_b32 s36, 5
L_p3_7959:
    s_waitcnt lgkmcnt(0)
    s_barrier
    v_mfma_f32_16x16x32_bf16 v[116:119], v[52:55], v[68:71], v[116:119]
    ds_read_b128 v[84:87], v248 offset:24576
    v_mfma_f32_16x16x32_bf16 v[120:123], v[52:55], v[72:75], v[120:123]
    ds_read_b64_tr_b16 v[100:101], v250 offset:24576
    v_mfma_f32_16x16x32_bf16 v[124:127], v[52:55], v[76:79], v[124:127]
    ds_read_b64_tr_b16 v[102:103], v250 offset:26624
    v_mfma_f32_16x16x32_bf16 v[128:131], v[52:55], v[80:83], v[128:131]
    ds_read_b128 v[88:91], v248 offset:24832
    v_mfma_f32_16x16x32_bf16 v[132:135], v[56:59], v[68:71], v[132:135]
    ds_read_b64_tr_b16 v[104:105], v28 offset:24576
    v_mfma_f32_16x16x32_bf16 v[136:139], v[56:59], v[72:75], v[136:139]
    ds_read_b64_tr_b16 v[106:107], v28 offset:26624
    v_mfma_f32_16x16x32_bf16 v[140:143], v[56:59], v[76:79], v[140:143]
    ds_read_b128 v[92:95], v248 offset:25088
    v_mfma_f32_16x16x32_bf16 v[144:147], v[56:59], v[80:83], v[144:147]
    ds_read_b64_tr_b16 v[108:109], v250 offset:25088
    v_mfma_f32_16x16x32_bf16 v[148:151], v[60:63], v[68:71], v[148:151]
    ds_read_b64_tr_b16 v[110:111], v250 offset:27136
    v_mfma_f32_16x16x32_bf16 v[152:155], v[60:63], v[72:75], v[152:155]
    ds_read_b128 v[96:99], v248 offset:25344
    v_mfma_f32_16x16x32_bf16 v[156:159], v[60:63], v[76:79], v[156:159]
    ds_read_b64_tr_b16 v[112:113], v28 offset:25088
    v_mfma_f32_16x16x32_bf16 v[160:163], v[60:63], v[80:83], v[160:163]
    ds_read_b64_tr_b16 v[114:115], v28 offset:27136
    v_mfma_f32_16x16x32_bf16 v[164:167], v[64:67], v[68:71], v[164:167]
    v_mfma_f32_16x16x32_bf16 v[168:171], v[64:67], v[72:75], v[168:171]
    v_mfma_f32_16x16x32_bf16 v[172:175], v[64:67], v[76:79], v[172:175]
    v_mfma_f32_16x16x32_bf16 v[176:179], v[64:67], v[80:83], v[176:179]
    s_waitcnt lgkmcnt(0)
    s_barrier
    v_mfma_f32_16x16x32_bf16 v[116:119], v[84:87], v[100:103], v[116:119]
    ds_read_b128 v[52:55], v25 offset:0
    v_mfma_f32_16x16x32_bf16 v[120:123], v[84:87], v[104:107], v[120:123]
    ds_read_b64_tr_b16 v[68:69], v27 offset:0
    v_mfma_f32_16x16x32_bf16 v[124:127], v[84:87], v[108:111], v[124:127]
    ds_read_b64_tr_b16 v[70:71], v27 offset:2048
    v_mfma_f32_16x16x32_bf16 v[128:131], v[84:87], v[112:115], v[128:131]
    ds_read_b128 v[56:59], v25 offset:256
    v_mfma_f32_16x16x32_bf16 v[132:135], v[88:91], v[100:103], v[132:135]
    ds_read_b64_tr_b16 v[72:73], v29 offset:0
    v_mfma_f32_16x16x32_bf16 v[136:139], v[88:91], v[104:107], v[136:139]
    ds_read_b64_tr_b16 v[74:75], v29 offset:2048
    v_mfma_f32_16x16x32_bf16 v[140:143], v[88:91], v[108:111], v[140:143]
    ds_read_b128 v[60:63], v25 offset:512
    v_mfma_f32_16x16x32_bf16 v[144:147], v[88:91], v[112:115], v[144:147]
    ds_read_b64_tr_b16 v[76:77], v27 offset:512
    v_mfma_f32_16x16x32_bf16 v[148:151], v[92:95], v[100:103], v[148:151]
    ds_read_b64_tr_b16 v[78:79], v27 offset:2560
    v_mfma_f32_16x16x32_bf16 v[152:155], v[92:95], v[104:107], v[152:155]
    ds_read_b128 v[64:67], v25 offset:768
    v_mfma_f32_16x16x32_bf16 v[156:159], v[92:95], v[108:111], v[156:159]
    ds_read_b64_tr_b16 v[80:81], v29 offset:512
    v_mfma_f32_16x16x32_bf16 v[160:163], v[92:95], v[112:115], v[160:163]
    ds_read_b64_tr_b16 v[82:83], v29 offset:2560
    v_mfma_f32_16x16x32_bf16 v[164:167], v[96:99], v[100:103], v[164:167]
    v_mfma_f32_16x16x32_bf16 v[168:171], v[96:99], v[104:107], v[168:171]
    v_mfma_f32_16x16x32_bf16 v[172:175], v[96:99], v[108:111], v[172:175]
    v_mfma_f32_16x16x32_bf16 v[176:179], v[96:99], v[112:115], v[176:179]
    s_waitcnt lgkmcnt(0)
    s_barrier
    v_mfma_f32_16x16x32_bf16 v[116:119], v[52:55], v[68:71], v[116:119]
    ds_read_b128 v[84:87], v25 offset:24576
    v_mfma_f32_16x16x32_bf16 v[120:123], v[52:55], v[72:75], v[120:123]
    ds_read_b64_tr_b16 v[100:101], v27 offset:24576
    v_mfma_f32_16x16x32_bf16 v[124:127], v[52:55], v[76:79], v[124:127]
    ds_read_b64_tr_b16 v[102:103], v27 offset:26624
    v_mfma_f32_16x16x32_bf16 v[128:131], v[52:55], v[80:83], v[128:131]
    ds_read_b128 v[88:91], v25 offset:24832
    v_mfma_f32_16x16x32_bf16 v[132:135], v[56:59], v[68:71], v[132:135]
    ds_read_b64_tr_b16 v[104:105], v29 offset:24576
    v_mfma_f32_16x16x32_bf16 v[136:139], v[56:59], v[72:75], v[136:139]
    ds_read_b64_tr_b16 v[106:107], v29 offset:26624
    v_mfma_f32_16x16x32_bf16 v[140:143], v[56:59], v[76:79], v[140:143]
    ds_read_b128 v[92:95], v25 offset:25088
    v_mfma_f32_16x16x32_bf16 v[144:147], v[56:59], v[80:83], v[144:147]
    ds_read_b64_tr_b16 v[108:109], v27 offset:25088
    v_mfma_f32_16x16x32_bf16 v[148:151], v[60:63], v[68:71], v[148:151]
    ds_read_b64_tr_b16 v[110:111], v27 offset:27136
    v_mfma_f32_16x16x32_bf16 v[152:155], v[60:63], v[72:75], v[152:155]
    ds_read_b128 v[96:99], v25 offset:25344
    v_mfma_f32_16x16x32_bf16 v[156:159], v[60:63], v[76:79], v[156:159]
    ds_read_b64_tr_b16 v[112:113], v29 offset:25088
    v_mfma_f32_16x16x32_bf16 v[160:163], v[60:63], v[80:83], v[160:163]
    ds_read_b64_tr_b16 v[114:115], v29 offset:27136
    v_mfma_f32_16x16x32_bf16 v[164:167], v[64:67], v[68:71], v[164:167]
    v_mfma_f32_16x16x32_bf16 v[168:171], v[64:67], v[72:75], v[168:171]
    v_mfma_f32_16x16x32_bf16 v[172:175], v[64:67], v[76:79], v[172:175]
    v_mfma_f32_16x16x32_bf16 v[176:179], v[64:67], v[80:83], v[176:179]
    s_waitcnt lgkmcnt(0)
    s_barrier
    v_mfma_f32_16x16x32_bf16 v[116:119], v[84:87], v[100:103], v[116:119]
    ds_read_b128 v[52:55], v248 offset:0
    v_mfma_f32_16x16x32_bf16 v[120:123], v[84:87], v[104:107], v[120:123]
    ds_read_b64_tr_b16 v[68:69], v250 offset:0
    v_mfma_f32_16x16x32_bf16 v[124:127], v[84:87], v[108:111], v[124:127]
    ds_read_b64_tr_b16 v[70:71], v250 offset:2048
    v_mfma_f32_16x16x32_bf16 v[128:131], v[84:87], v[112:115], v[128:131]
    ds_read_b128 v[56:59], v248 offset:256
    v_mfma_f32_16x16x32_bf16 v[132:135], v[88:91], v[100:103], v[132:135]
    ds_read_b64_tr_b16 v[72:73], v28 offset:0
    v_mfma_f32_16x16x32_bf16 v[136:139], v[88:91], v[104:107], v[136:139]
    ds_read_b64_tr_b16 v[74:75], v28 offset:2048
    v_mfma_f32_16x16x32_bf16 v[140:143], v[88:91], v[108:111], v[140:143]
    ds_read_b128 v[60:63], v248 offset:512
    v_mfma_f32_16x16x32_bf16 v[144:147], v[88:91], v[112:115], v[144:147]
    ds_read_b64_tr_b16 v[76:77], v250 offset:512
    v_mfma_f32_16x16x32_bf16 v[148:151], v[92:95], v[100:103], v[148:151]
    ds_read_b64_tr_b16 v[78:79], v250 offset:2560
    v_mfma_f32_16x16x32_bf16 v[152:155], v[92:95], v[104:107], v[152:155]
    ds_read_b128 v[64:67], v248 offset:768
    v_mfma_f32_16x16x32_bf16 v[156:159], v[92:95], v[108:111], v[156:159]
    ds_read_b64_tr_b16 v[80:81], v28 offset:512
    v_mfma_f32_16x16x32_bf16 v[160:163], v[92:95], v[112:115], v[160:163]
    ds_read_b64_tr_b16 v[82:83], v28 offset:2560
    v_mfma_f32_16x16x32_bf16 v[164:167], v[96:99], v[100:103], v[164:167]
    v_mfma_f32_16x16x32_bf16 v[168:171], v[96:99], v[104:107], v[168:171]
    v_mfma_f32_16x16x32_bf16 v[172:175], v[96:99], v[108:111], v[172:175]
    v_mfma_f32_16x16x32_bf16 v[176:179], v[96:99], v[112:115], v[176:179]
    s_sub_u32 s36, s36, 1
    s_cmp_lg_u32 s36, 0
    s_cbranch_scc1 L_p3_7959
    s_waitcnt lgkmcnt(0)
    s_barrier
    v_mfma_f32_16x16x32_bf16 v[116:119], v[52:55], v[68:71], v[116:119]
    ds_read_b128 v[84:87], v248 offset:24576
    v_mfma_f32_16x16x32_bf16 v[120:123], v[52:55], v[72:75], v[120:123]
    ds_read_b64_tr_b16 v[100:101], v250 offset:24576
    v_mfma_f32_16x16x32_bf16 v[124:127], v[52:55], v[76:79], v[124:127]
    ds_read_b64_tr_b16 v[102:103], v250 offset:26624
    v_mfma_f32_16x16x32_bf16 v[128:131], v[52:55], v[80:83], v[128:131]
    ds_read_b128 v[88:91], v248 offset:24832
    v_mfma_f32_16x16x32_bf16 v[132:135], v[56:59], v[68:71], v[132:135]
    ds_read_b64_tr_b16 v[104:105], v28 offset:24576
    v_mfma_f32_16x16x32_bf16 v[136:139], v[56:59], v[72:75], v[136:139]
    ds_read_b64_tr_b16 v[106:107], v28 offset:26624
    v_mfma_f32_16x16x32_bf16 v[140:143], v[56:59], v[76:79], v[140:143]
    ds_read_b128 v[92:95], v248 offset:25088
    v_mfma_f32_16x16x32_bf16 v[144:147], v[56:59], v[80:83], v[144:147]
    ds_read_b64_tr_b16 v[108:109], v250 offset:25088
    v_mfma_f32_16x16x32_bf16 v[148:151], v[60:63], v[68:71], v[148:151]
    ds_read_b64_tr_b16 v[110:111], v250 offset:27136
    v_mfma_f32_16x16x32_bf16 v[152:155], v[60:63], v[72:75], v[152:155]
    ds_read_b128 v[96:99], v248 offset:25344
    v_mfma_f32_16x16x32_bf16 v[156:159], v[60:63], v[76:79], v[156:159]
    ds_read_b64_tr_b16 v[112:113], v28 offset:25088
    v_mfma_f32_16x16x32_bf16 v[160:163], v[60:63], v[80:83], v[160:163]
    ds_read_b64_tr_b16 v[114:115], v28 offset:27136
    v_mfma_f32_16x16x32_bf16 v[164:167], v[64:67], v[68:71], v[164:167]
    v_mfma_f32_16x16x32_bf16 v[168:171], v[64:67], v[72:75], v[168:171]
    v_mfma_f32_16x16x32_bf16 v[172:175], v[64:67], v[76:79], v[172:175]
    v_mfma_f32_16x16x32_bf16 v[176:179], v[64:67], v[80:83], v[176:179]
    s_waitcnt lgkmcnt(0)
    s_barrier
    v_mfma_f32_16x16x32_bf16 v[116:119], v[84:87], v[100:103], v[116:119]
    ds_read_b128 v[52:55], v25 offset:0
    v_mfma_f32_16x16x32_bf16 v[120:123], v[84:87], v[104:107], v[120:123]
    ds_read_b64_tr_b16 v[68:69], v27 offset:0
    v_mfma_f32_16x16x32_bf16 v[124:127], v[84:87], v[108:111], v[124:127]
    ds_read_b64_tr_b16 v[70:71], v27 offset:2048
    v_mfma_f32_16x16x32_bf16 v[128:131], v[84:87], v[112:115], v[128:131]
    ds_read_b128 v[56:59], v25 offset:256
    v_mfma_f32_16x16x32_bf16 v[132:135], v[88:91], v[100:103], v[132:135]
    ds_read_b64_tr_b16 v[72:73], v29 offset:0
    v_mfma_f32_16x16x32_bf16 v[136:139], v[88:91], v[104:107], v[136:139]
    ds_read_b64_tr_b16 v[74:75], v29 offset:2048
    v_mfma_f32_16x16x32_bf16 v[140:143], v[88:91], v[108:111], v[140:143]
    ds_read_b128 v[60:63], v25 offset:512
    v_mfma_f32_16x16x32_bf16 v[144:147], v[88:91], v[112:115], v[144:147]
    ds_read_b64_tr_b16 v[76:77], v27 offset:512
    v_mfma_f32_16x16x32_bf16 v[148:151], v[92:95], v[100:103], v[148:151]
    ds_read_b64_tr_b16 v[78:79], v27 offset:2560
    v_mfma_f32_16x16x32_bf16 v[152:155], v[92:95], v[104:107], v[152:155]
    ds_read_b128 v[64:67], v25 offset:768
    v_mfma_f32_16x16x32_bf16 v[156:159], v[92:95], v[108:111], v[156:159]
    ds_read_b64_tr_b16 v[80:81], v29 offset:512
    v_mfma_f32_16x16x32_bf16 v[160:163], v[92:95], v[112:115], v[160:163]
    ds_read_b64_tr_b16 v[82:83], v29 offset:2560
    v_mfma_f32_16x16x32_bf16 v[164:167], v[96:99], v[100:103], v[164:167]
    v_mfma_f32_16x16x32_bf16 v[168:171], v[96:99], v[104:107], v[168:171]
    v_mfma_f32_16x16x32_bf16 v[172:175], v[96:99], v[108:111], v[172:175]
    v_mfma_f32_16x16x32_bf16 v[176:179], v[96:99], v[112:115], v[176:179]
    s_waitcnt lgkmcnt(0)
    s_barrier
    v_mfma_f32_16x16x32_bf16 v[116:119], v[52:55], v[68:71], v[116:119]
    ds_read_b128 v[84:87], v25 offset:24576
    v_mfma_f32_16x16x32_bf16 v[120:123], v[52:55], v[72:75], v[120:123]
    ds_read_b64_tr_b16 v[100:101], v27 offset:24576
    v_mfma_f32_16x16x32_bf16 v[124:127], v[52:55], v[76:79], v[124:127]
    ds_read_b64_tr_b16 v[102:103], v27 offset:26624
    v_mfma_f32_16x16x32_bf16 v[128:131], v[52:55], v[80:83], v[128:131]
    ds_read_b128 v[88:91], v25 offset:24832
    v_mfma_f32_16x16x32_bf16 v[132:135], v[56:59], v[68:71], v[132:135]
    ds_read_b64_tr_b16 v[104:105], v29 offset:24576
    v_mfma_f32_16x16x32_bf16 v[136:139], v[56:59], v[72:75], v[136:139]
    ds_read_b64_tr_b16 v[106:107], v29 offset:26624
    v_mfma_f32_16x16x32_bf16 v[140:143], v[56:59], v[76:79], v[140:143]
    ds_read_b128 v[92:95], v25 offset:25088
    v_mfma_f32_16x16x32_bf16 v[144:147], v[56:59], v[80:83], v[144:147]
    ds_read_b64_tr_b16 v[108:109], v27 offset:25088
    v_mfma_f32_16x16x32_bf16 v[148:151], v[60:63], v[68:71], v[148:151]
    ds_read_b64_tr_b16 v[110:111], v27 offset:27136
    v_mfma_f32_16x16x32_bf16 v[152:155], v[60:63], v[72:75], v[152:155]
    ds_read_b128 v[96:99], v25 offset:25344
    v_mfma_f32_16x16x32_bf16 v[156:159], v[60:63], v[76:79], v[156:159]
    ds_read_b64_tr_b16 v[112:113], v29 offset:25088
    v_mfma_f32_16x16x32_bf16 v[160:163], v[60:63], v[80:83], v[160:163]
    ds_read_b64_tr_b16 v[114:115], v29 offset:27136
    v_mfma_f32_16x16x32_bf16 v[164:167], v[64:67], v[68:71], v[164:167]
    v_mfma_f32_16x16x32_bf16 v[168:171], v[64:67], v[72:75], v[168:171]
    v_mfma_f32_16x16x32_bf16 v[172:175], v[64:67], v[76:79], v[172:175]
    v_mfma_f32_16x16x32_bf16 v[176:179], v[64:67], v[80:83], v[176:179]
    s_waitcnt lgkmcnt(0)
    v_mfma_f32_16x16x32_bf16 v[116:119], v[84:87], v[100:103], v[116:119]
    v_mfma_f32_16x16x32_bf16 v[120:123], v[84:87], v[104:107], v[120:123]
    v_mfma_f32_16x16x32_bf16 v[124:127], v[84:87], v[108:111], v[124:127]
    v_mfma_f32_16x16x32_bf16 v[128:131], v[84:87], v[112:115], v[128:131]
    v_mfma_f32_16x16x32_bf16 v[132:135], v[88:91], v[100:103], v[132:135]
    v_mfma_f32_16x16x32_bf16 v[136:139], v[88:91], v[104:107], v[136:139]
    v_mfma_f32_16x16x32_bf16 v[140:143], v[88:91], v[108:111], v[140:143]
    v_mfma_f32_16x16x32_bf16 v[144:147], v[88:91], v[112:115], v[144:147]
    v_mfma_f32_16x16x32_bf16 v[148:151], v[92:95], v[100:103], v[148:151]
    v_mfma_f32_16x16x32_bf16 v[152:155], v[92:95], v[104:107], v[152:155]
    v_mfma_f32_16x16x32_bf16 v[156:159], v[92:95], v[108:111], v[156:159]
    v_mfma_f32_16x16x32_bf16 v[160:163], v[92:95], v[112:115], v[160:163]
    v_mfma_f32_16x16x32_bf16 v[164:167], v[96:99], v[100:103], v[164:167]
    v_mfma_f32_16x16x32_bf16 v[168:171], v[96:99], v[104:107], v[168:171]
    v_mfma_f32_16x16x32_bf16 v[172:175], v[96:99], v[108:111], v[172:175]
    v_mfma_f32_16x16x32_bf16 v[176:179], v[96:99], v[112:115], v[176:179]
P3_Bend:
    s_nop 6
    v_pk_fma_f32 v[116:117], v[116:117], v[36:37], v[180:181] op_sel_hi:[1,0,1]
    v_pk_fma_f32 v[118:119], v[118:119], v[36:37], v[182:183] op_sel_hi:[1,0,1]
    v_pk_fma_f32 v[132:133], v[132:133], v[36:37], v[196:197] op_sel_hi:[1,0,1]
    v_pk_fma_f32 v[134:135], v[134:135], v[36:37], v[198:199] op_sel_hi:[1,0,1]
    v_pk_fma_f32 v[148:149], v[148:149], v[36:37], v[212:213] op_sel_hi:[1,0,1]
    v_pk_fma_f32 v[150:151], v[150:151], v[36:37], v[214:215] op_sel_hi:[1,0,1]
    v_pk_fma_f32 v[164:165], v[164:165], v[36:37], v[228:229] op_sel_hi:[1,0,1]
    v_pk_fma_f32 v[166:167], v[166:167], v[36:37], v[230:231] op_sel_hi:[1,0,1]
    v_pk_fma_f32 v[120:121], v[120:121], v[38:39], v[184:185] op_sel_hi:[1,0,1]
    v_pk_fma_f32 v[122:123], v[122:123], v[38:39], v[186:187] op_sel_hi:[1,0,1]
    v_pk_fma_f32 v[136:137], v[136:137], v[38:39], v[200:201] op_sel_hi:[1,0,1]
    v_pk_fma_f32 v[138:139], v[138:139], v[38:39], v[202:203] op_sel_hi:[1,0,1]
    v_pk_fma_f32 v[152:153], v[152:153], v[38:39], v[216:217] op_sel_hi:[1,0,1]
    v_pk_fma_f32 v[154:155], v[154:155], v[38:39], v[218:219] op_sel_hi:[1,0,1]
    v_pk_fma_f32 v[168:169], v[168:169], v[38:39], v[232:233] op_sel_hi:[1,0,1]
    v_pk_fma_f32 v[170:171], v[170:171], v[38:39], v[234:235] op_sel_hi:[1,0,1]
    v_pk_fma_f32 v[124:125], v[124:125], v[40:41], v[188:189] op_sel_hi:[1,0,1]
    v_pk_fma_f32 v[126:127], v[126:127], v[40:41], v[190:191] op_sel_hi:[1,0,1]
    v_pk_fma_f32 v[140:141], v[140:141], v[40:41], v[204:205] op_sel_hi:[1,0,1]
    v_pk_fma_f32 v[142:143], v[142:143], v[40:41], v[206:207] op_sel_hi:[1,0,1]
    v_pk_fma_f32 v[156:157], v[156:157], v[40:41], v[220:221] op_sel_hi:[1,0,1]
    v_pk_fma_f32 v[158:159], v[158:159], v[40:41], v[222:223] op_sel_hi:[1,0,1]
    v_pk_fma_f32 v[172:173], v[172:173], v[40:41], v[236:237] op_sel_hi:[1,0,1]
    v_pk_fma_f32 v[174:175], v[174:175], v[40:41], v[238:239] op_sel_hi:[1,0,1]
    v_pk_fma_f32 v[128:129], v[128:129], v[42:43], v[192:193] op_sel_hi:[1,0,1]
    v_pk_fma_f32 v[130:131], v[130:131], v[42:43], v[194:195] op_sel_hi:[1,0,1]
    v_pk_fma_f32 v[144:145], v[144:145], v[42:43], v[208:209] op_sel_hi:[1,0,1]
    v_pk_fma_f32 v[146:147], v[146:147], v[42:43], v[210:211] op_sel_hi:[1,0,1]
    v_pk_fma_f32 v[160:161], v[160:161], v[42:43], v[224:225] op_sel_hi:[1,0,1]
    v_pk_fma_f32 v[162:163], v[162:163], v[42:43], v[226:227] op_sel_hi:[1,0,1]
    v_pk_fma_f32 v[176:177], v[176:177], v[42:43], v[240:241] op_sel_hi:[1,0,1]
    v_pk_fma_f32 v[178:179], v[178:179], v[42:43], v[242:243] op_sel_hi:[1,0,1]
P3_epi:
    s_lshl_b32 s34, s40, 3
    s_add_u32 s34, s34, s41
    s_lshl_b32 s30, s34, 7
    s_add_u32 s30, s30, 41959424
    s_lshl_b32 s34, s34, 18
    s_lshl_b32 s35, s28, 11
    s_add_u32 s34, s34, s35
    s_add_u32 s34, s34, 67108864
    s_lshl_b32 s32, s42, 14
    s_add_u32 s32, s32, s34
    s_lshl_b32 s33, s42, 16
    s_add_u32 s33, s33, s34
    v_lshlrev_b32 v8, 4, v1
    s_cmp_eq_u32 s42, 0
    s_cbranch_scc1 P3_e0
    s_cmp_eq_u32 s42, 1
    s_cbranch_scc1 P3_e1
    s_cmp_eq_u32 s42, 2
    s_cbranch_scc1 P3_e2
    s_cmp_eq_u32 s42, 3
    s_cbranch_scc1 P3_e3
P3_e0:
    s_add_u32 s34, s32, 65536
    v_cvt_pk_bf16_f32 v188, v120, v121
    v_cvt_pk_bf16_f32 v189, v122, v123
    v_cvt_pk_bf16_f32 v190, v136, v137
    v_cvt_pk_bf16_f32 v191, v138, v139
    buffer_store_dwordx4 v[188:191], v8, s[16:19], s34 offen offset:0 sc1
    v_cvt_pk_bf16_f32 v192, v152, v153
    v_cvt_pk_bf16_f32 v193, v154, v155
    v_cvt_pk_bf16_f32 v194, v168, v169
    v_cvt_pk_bf16_f32 v195, v170, v171
    buffer_store_dwordx4 v[192:195], v8, s[16:19], s34 offen offset:1024 sc1
    s_add_u32 s34, s32, 131072
    v_cvt_pk_bf16_f32 v196, v124, v125
    v_cvt_pk_bf16_f32 v197, v126, v127
    v_cvt_pk_bf16_f32 v198, v140, v141
    v_cvt_pk_bf16_f32 v199, v142, v143
    buffer_store_dwordx4 v[196:199], v8, s[16:19], s34 offen offset:0 sc1
    v_cvt_pk_bf16_f32 v200, v156, v157
    v_cvt_pk_bf16_f32 v201, v158, v159
    v_cvt_pk_bf16_f32 v202, v172, v173
    v_cvt_pk_bf16_f32 v203, v174, v175
    buffer_store_dwordx4 v[200:203], v8, s[16:19], s34 offen offset:1024 sc1
    s_add_u32 s34, s32, 196608
    v_cvt_pk_bf16_f32 v204, v128, v129
    v_cvt_pk_bf16_f32 v205, v130, v131
    v_cvt_pk_bf16_f32 v206, v144, v145
    v_cvt_pk_bf16_f32 v207, v146, v147
    buffer_store_dwordx4 v[204:207], v8, s[16:19], s34 offen offset:0 sc1
    v_cvt_pk_bf16_f32 v208, v160, v161
    v_cvt_pk_bf16_f32 v209, v162, v163
    v_cvt_pk_bf16_f32 v210, v176, v177
    v_cvt_pk_bf16_f32 v211, v178, v179
    buffer_store_dwordx4 v[208:211], v8, s[16:19], s34 offen offset:1024 sc1
    v_pk_add_f32 v[52:53], v[116:117], v[2:3] op_sel_hi:[1,0]
    v_pk_add_f32 v[54:55], v[118:119], v[2:3] op_sel_hi:[1,0]
    v_pk_add_f32 v[56:57], v[132:133], v[2:3] op_sel_hi:[1,0]
    v_pk_add_f32 v[58:59], v[134:135], v[2:3] op_sel_hi:[1,0]
    v_pk_add_f32 v[60:61], v[148:149], v[2:3] op_sel_hi:[1,0]
    v_pk_add_f32 v[62:63], v[150:151], v[2:3] op_sel_hi:[1,0]
    v_pk_add_f32 v[64:65], v[164:165], v[2:3] op_sel_hi:[1,0]
    v_pk_add_f32 v[66:67], v[166:167], v[2:3] op_sel_hi:[1,0]
    s_branch P3_e4
P3_e1:
    s_add_u32 s34, s32, 131072
    v_cvt_pk_bf16_f32 v196, v124, v125
    v_cvt_pk_bf16_f32 v197, v126, v127
    v_cvt_pk_bf16_f32 v198, v140, v141
    v_cvt_pk_bf16_f32 v199, v142, v143
    buffer_store_dwordx4 v[196:199], v8, s[16:19], s34 offen offset:0 sc1
    v_cvt_pk_bf16_f32 v200, v156, v157
    v_cvt_pk_bf16_f32 v201, v158, v159
    v_cvt_pk_bf16_f32 v202, v172, v173
    v_cvt_pk_bf16_f32 v203, v174, v175
    buffer_store_dwordx4 v[200:203], v8, s[16:19], s34 offen offset:1024 sc1
    s_add_u32 s34, s32, 196608
    v_cvt_pk_bf16_f32 v204, v128, v129
    v_cvt_pk_bf16_f32 v205, v130, v131
    v_cvt_pk_bf16_f32 v206, v144, v145
    v_cvt_pk_bf16_f32 v207, v146, v147
    buffer_store_dwordx4 v[204:207], v8, s[16:19], s34 offen offset:0 sc1
    v_cvt_pk_bf16_f32 v208, v160, v161
    v_cvt_pk_bf16_f32 v209, v162, v163
    v_cvt_pk_bf16_f32 v210, v176, v177
    v_cvt_pk_bf16_f32 v211, v178, v179
    buffer_store_dwordx4 v[208:211], v8, s[16:19], s34 offen offset:1024 sc1
    s_add_u32 s34, s32, 0
    v_cvt_pk_bf16_f32 v180, v116, v117
    v_cvt_pk_bf16_f32 v181, v118, v119
    v_cvt_pk_bf16_f32 v182, v132, v133
    v_cvt_pk_bf16_f32 v183, v134, v135
    buffer_store_dwordx4 v[180:183], v8, s[16:19], s34 offen offset:0 sc1
    v_cvt_pk_bf16_f32 v184, v148, v149
    v_cvt_pk_bf16_f32 v185, v150, v151
    v_cvt_pk_bf16_f32 v186, v164, v165
    v_cvt_pk_bf16_f32 v187, v166, v167
    buffer_store_dwordx4 v[184:187], v8, s[16:19], s34 offen offset:1024 sc1
    v_pk_add_f32 v[52:53], v[120:121], v[2:3] op_sel_hi:[1,0]
    v_pk_add_f32 v[54:55], v[122:123], v[2:3] op_sel_hi:[1,0]
    v_pk_add_f32 v[56:57], v[136:137], v[2:3] op_sel_hi:[1,0]
    v_pk_add_f32 v[58:59], v[138:139], v[2:3] op_sel_hi:[1,0]
    v_pk_add_f32 v[60:61], v[152:153], v[2:3] op_sel_hi:[1,0]
    v_pk_add_f32 v[62:63], v[154:155], v[2:3] op_sel_hi:[1,0]
    v_pk_add_f32 v[64:65], v[168:169], v[2:3] op_sel_hi:[1,0]
    v_pk_add_f32 v[66:67], v[170:171], v[2:3] op_sel_hi:[1,0]
    s_branch P3_e4
P3_e2:
    s_add_u32 s34, s32, 196608
    v_cvt_pk_bf16_f32 v204, v128, v129
    v_cvt_pk_bf16_f32 v205, v130, v131
    v_cvt_pk_bf16_f32 v206, v144, v145
    v_cvt_pk_bf16_f32 v207, v146, v147
    buffer_store_dwordx4 v[204:207], v8, s[16:19], s34 offen offset:0 sc1
    v_cvt_pk_bf16_f32 v208, v160, v161
    v_cvt_pk_bf16_f32 v209, v162, v163
    v_cvt_pk_bf16_f32 v210, v176, v177
    v_cvt_pk_bf16_f32 v211, v178, v179
    buffer_store_dwordx4 v[208:211], v8, s[16:19], s34 offen offset:1024 sc1
    s_add_u32 s34, s32, 0
    v_cvt_pk_bf16_f32 v180, v116, v117
    v_cvt_pk_bf16_f32 v181, v118, v119
    v_cvt_pk_bf16_f32 v182, v132, v133
    v_cvt_pk_bf16_f32 v183, v134, v135
    buffer_store_dwordx4 v[180:183], v8, s[16:19], s34 offen offset:0 sc1
    v_cvt_pk_bf16_f32 v184, v148, v149
    v_cvt_pk_bf16_f32 v185, v150, v151
    v_cvt_pk_bf16_f32 v186, v164, v165
    v_cvt_pk_bf16_f32 v187, v166, v167
    buffer_store_dwordx4 v[184:187], v8, s[16:19], s34 offen offset:1024 sc1
    s_add_u32 s34, s32, 65536
    v_cvt_pk_bf16_f32 v188, v120, v121
    v_cvt_pk_bf16_f32 v189, v122, v123
    v_cvt_pk_bf16_f32 v190, v136, v137
    v_cvt_pk_bf16_f32 v191, v138, v139
    buffer_store_dwordx4 v[188:191], v8, s[16:19], s34 offen offset:0 sc1
    v_cvt_pk_bf16_f32 v192, v152, v153
    v_cvt_pk_bf16_f32 v193, v154, v155
    v_cvt_pk_bf16_f32 v194, v168, v169
    v_cvt_pk_bf16_f32 v195, v170, v171
    buffer_store_dwordx4 v[192:195], v8, s[16:19], s34 offen offset:1024 sc1
    v_pk_add_f32 v[52:53], v[124:125], v[2:3] op_sel_hi:[1,0]
    v_pk_add_f32 v[54:55], v[126:127], v[2:3] op_sel_hi:[1,0]
    v_pk_add_f32 v[56:57], v[140:141], v[2:3] op_sel_hi:[1,0]
    v_pk_add_f32 v[58:59], v[142:143], v[2:3] op_sel_hi:[1,0]
    v_pk_add_f32 v[60:61], v[156:157], v[2:3] op_sel_hi:[1,0]
    v_pk_add_f32 v[62:63], v[158:159], v[2:3] op_sel_hi:[1,0]
    v_pk_add_f32 v[64:65], v[172:173], v[2:3] op_sel_hi:[1,0]
    v_pk_add_f32 v[66:67], v[174:175], v[2:3] op_sel_hi:[1,0]
    s_branch P3_e4
P3_e3:
    s_add_u32 s34, s32, 0
    v_cvt_pk_bf16_f32 v180, v116, v117
    v_cvt_pk_bf16_f32 v181, v118, v119
    v_cvt_pk_bf16_f32 v182, v132, v133
    v_cvt_pk_bf16_f32 v183, v134, v135
    buffer_store_dwordx4 v[180:183], v8, s[16:19], s34 offen offset:0 sc1
    v_cvt_pk_bf16_f32 v184, v148, v149
    v_cvt_pk_bf16_f32 v185, v150, v151
    v_cvt_pk_bf16_f32 v186, v164, v165
    v_cvt_pk_bf16_f32 v187, v166, v167
    buffer_store_dwordx4 v[184:187], v8, s[16:19], s34 offen offset:1024 sc1
    s_add_u32 s34, s32, 65536
    v_cvt_pk_bf16_f32 v188, v120, v121
    v_cvt_pk_bf16_f32 v189, v122, v123
    v_cvt_pk_bf16_f32 v190, v136, v137
    v_cvt_pk_bf16_f32 v191, v138, v139
    buffer_store_dwordx4 v[188:191], v8, s[16:19], s34 offen offset:0 sc1
    v_cvt_pk_bf16_f32 v192, v152, v153
    v_cvt_pk_bf16_f32 v193, v154, v155
    v_cvt_pk_bf16_f32 v194, v168, v169
    v_cvt_pk_bf16_f32 v195, v170, v171
    buffer_store_dwordx4 v[192:195], v8, s[16:19], s34 offen offset:1024 sc1
    s_add_u32 s34, s32, 131072
    v_cvt_pk_bf16_f32 v196, v124, v125
    v_cvt_pk_bf16_f32 v197, v126, v127
    v_cvt_pk_bf16_f32 v198, v140, v141
    v_cvt_pk_bf16_f32 v199, v142, v143
    buffer_store_dwordx4 v[196:199], v8, s[16:19], s34 offen offset:0 sc1
    v_cvt_pk_bf16_f32 v200, v156, v157
    v_cvt_pk_bf16_f32 v201, v158, v159
    v_cvt_pk_bf16_f32 v202, v172, v173
    v_cvt_pk_bf16_f32 v203, v174, v175
    buffer_store_dwordx4 v[200:203], v8, s[16:19], s34 offen offset:1024 sc1
    v_pk_add_f32 v[52:53], v[128:129], v[2:3] op_sel_hi:[1,0]
    v_pk_add_f32 v[54:55], v[130:131], v[2:3] op_sel_hi:[1,0]
    v_pk_add_f32 v[56:57], v[144:145], v[2:3] op_sel_hi:[1,0]
    v_pk_add_f32 v[58:59], v[146:147], v[2:3] op_sel_hi:[1,0]
    v_pk_add_f32 v[60:61], v[160:161], v[2:3] op_sel_hi:[1,0]
    v_pk_add_f32 v[62:63], v[162:163], v[2:3] op_sel_hi:[1,0]
    v_pk_add_f32 v[64:65], v[176:177], v[2:3] op_sel_hi:[1,0]
    v_pk_add_f32 v[66:67], v[178:179], v[2:3] op_sel_hi:[1,0]
P3_e4:
    s_mov_b32 s56, s98
    s_mov_b32 s57, s99
    s_mov_b32 s58, 4194304
    s_mov_b32 s59, 0x20000
    v_lshl_add_u32 v9, s42, 4, v252
    v_lshlrev_b32 v9, 11, v9
    v_and_b32 v10, 1, v4
    v_lshl_add_u32 v9, v10, 5, v9
    v_lshrrev_b32 v10, 1, v4
    v_lshl_add_u32 v9, v10, 4, v9
    s_lshl_b32 s36, s40, 8
    s_lshr_b32 s35, s28, 2
    s_lshl_b32 s35, s35, 7
    s_add_u32 s36, s36, s35
    v_mov_b32 v3, s51
    v_and_b32 v16, 3, v1
    v_lshlrev_b32 v16, 2, v16
    s_lshl_b32 s35, s42, 2
    s_add_u32 s35, s35, s30
    s_add_u32 s34, s42, 1
    s_and_b32 s34, s34, 3
    s_lshl_b32 s34, s34, 14
    s_add_u32 s9, s34, s33
    s_add_u32 s34, s42, 2
    s_and_b32 s34, s34, 3
    s_lshl_b32 s34, s34, 14
    s_add_u32 s10, s34, s33
    s_add_u32 s34, s42, 3
    s_and_b32 s34, s34, 3
    s_lshl_b32 s34, s34, 14
    s_add_u32 s11, s34, s33
    s_waitcnt vmcnt(0)
    s_barrier
    s_cmp_lg_u32 s28, 0
    s_cbranch_scc1 P3_nf
    s_mov_b64 exec, 1
    buffer_store_dword v3, v2, s[16:19], s35 offen sc1
    s_mov_b64 exec, -1
P3_nf:
    s_mov_b32 s39, 0
Lp_x:
    buffer_load_dword v10, v16, s[16:19], s30 offen sc1
    s_add_u32 s39, s39, 1
    s_waitcnt vmcnt(0)
    v_cmp_ne_u32 vcc, s51, v10
    s_cbranch_vccz Lq_x
    s_cmp_ge_u32 s39, 0x40000
    s_cbranch_scc1 Lq_x
    s_sleep 1
    s_branch Lp_x
Lq_x:
    buffer_load_dwordx4 v[116:119], v8, s[16:19], s9 offen offset:0 sc1
    buffer_load_dwordx4 v[120:123], v8, s[16:19], s9 offen offset:1024 sc1
    buffer_load_dwordx4 v[132:135], v8, s[16:19], s10 offen offset:0 sc1
    buffer_load_dwordx4 v[136:139], v8, s[16:19], s10 offen offset:1024 sc1
    buffer_load_dwordx4 v[148:151], v8, s[16:19], s11 offen offset:0 sc1
    buffer_load_dwordx4 v[152:155], v8, s[16:19], s11 offen offset:1024 sc1
    s_waitcnt vmcnt(4)
    v_lshlrev_b32 v180, 16, v116
    v_and_b32 v181, 0xffff0000, v116
    v_pk_add_f32 v[52:53], v[52:53], v[180:181]
    v_lshlrev_b32 v182, 16, v117
    v_and_b32 v183, 0xffff0000, v117
    v_pk_add_f32 v[54:55], v[54:55], v[182:183]
    v_lshlrev_b32 v184, 16, v118
    v_and_b32 v185, 0xffff0000, v118
    v_pk_add_f32 v[56:57], v[56:57], v[184:185]
    v_lshlrev_b32 v186, 16, v119
    v_and_b32 v187, 0xffff0000, v119
    v_pk_add_f32 v[58:59], v[58:59], v[186:187]
    v_lshlrev_b32 v188, 16, v120
    v_and_b32 v189, 0xffff0000, v120
    v_pk_add_f32 v[60:61], v[60:61], v[188:189]
    v_lshlrev_b32 v190, 16, v121
    v_and_b32 v191, 0xffff0000, v121
    v_pk_add_f32 v[62:63], v[62:63], v[190:191]
    v_lshlrev_b32 v192, 16, v122
    v_and_b32 v193, 0xffff0000, v122
    v_pk_add_f32 v[64:65], v[64:65], v[192:193]
    v_lshlrev_b32 v194, 16, v123
    v_and_b32 v195, 0xffff0000, v123
    v_pk_add_f32 v[66:67], v[66:67], v[194:195]
    s_waitcnt vmcnt(2)
    v_lshlrev_b32 v180, 16, v132
    v_and_b32 v181, 0xffff0000, v132
    v_pk_add_f32 v[52:53], v[52:53], v[180:181]
    v_lshlrev_b32 v182, 16, v133
    v_and_b32 v183, 0xffff0000, v133
    v_pk_add_f32 v[54:55], v[54:55], v[182:183]
    v_lshlrev_b32 v184, 16, v134
    v_and_b32 v185, 0xffff0000, v134
    v_pk_add_f32 v[56:57], v[56:57], v[184:185]
    v_lshlrev_b32 v186, 16, v135
    v_and_b32 v187, 0xffff0000, v135
    v_pk_add_f32 v[58:59], v[58:59], v[186:187]
    v_lshlrev_b32 v188, 16, v136
    v_and_b32 v189, 0xffff0000, v136
    v_pk_add_f32 v[60:61], v[60:61], v[188:189]
    v_lshlrev_b32 v190, 16, v137
    v_and_b32 v191, 0xffff0000, v137
    v_pk_add_f32 v[62:63], v[62:63], v[190:191]
    v_lshlrev_b32 v192, 16, v138
    v_and_b32 v193, 0xffff0000, v138
    v_pk_add_f32 v[64:65], v[64:65], v[192:193]
    v_lshlrev_b32 v194, 16, v139
    v_and_b32 v195, 0xffff0000, v139
    v_pk_add_f32 v[66:67], v[66:67], v[194:195]
    s_waitcnt vmcnt(0)
    v_lshlrev_b32 v180, 16, v148
    v_and_b32 v181, 0xffff0000, v148
    v_pk_add_f32 v[52:53], v[52:53], v[180:181]
    v_lshlrev_b32 v182, 16, v149
    v_and_b32 v183, 0xffff0000, v149
    v_pk_add_f32 v[54:55], v[54:55], v[182:183]
    v_lshlrev_b32 v184, 16, v150
    v_and_b32 v185, 0xffff0000, v150
    v_pk_add_f32 v[56:57], v[56:57], v[184:185]
    v_lshlrev_b32 v186, 16, v151
    v_and_b32 v187, 0xffff0000, v151
    v_pk_add_f32 v[58:59], v[58:59], v[186:187]
    v_lshlrev_b32 v188, 16, v152
    v_and_b32 v189, 0xffff0000, v152
    v_pk_add_f32 v[60:61], v[60:61], v[188:189]
    v_lshlrev_b32 v190, 16, v153
    v_and_b32 v191, 0xffff0000, v153
    v_pk_add_f32 v[62:63], v[62:63], v[190:191]
    v_lshlrev_b32 v192, 16, v154
    v_and_b32 v193, 0xffff0000, v154
    v_pk_add_f32 v[64:65], v[64:65], v[192:193]
    v_lshlrev_b32 v194, 16, v155
    v_and_b32 v195, 0xffff0000, v155
    v_pk_add_f32 v[66:67], v[66:67], v[194:195]
    v_cvt_pk_bf16_f32 v84, v52, v53
    v_cvt_pk_bf16_f32 v85, v54, v55
    v_cvt_pk_bf16_f32 v86, v56, v57
    v_cvt_pk_bf16_f32 v87, v58, v59
    v_cvt_pk_bf16_f32 v88, v60, v61
    v_cvt_pk_bf16_f32 v89, v62, v63
    v_cvt_pk_bf16_f32 v90, v64, v65
    v_cvt_pk_bf16_f32 v91, v66, v67
    v_permlane16_swap_b32 v84, v86
    v_permlane16_swap_b32 v85, v87
    buffer_store_dwordx4 v[84:87], v9, s[56:59], s36 offen offset:0
    s_nop 0
    v_permlane16_swap_b32 v88, v90
    v_permlane16_swap_b32 v89, v91
    buffer_store_dwordx4 v[88:91], v9, s[56:59], s36 offen offset:64
L1_end:
    s_endpgm
.section .rodata,"a"
.p2align 6
.amdhsa_kernel gated_mix__linear_kernel_hedgehog__mixer_token_mlp__prompt_kernel
  .amdhsa_next_free_vgpr 256
  .amdhsa_next_free_sgpr 102
  .amdhsa_accum_offset 256
  .amdhsa_group_segment_fixed_size 0
  .amdhsa_kernarg_size 104
  .amdhsa_user_sgpr_count 2
  .amdhsa_user_sgpr_kernarg_segment_ptr 1
  .amdhsa_system_sgpr_workgroup_id_x 1
  .amdhsa_float_denorm_mode_32 3
.end_amdhsa_kernel
```
